```python
import torch

def _softmax(x, axis=-1):
    return torch.softmax(x, dim=axis)
def _gelu(x):
    return torch.nn.functional.gelu(x, approximate="tanh")
def _silu(x):
    return torch.nn.functional.silu(x)
def _sigmoid(x):
    return torch.sigmoid(x)
def _layernorm(x, axis=-1, eps=1e-5):
    m = x.mean(dim=axis, keepdim=True)
    v = x.var(dim=axis, keepdim=True, unbiased=False)
    return (x - m) / torch.sqrt(v + eps)
def _scatter_add(tgt, idx, src, axis=0):
    return tgt.clone().index_add_(axis, idx, src)
def _segment_sum(src, seg, n):
    out = torch.zeros((n,) + src.shape[1:], dtype=src.dtype)
    return out.index_add_(0, seg, src)
def _pad(x, pw):
    flat = tuple(v for pair in reversed(pw) for v in pair)
    return torch.nn.functional.pad(x, flat)

kernel_name = 'recurrent_scan__gqa_block_cached__dense_activation_relu__prompt'

def setup_inputs():

    _w = (lambda a: (lambda t: t.to(torch.bfloat16) if t.is_floating_point() else t)(torch.as_tensor(a)))
    def _A_setup():
        B, Sq, D = 1, 2048, 512
        Hq, Hkv, Sk, Dh = 32, 8, 2048, 128
        assert Hq % Hkv == 0, (Hq, Hkv)
        return {
            "x": _w((lambda *s: torch.randn(*s, dtype=torch.bfloat16) * 0.05)(B, Sq, D)),
            "k_cache": _w((lambda *s: torch.randn(*s, dtype=torch.bfloat16) * 1.6)(B, Hkv, Sk, Dh)),
            "v_cache": _w((lambda *s: torch.randn(*s, dtype=torch.bfloat16) * 0.2)(B, Hkv, Sk, Dh)),
            "wq": _w((lambda *s: torch.randn(*s, dtype=torch.bfloat16) * 1.6)(D, Hq * Dh) * (D ** -0.5)),
            "wo": _w((lambda *s: torch.randn(*s, dtype=torch.bfloat16) * 0.2)(Hq * Dh, D) * ((Hq * Dh) ** -0.5)),
        }
    _A_in = _A_setup()

    def _B_setup():
        B, S, D, Dff = 1, 2048, 512, 1792
        return {
            "x": _w((lambda *s: torch.randn(*s, dtype=torch.bfloat16) * 0.05)(B, S, D)),
            "w1": _w((lambda *s: torch.randn(*s, dtype=torch.bfloat16) * 0.1)(D, Dff)),
            "w2": _w((lambda *s: torch.randn(*s, dtype=torch.bfloat16) * 0.1)(Dff, D)),
        }
    _B_in = _B_setup()

    return {
        "A_x": _A_in["x"],
        "A_k_cache": _A_in["k_cache"],
        "A_v_cache": _A_in["v_cache"],
        "A_wq": _A_in["wq"],
        "A_wo": _A_in["wo"],
        "B_x": _B_in["x"],
        "B_w1": _B_in["w1"],
        "B_w2": _B_in["w2"],
    }

def reference(A_x, A_k_cache, A_v_cache, A_wq, A_wo, B_x, B_w1, B_w2):
    def _A_ref(x, k_cache, v_cache, wq, wo):
        B, Sq, D = x.shape
        Hq, Dh = 32, 128
        Hkv = k_cache.shape[1]
        rep = Hq // Hkv
        q = (lambda x, *d: x.permute(*d))((x @ wq).reshape(B, Sq, Hq, Dh), 0, 2, 1, 3)
        k = (lambda x, n, axis: torch.repeat_interleave(x, n, dim=axis))(k_cache, rep, axis=1)
        v = (lambda x, n, axis: torch.repeat_interleave(x, n, dim=axis))(v_cache, rep, axis=1)
        scores = torch.einsum("bhqd,bhkd->bhqk", q, k) * (Dh ** -0.5)
        p = _softmax(scores, axis=-1)
        o = torch.einsum("bhqk,bhkd->bhqd", p, v)
        return (lambda x, *d: x.permute(*d))(o, 0, 2, 1, 3).reshape(B, Sq, Hq * Dh) @ wo

    def _B_ref(x, w1, w2):
        h = torch.einsum("bsd,df->bsf", x, w1)
        zero = torch.zeros_like(h)
        h = torch.maximum(h, zero)
        return torch.einsum("bsf,fd->bsd", h, w2)

    x = A_x
    xn = _layernorm(x, axis=-1)
    s = _A_ref(xn, A_k_cache, A_v_cache, A_wq, A_wo)
    g = _silu(_B_ref(xn, B_w1, B_w2))
    return x + s * g
```

```asm
; @launch grid=(256,1,1) block=(256,1,1) lds=163840
.amdgcn_target "amdgcn-amd-amdhsa--gfx950"
.text
.globl recurrent_scan__gqa_block_cached__dense_activation_relu__prompt_kernel
.p2align 8
.type recurrent_scan__gqa_block_cached__dense_activation_relu__prompt_kernel,@function
recurrent_scan__gqa_block_cached__dense_activation_relu__prompt_kernel:

  s_cmp_ge_u32 s2, 256
  s_cbranch_scc1 L_end
  s_load_dwordx16 s[16:31], s[0:1], 0
  s_load_dwordx2 s[36:37], s[0:1], 80
  s_load_dwordx4 s[32:35], s[0:1], 64
  s_getpc_b64 s[48:49]
L_pc:
  s_lshr_b32 s71, s2, 3
  s_mov_b32 s50, L_code_end-L_pc
  s_mov_b32 s51, 0x20000
  s_lshl_b32 s72, s71, 11
  v_lshlrev_b32 v2, 3, v0

  buffer_load_dword a128, v2, s[48:51], s72 offen

  s_lshr_b32 s100, s71, 1
  s_lshr_b32 s70, s2, 1
  s_xor_b32 s70, s70, s2
  s_and_b32 s70, s70, 1
  s_lshl_b32 s70, s70, 4
  s_add_u32 s6, s100, s70
  s_lshl_b32 s94, s6, 16
  v_lshrrev_b32 v4, 2, v0
  v_lshlrev_b32 v4, 10, v4
  v_and_b32 v5, 3, v0
  v_lshl_add_u32 v214, v5, 4, v4
  s_mov_b32 s58, 2097152
  s_mov_b32 s59, 0x20000
  s_and_b32 s5, s2, 6
  s_and_b32 s73, s71, 1
  s_add_u32 s5, s5, s73
  s_mov_b32 s43, 0x20000

  v_lshrrev_b32 v1, 6, v0
  v_and_b32 v212, 63, v0
  s_mov_b32 s66, 0
  v_readfirstlane_b32 s4, v1
  s_and_b32 s67, s6, 0
  s_lshl_b32 s67, s67, 7
  s_and_b32 s15, s2, 1
  s_xor_b32 s15, s15, 0
  s_mul_i32 s70, s100, 43
  s_lshr_b32 s70, s70, 8
  s_mul_i32 s70, s70, 6
  s_sub_u32 s70, s100, s70
  s_and_b32 s101, s100, 7
  s_cmp_lg_u32 s15, 0
  s_cselect_b32 s101, s70, s101
  s_lshl_b32 s100, s100, 0
  s_and_b32 s100, s100, 15
  v_lshrrev_b32 v3, 3, v212
  v_and_b32 v3, 4, v3
  v_xor_b32 v3, v3, v212
  v_lshlrev_b32 v213, 4, v3
  v_lshrrev_b32 v208, 3, v212
  v_lshrrev_b32 v1, 4, v212
  v_lshlrev_b32 v2, 1, v1
  v_and_b32 v3, 7, v212
  v_xor_b32 v3, v3, v2
  v_lshlrev_b32 v209, 4, v3
  s_lshl_b32 s63, s4, 12
  s_add_u32 s64, s63, 65536

  s_waitcnt lgkmcnt(0)
  s_mov_b32 s56, s16
  s_mov_b32 s57, s17
  buffer_load_dwordx4 v[64:67], v214, s[56:59], s94 offen offset:0
  buffer_load_dwordx4 v[68:71], v214, s[56:59], s94 offen offset:64
  buffer_load_dwordx4 v[72:75], v214, s[56:59], s94 offen offset:128
  buffer_load_dwordx4 v[76:79], v214, s[56:59], s94 offen offset:192
  buffer_load_dwordx4 v[80:83], v214, s[56:59], s94 offen offset:256
  buffer_load_dwordx4 v[84:87], v214, s[56:59], s94 offen offset:320
  buffer_load_dwordx4 v[88:91], v214, s[56:59], s94 offen offset:384
  buffer_load_dwordx4 v[92:95], v214, s[56:59], s94 offen offset:448
  buffer_load_dwordx4 v[96:99], v214, s[56:59], s94 offen offset:512
  buffer_load_dwordx4 v[100:103], v214, s[56:59], s94 offen offset:576
  buffer_load_dwordx4 v[104:107], v214, s[56:59], s94 offen offset:640
  buffer_load_dwordx4 v[108:111], v214, s[56:59], s94 offen offset:704
  buffer_load_dwordx4 v[112:115], v214, s[56:59], s94 offen offset:768
  buffer_load_dwordx4 v[116:119], v214, s[56:59], s94 offen offset:832
  buffer_load_dwordx4 v[120:123], v214, s[56:59], s94 offen offset:896
  buffer_load_dwordx4 v[124:127], v214, s[56:59], s94 offen offset:960

  s_lshr_b32 s70, s5, 2
  s_mul_i32 s26, s70, 896
  s_lshl_b32 s70, s15, 9
  s_add_u32 s26, s26, s70
  s_lshl_b32 s70, s15, 6
  s_sub_u32 s70, 256, s70
  s_and_b32 s71, s5, 1
  s_mul_i32 s70, s70, s71
  s_add_u32 s26, s26, s70

  s_mov_b32 s40, s28
  s_mov_b32 s41, s29
  s_mov_b32 s42, 1835008
  s_mov_b32 s70, 3584
  v_mad_u32_u24 v236, v208, s70, v209
  s_lshl_b32 s70, s26, 1
  s_lshl_b32 s71, s4, 7
  s_add_u32 s70, s70, s71
  v_add_u32 v236, s70, v236
  v_add_u32 v237, 27648, v236
  v_add_u32 v238, 55296, v236
  v_add_u32 v239, 82944, v236
  s_mov_b32 s14, 114688
  s_lshl_b32 s70, s15, 2
  s_or_b32 s70, s70, s4
  s_cmp_eq_u32 s70, 7
  s_cselect_b32 s42, 0, s42
  s_mov_b32 s27, 1835008
  s_mul_i32 s13, s100, 114688
  s_sub_u32 s13, s13, s14

  v_and_b32 v6, 15, v212
  v_lshrrev_b32 v8, 2, v6
  v_lshl_add_u32 v8, v1, 2, v8
  v_and_b32 v9, 3, v6
  v_lshlrev_b32 v9, 3, v9
  v_lshl_add_u32 v10, v8, 7, v9
  v_add_u32 v10, s64, v10
  v_bfe_u32 v11, v8, 1, 2

  v_xor_b32 v12, 0, v11
  v_lshl_add_u32 v240, v12, 5, v10
  v_add_u32 v244, 49152, v240
  v_xor_b32 v12, 1, v11
  v_lshl_add_u32 v241, v12, 5, v10
  v_add_u32 v245, 49152, v241
  v_xor_b32 v12, 2, v11
  v_lshl_add_u32 v242, v12, 5, v10
  v_add_u32 v246, 49152, v242
  v_xor_b32 v12, 3, v11
  v_lshl_add_u32 v243, v12, 5, v10
  v_add_u32 v247, 49152, v243

  v_lshrrev_b32 v8, 2, v212
  v_and_b32 v9, 1, v212
  v_mul_u32_u24 v9, 36, v9
  v_xor_b32 v8, v9, v8
  v_lshlrev_b32 v8, 4, v8
  v_bfe_u32 v9, v212, 1, 1
  v_lshl_add_u32 v8, v9, 3, v8
  s_lshl_b32 s70, s4, 10
  v_add_u32 v215, s70, v8

  s_lshl_b32 s70, s5, 19
  s_add_u32 s44, s18, s70
  s_addc_u32 s45, s19, 0
  s_mov_b32 s46, 0x80000
  s_mov_b32 s47, 0x20000
  s_add_u32 s48, s20, s70
  s_addc_u32 s49, s21, 0
  s_mov_b32 s50, 0x80000
  s_mov_b32 s51, 0x20000
  s_mov_b32 s52, s36
  s_mov_b32 s53, s37
  s_mov_b32 s54, 67108864
  s_mov_b32 s55, 0x20000
  s_and_b32 s69, s6, 0
  s_lshl_b32 s69, s69, 18
  s_add_u32 s69, s69, s63
  s_mov_b32 s60, s69
  s_lshl_b32 s65, s6, 3
  s_add_u32 s65, s65, s5
  s_lshl_b32 s65, s65, 15
  s_and_b32 s70, s6, 0
  s_add_u32 s70, s70, s4
  s_and_b32 s70, s70, 3
  s_lshl_b32 s70, s70, 13
  s_add_u32 s65, s65, s70
  v_lshrrev_b32 v129, 4, v212
  v_lshlrev_b32 v130, 1, v129
  v_and_b32 v134, 15, v212
  v_xor_b32 v135, v134, v129
  v_lshlrev_b32 v135, 4, v135
  v_lshl_add_u32 v228, v129, 8, v135

  v_xor_b32 v229, 64, v228
  v_xor_b32 v230, 128, v228
  v_xor_b32 v231, 192, v228

  v_xor_b32 v136, v134, v130
  v_lshlrev_b32 v136, 4, v136
  v_lshl_add_u32 v232, v129, 8, v136
  v_xor_b32 v233, 128, v232
  v_and_b32 v136, 2, v130
  v_lshrrev_b32 v137, 1, v129
  v_or_b32 v136, v136, v137
  v_xor_b32 v136, v136, v134
  v_lshlrev_b32 v136, 4, v136
  v_lshl_add_u32 v216, v134, 8, v136
  s_lshl_b32 s70, s15, 7
  s_and_b32 s70, s70, 0
  s_xor_b32 s70, s70, s67
  v_xor_b32 v216, s70, v216

  v_xor_b32 v217, 64, v216
  v_xor_b32 v218, 128, v216
  v_xor_b32 v219, 192, v216

  v_lshrrev_b32 v136, 2, v134
  v_lshl_add_u32 v136, v129, 2, v136
  v_and_b32 v137, 3, v134
  v_lshlrev_b32 v137, 3, v137
  v_lshl_add_u32 v138, v136, 8, v137
  v_add_u32 v138, 65536, v138
  v_and_b32 v139, 7, v136
  v_lshl_add_u32 v220, v139, 5, v138

  v_xor_b32 v221, 32, v220
  v_xor_b32 v222, 64, v220
  v_xor_b32 v223, 96, v220
  v_xor_b32 v224, 128, v220
  v_xor_b32 v225, 160, v220
  v_xor_b32 v226, 192, v220
  v_xor_b32 v227, 224, v220

  s_mov_b32 s96, s34
  s_mov_b32 s97, s35
  s_lshl_b32 s98, s6, 2
  s_add_u32 s98, s98, 4
  s_mov_b32 s99, 0x20000
  s_lshl_b32 s11, s6, 18
  s_lshr_b32 s70, s5, 1
  s_lshl_b32 s70, s70, 2
  s_and_b32 s71, s5, 1
  s_add_u32 s71, s71, s70
  s_and_b32 s70, s6, 0
  s_lshl_b32 s70, s70, 1
  s_add_u32 s70, s70, s5
  s_and_b32 s70, s70, 7
  s_lshl_b32 s70, s70, 12
  s_add_u32 s11, s11, s70
  s_lshl_b32 s70, s4, 10
  s_add_u32 s11, s11, s70
  s_lshl_b32 s12, s6, 16
  s_lshl_b32 s70, s4, 14
  s_add_u32 s12, s12, s70
  s_lshl_b32 s70, s71, 6
  s_add_u32 s12, s12, s70

  v_mov_b32 v204, 0
  v_mov_b32 v205, 0
  v_mov_b32 v206, 0
  v_mov_b32 v207, 0
  s_nop 1
  v_mfma_f32_32x32x16_bf16 a[0:15], v[204:207], v[204:207], 0
  v_mfma_f32_32x32x16_bf16 a[16:31], v[204:207], v[204:207], 0
  v_mfma_f32_32x32x16_bf16 a[32:47], v[204:207], v[204:207], 0
  v_mfma_f32_32x32x16_bf16 a[48:63], v[204:207], v[204:207], 0
  v_mfma_f32_32x32x16_bf16 a[64:79], v[204:207], v[204:207], 0
  v_mfma_f32_32x32x16_bf16 a[80:95], v[204:207], v[204:207], 0
  v_mfma_f32_32x32x16_bf16 a[96:111], v[204:207], v[204:207], 0
  v_mfma_f32_32x32x16_bf16 a[112:127], v[204:207], v[204:207], 0
  v_and_b32 v8, 3, v212
  v_and_b32 v9, 60, v212
  v_lshl_add_u32 v8, v8, 12, v9
  s_lshl_b32 s70, s4, 6
  s_add_u32 s70, s70, 81920
  v_add_u32 v210, s70, v8
  s_add_u32 s70, s64, 16384
  v_lshl_add_u32 v235, v6, 2, s70
  s_waitcnt vmcnt(15)
  s_add_u32 m0, s64, 32768
  s_add_u32 s13, s13, s14
  s_cmp_eq_u32 s13, s27
  s_cselect_b32 s13, 0, s13
  buffer_load_dwordx4 v236, s[40:43], s13 offen offset:0 lds
  v_lshlrev_b32 v0, 16, v64
  v_and_b32 v1, 0xffff0000, v64
  v_lshlrev_b32 v2, 16, v65
  v_and_b32 v3, 0xffff0000, v65
  v_lshlrev_b32 v4, 16, v66
  v_and_b32 v5, 0xffff0000, v66
  v_lshlrev_b32 v6, 16, v67
  v_and_b32 v7, 0xffff0000, v67
  v_pk_add_f32 v[192:193], v[0:1], v[4:5]
  v_pk_mul_f32 v[196:197], v[0:1], v[0:1]
  v_pk_add_f32 v[194:195], v[2:3], v[6:7]
  v_pk_mul_f32 v[198:199], v[2:3], v[2:3]
  v_pk_fma_f32 v[196:197], v[4:5], v[4:5], v[196:197]
  v_pk_fma_f32 v[198:199], v[6:7], v[6:7], v[198:199]
  s_waitcnt vmcnt(15)
  buffer_load_dwordx4 v237, s[40:43], s13 offen offset:1024 lds
  v_lshlrev_b32 v8, 16, v68
  v_and_b32 v9, 0xffff0000, v68
  v_lshlrev_b32 v10, 16, v69
  v_and_b32 v11, 0xffff0000, v69
  v_lshlrev_b32 v12, 16, v70
  v_and_b32 v13, 0xffff0000, v70
  v_lshlrev_b32 v14, 16, v71
  v_and_b32 v15, 0xffff0000, v71
  v_pk_add_f32 v[192:193], v[192:193], v[8:9]
  v_pk_fma_f32 v[196:197], v[8:9], v[8:9], v[196:197]
  v_pk_add_f32 v[194:195], v[194:195], v[10:11]
  v_pk_fma_f32 v[198:199], v[10:11], v[10:11], v[198:199]
  v_pk_add_f32 v[192:193], v[192:193], v[12:13]
  v_pk_fma_f32 v[196:197], v[12:13], v[12:13], v[196:197]
  v_pk_add_f32 v[194:195], v[194:195], v[14:15]
  v_pk_fma_f32 v[198:199], v[14:15], v[14:15], v[198:199]
  s_waitcnt vmcnt(15)
  buffer_load_dwordx4 v238, s[40:43], s13 offen offset:2048 lds
  v_lshlrev_b32 v16, 16, v72
  v_and_b32 v17, 0xffff0000, v72
  v_lshlrev_b32 v18, 16, v73
  v_and_b32 v19, 0xffff0000, v73
  v_lshlrev_b32 v20, 16, v74
  v_and_b32 v21, 0xffff0000, v74
  v_lshlrev_b32 v22, 16, v75
  v_and_b32 v23, 0xffff0000, v75
  v_pk_add_f32 v[192:193], v[192:193], v[16:17]
  v_pk_fma_f32 v[196:197], v[16:17], v[16:17], v[196:197]
  v_pk_add_f32 v[194:195], v[194:195], v[18:19]
  v_pk_fma_f32 v[198:199], v[18:19], v[18:19], v[198:199]
  v_pk_add_f32 v[192:193], v[192:193], v[20:21]
  v_pk_fma_f32 v[196:197], v[20:21], v[20:21], v[196:197]
  v_pk_add_f32 v[194:195], v[194:195], v[22:23]
  v_pk_fma_f32 v[198:199], v[22:23], v[22:23], v[198:199]
  s_waitcnt vmcnt(15)
  buffer_load_dwordx4 v239, s[40:43], s13 offen offset:3072 lds
  v_lshlrev_b32 v24, 16, v76
  v_and_b32 v25, 0xffff0000, v76
  v_lshlrev_b32 v26, 16, v77
  v_and_b32 v27, 0xffff0000, v77
  v_lshlrev_b32 v28, 16, v78
  v_and_b32 v29, 0xffff0000, v78
  v_lshlrev_b32 v30, 16, v79
  v_and_b32 v31, 0xffff0000, v79
  v_pk_add_f32 v[192:193], v[192:193], v[24:25]
  v_pk_fma_f32 v[196:197], v[24:25], v[24:25], v[196:197]
  v_pk_add_f32 v[194:195], v[194:195], v[26:27]
  v_pk_fma_f32 v[198:199], v[26:27], v[26:27], v[198:199]
  v_pk_add_f32 v[192:193], v[192:193], v[28:29]
  v_pk_fma_f32 v[196:197], v[28:29], v[28:29], v[196:197]
  v_pk_add_f32 v[194:195], v[194:195], v[30:31]
  v_pk_fma_f32 v[198:199], v[30:31], v[30:31], v[198:199]
  s_waitcnt vmcnt(15)
  s_add_u32 m0, s64, 49152
  s_add_u32 s13, s13, s14
  s_cmp_eq_u32 s13, s27
  s_cselect_b32 s13, 0, s13
  buffer_load_dwordx4 v236, s[40:43], s13 offen offset:0 lds
  v_lshlrev_b32 v32, 16, v80
  v_and_b32 v33, 0xffff0000, v80
  v_lshlrev_b32 v34, 16, v81
  v_and_b32 v35, 0xffff0000, v81
  v_lshlrev_b32 v36, 16, v82
  v_and_b32 v37, 0xffff0000, v82
  v_lshlrev_b32 v38, 16, v83
  v_and_b32 v39, 0xffff0000, v83
  v_pk_add_f32 v[192:193], v[192:193], v[32:33]
  v_pk_fma_f32 v[196:197], v[32:33], v[32:33], v[196:197]
  v_pk_add_f32 v[194:195], v[194:195], v[34:35]
  v_pk_fma_f32 v[198:199], v[34:35], v[34:35], v[198:199]
  v_pk_add_f32 v[192:193], v[192:193], v[36:37]
  v_pk_fma_f32 v[196:197], v[36:37], v[36:37], v[196:197]
  v_pk_add_f32 v[194:195], v[194:195], v[38:39]
  v_pk_fma_f32 v[198:199], v[38:39], v[38:39], v[198:199]
  s_waitcnt vmcnt(15)
  buffer_load_dwordx4 v237, s[40:43], s13 offen offset:1024 lds
  v_lshlrev_b32 v40, 16, v84
  v_and_b32 v41, 0xffff0000, v84
  v_lshlrev_b32 v42, 16, v85
  v_and_b32 v43, 0xffff0000, v85
  v_lshlrev_b32 v44, 16, v86
  v_and_b32 v45, 0xffff0000, v86
  v_lshlrev_b32 v46, 16, v87
  v_and_b32 v47, 0xffff0000, v87
  v_pk_add_f32 v[192:193], v[192:193], v[40:41]
  v_pk_fma_f32 v[196:197], v[40:41], v[40:41], v[196:197]
  v_pk_add_f32 v[194:195], v[194:195], v[42:43]
  v_pk_fma_f32 v[198:199], v[42:43], v[42:43], v[198:199]
  v_pk_add_f32 v[192:193], v[192:193], v[44:45]
  v_pk_fma_f32 v[196:197], v[44:45], v[44:45], v[196:197]
  v_pk_add_f32 v[194:195], v[194:195], v[46:47]
  v_pk_fma_f32 v[198:199], v[46:47], v[46:47], v[198:199]
  s_waitcnt vmcnt(15)
  buffer_load_dwordx4 v238, s[40:43], s13 offen offset:2048 lds
  v_lshlrev_b32 v48, 16, v88
  v_and_b32 v49, 0xffff0000, v88
  v_lshlrev_b32 v50, 16, v89
  v_and_b32 v51, 0xffff0000, v89
  v_lshlrev_b32 v52, 16, v90
  v_and_b32 v53, 0xffff0000, v90
  v_lshlrev_b32 v54, 16, v91
  v_and_b32 v55, 0xffff0000, v91
  v_pk_add_f32 v[192:193], v[192:193], v[48:49]
  v_pk_fma_f32 v[196:197], v[48:49], v[48:49], v[196:197]
  v_pk_add_f32 v[194:195], v[194:195], v[50:51]
  v_pk_fma_f32 v[198:199], v[50:51], v[50:51], v[198:199]
  v_pk_add_f32 v[192:193], v[192:193], v[52:53]
  v_pk_fma_f32 v[196:197], v[52:53], v[52:53], v[196:197]
  v_pk_add_f32 v[194:195], v[194:195], v[54:55]
  v_pk_fma_f32 v[198:199], v[54:55], v[54:55], v[198:199]
  s_waitcnt vmcnt(15)
  buffer_load_dwordx4 v239, s[40:43], s13 offen offset:3072 lds
  v_lshlrev_b32 v56, 16, v92
  v_and_b32 v57, 0xffff0000, v92
  v_lshlrev_b32 v58, 16, v93
  v_and_b32 v59, 0xffff0000, v93
  v_lshlrev_b32 v60, 16, v94
  v_and_b32 v61, 0xffff0000, v94
  v_lshlrev_b32 v62, 16, v95
  v_and_b32 v63, 0xffff0000, v95
  v_pk_add_f32 v[192:193], v[192:193], v[56:57]
  v_pk_fma_f32 v[196:197], v[56:57], v[56:57], v[196:197]
  v_pk_add_f32 v[194:195], v[194:195], v[58:59]
  v_pk_fma_f32 v[198:199], v[58:59], v[58:59], v[198:199]
  v_pk_add_f32 v[192:193], v[192:193], v[60:61]
  v_pk_fma_f32 v[196:197], v[60:61], v[60:61], v[196:197]
  v_pk_add_f32 v[194:195], v[194:195], v[62:63]
  v_pk_fma_f32 v[198:199], v[62:63], v[62:63], v[198:199]
  s_waitcnt vmcnt(15)
  v_lshlrev_b32 v128, 16, v96
  v_and_b32 v129, 0xffff0000, v96
  v_lshlrev_b32 v130, 16, v97
  v_and_b32 v131, 0xffff0000, v97
  v_lshlrev_b32 v132, 16, v98
  v_and_b32 v133, 0xffff0000, v98
  v_lshlrev_b32 v134, 16, v99
  v_and_b32 v135, 0xffff0000, v99
  v_pk_add_f32 v[192:193], v[192:193], v[128:129]
  v_pk_fma_f32 v[196:197], v[128:129], v[128:129], v[196:197]
  v_pk_add_f32 v[194:195], v[194:195], v[130:131]
  v_pk_fma_f32 v[198:199], v[130:131], v[130:131], v[198:199]
  v_pk_add_f32 v[192:193], v[192:193], v[132:133]
  v_pk_fma_f32 v[196:197], v[132:133], v[132:133], v[196:197]
  v_pk_add_f32 v[194:195], v[194:195], v[134:135]
  v_pk_fma_f32 v[198:199], v[134:135], v[134:135], v[198:199]
  s_waitcnt vmcnt(14)
  v_lshlrev_b32 v136, 16, v100
  v_and_b32 v137, 0xffff0000, v100
  v_lshlrev_b32 v138, 16, v101
  v_and_b32 v139, 0xffff0000, v101
  v_lshlrev_b32 v140, 16, v102
  v_and_b32 v141, 0xffff0000, v102
  v_lshlrev_b32 v142, 16, v103
  v_and_b32 v143, 0xffff0000, v103
  v_pk_add_f32 v[192:193], v[192:193], v[136:137]
  v_pk_fma_f32 v[196:197], v[136:137], v[136:137], v[196:197]
  v_pk_add_f32 v[194:195], v[194:195], v[138:139]
  v_pk_fma_f32 v[198:199], v[138:139], v[138:139], v[198:199]
  v_pk_add_f32 v[192:193], v[192:193], v[140:141]
  v_pk_fma_f32 v[196:197], v[140:141], v[140:141], v[196:197]
  v_pk_add_f32 v[194:195], v[194:195], v[142:143]
  v_pk_fma_f32 v[198:199], v[142:143], v[142:143], v[198:199]
  s_waitcnt vmcnt(13)
  v_lshlrev_b32 v144, 16, v104
  v_and_b32 v145, 0xffff0000, v104
  v_lshlrev_b32 v146, 16, v105
  v_and_b32 v147, 0xffff0000, v105
  v_lshlrev_b32 v148, 16, v106
  v_and_b32 v149, 0xffff0000, v106
  v_lshlrev_b32 v150, 16, v107
  v_and_b32 v151, 0xffff0000, v107
  v_pk_add_f32 v[192:193], v[192:193], v[144:145]
  v_pk_fma_f32 v[196:197], v[144:145], v[144:145], v[196:197]
  v_pk_add_f32 v[194:195], v[194:195], v[146:147]
  v_pk_fma_f32 v[198:199], v[146:147], v[146:147], v[198:199]
  v_pk_add_f32 v[192:193], v[192:193], v[148:149]
  v_pk_fma_f32 v[196:197], v[148:149], v[148:149], v[196:197]
  v_pk_add_f32 v[194:195], v[194:195], v[150:151]
  v_pk_fma_f32 v[198:199], v[150:151], v[150:151], v[198:199]
  s_waitcnt vmcnt(12)
  v_lshlrev_b32 v152, 16, v108
  v_and_b32 v153, 0xffff0000, v108
  v_lshlrev_b32 v154, 16, v109
  v_and_b32 v155, 0xffff0000, v109
  v_lshlrev_b32 v156, 16, v110
  v_and_b32 v157, 0xffff0000, v110
  v_lshlrev_b32 v158, 16, v111
  v_and_b32 v159, 0xffff0000, v111
  v_pk_add_f32 v[192:193], v[192:193], v[152:153]
  v_pk_fma_f32 v[196:197], v[152:153], v[152:153], v[196:197]
  v_pk_add_f32 v[194:195], v[194:195], v[154:155]
  v_pk_fma_f32 v[198:199], v[154:155], v[154:155], v[198:199]
  v_pk_add_f32 v[192:193], v[192:193], v[156:157]
  v_pk_fma_f32 v[196:197], v[156:157], v[156:157], v[196:197]
  v_pk_add_f32 v[194:195], v[194:195], v[158:159]
  v_pk_fma_f32 v[198:199], v[158:159], v[158:159], v[198:199]
  s_waitcnt vmcnt(11)
  v_lshlrev_b32 v160, 16, v112
  v_and_b32 v161, 0xffff0000, v112
  v_lshlrev_b32 v162, 16, v113
  v_and_b32 v163, 0xffff0000, v113
  v_lshlrev_b32 v164, 16, v114
  v_and_b32 v165, 0xffff0000, v114
  v_lshlrev_b32 v166, 16, v115
  v_and_b32 v167, 0xffff0000, v115
  v_pk_add_f32 v[192:193], v[192:193], v[160:161]
  v_pk_fma_f32 v[196:197], v[160:161], v[160:161], v[196:197]
  v_pk_add_f32 v[194:195], v[194:195], v[162:163]
  v_pk_fma_f32 v[198:199], v[162:163], v[162:163], v[198:199]
  v_pk_add_f32 v[192:193], v[192:193], v[164:165]
  v_pk_fma_f32 v[196:197], v[164:165], v[164:165], v[196:197]
  v_pk_add_f32 v[194:195], v[194:195], v[166:167]
  v_pk_fma_f32 v[198:199], v[166:167], v[166:167], v[198:199]
  s_waitcnt vmcnt(10)
  v_lshlrev_b32 v168, 16, v116
  v_and_b32 v169, 0xffff0000, v116
  v_lshlrev_b32 v170, 16, v117
  v_and_b32 v171, 0xffff0000, v117
  v_lshlrev_b32 v172, 16, v118
  v_and_b32 v173, 0xffff0000, v118
  v_lshlrev_b32 v174, 16, v119
  v_and_b32 v175, 0xffff0000, v119
  v_pk_add_f32 v[192:193], v[192:193], v[168:169]
  v_pk_fma_f32 v[196:197], v[168:169], v[168:169], v[196:197]
  v_pk_add_f32 v[194:195], v[194:195], v[170:171]
  v_pk_fma_f32 v[198:199], v[170:171], v[170:171], v[198:199]
  v_pk_add_f32 v[192:193], v[192:193], v[172:173]
  v_pk_fma_f32 v[196:197], v[172:173], v[172:173], v[196:197]
  v_pk_add_f32 v[194:195], v[194:195], v[174:175]
  v_pk_fma_f32 v[198:199], v[174:175], v[174:175], v[198:199]
  s_waitcnt vmcnt(9)
  v_lshlrev_b32 v176, 16, v120
  v_and_b32 v177, 0xffff0000, v120
  v_lshlrev_b32 v178, 16, v121
  v_and_b32 v179, 0xffff0000, v121
  v_lshlrev_b32 v180, 16, v122
  v_and_b32 v181, 0xffff0000, v122
  v_lshlrev_b32 v182, 16, v123
  v_and_b32 v183, 0xffff0000, v123
  v_pk_add_f32 v[192:193], v[192:193], v[176:177]
  v_pk_fma_f32 v[196:197], v[176:177], v[176:177], v[196:197]
  v_pk_add_f32 v[194:195], v[194:195], v[178:179]
  v_pk_fma_f32 v[198:199], v[178:179], v[178:179], v[198:199]
  v_pk_add_f32 v[192:193], v[192:193], v[180:181]
  v_pk_fma_f32 v[196:197], v[180:181], v[180:181], v[196:197]
  v_pk_add_f32 v[194:195], v[194:195], v[182:183]
  v_pk_fma_f32 v[198:199], v[182:183], v[182:183], v[198:199]
  s_waitcnt vmcnt(8)
  v_lshlrev_b32 v184, 16, v124
  v_and_b32 v185, 0xffff0000, v124
  v_lshlrev_b32 v186, 16, v125
  v_and_b32 v187, 0xffff0000, v125
  v_lshlrev_b32 v188, 16, v126
  v_and_b32 v189, 0xffff0000, v126
  v_lshlrev_b32 v190, 16, v127
  v_and_b32 v191, 0xffff0000, v127
  v_pk_add_f32 v[192:193], v[192:193], v[184:185]
  v_pk_fma_f32 v[196:197], v[184:185], v[184:185], v[196:197]
  v_pk_add_f32 v[194:195], v[194:195], v[186:187]
  v_pk_fma_f32 v[198:199], v[186:187], v[186:187], v[198:199]
  v_pk_add_f32 v[192:193], v[192:193], v[188:189]
  v_pk_fma_f32 v[196:197], v[188:189], v[188:189], v[196:197]
  v_pk_add_f32 v[194:195], v[194:195], v[190:191]
  v_pk_fma_f32 v[198:199], v[190:191], v[190:191], v[198:199]
  v_pk_add_f32 v[192:193], v[192:193], v[194:195]
  v_pk_add_f32 v[196:197], v[196:197], v[198:199]
  v_add_f32 v192, v192, v193
  v_add_f32 v196, v196, v197
  s_nop 0
  v_add_f32_dpp v192, v192, v192 quad_perm:[1,0,3,2] row_mask:0xf bank_mask:0xf
  v_add_f32_dpp v196, v196, v196 quad_perm:[1,0,3,2] row_mask:0xf bank_mask:0xf
  s_nop 0
  v_add_f32_dpp v192, v192, v192 quad_perm:[2,3,0,1] row_mask:0xf bank_mask:0xf
  v_add_f32_dpp v196, v196, v196 quad_perm:[2,3,0,1] row_mask:0xf bank_mask:0xf
  s_nop 0

  v_mul_f32 v200, 0x3b000000, v192
  v_cvt_pk_bf16_f32 v202, v200, v200
  v_and_b32 v202, 0xffff0000, v202

  v_pk_add_f32 v[0:1], v[0:1], v[202:203] op_sel_hi:[1,0] neg_lo:[0,1] neg_hi:[0,1]
  v_pk_add_f32 v[2:3], v[2:3], v[202:203] op_sel_hi:[1,0] neg_lo:[0,1] neg_hi:[0,1]
  v_pk_add_f32 v[4:5], v[4:5], v[202:203] op_sel_hi:[1,0] neg_lo:[0,1] neg_hi:[0,1]
  v_pk_add_f32 v[6:7], v[6:7], v[202:203] op_sel_hi:[1,0] neg_lo:[0,1] neg_hi:[0,1]
  v_mul_f32 v196, 0x3b000000, v196
  v_cvt_pk_bf16_f32 v64, v0, v1
  v_cvt_pk_bf16_f32 v65, v2, v3
  v_cvt_pk_bf16_f32 v66, v4, v5
  v_cvt_pk_bf16_f32 v67, v6, v7
  ds_write_b64 v215, v[64:65] offset:0
  ds_write_b64 v215, v[66:67] offset:256
  v_pk_add_f32 v[8:9], v[8:9], v[202:203] op_sel_hi:[1,0] neg_lo:[0,1] neg_hi:[0,1]
  v_pk_add_f32 v[10:11], v[10:11], v[202:203] op_sel_hi:[1,0] neg_lo:[0,1] neg_hi:[0,1]
  v_pk_add_f32 v[12:13], v[12:13], v[202:203] op_sel_hi:[1,0] neg_lo:[0,1] neg_hi:[0,1]
  v_pk_add_f32 v[14:15], v[14:15], v[202:203] op_sel_hi:[1,0] neg_lo:[0,1] neg_hi:[0,1]
  v_fma_f32 v196, -v200, v200, v196
  v_cvt_pk_bf16_f32 v68, v8, v9
  v_cvt_pk_bf16_f32 v69, v10, v11
  v_cvt_pk_bf16_f32 v70, v12, v13
  v_cvt_pk_bf16_f32 v71, v14, v15
  ds_write_b64 v215, v[68:69] offset:4096
  ds_write_b64 v215, v[70:71] offset:4352
  v_pk_add_f32 v[16:17], v[16:17], v[202:203] op_sel_hi:[1,0] neg_lo:[0,1] neg_hi:[0,1]
  v_pk_add_f32 v[18:19], v[18:19], v[202:203] op_sel_hi:[1,0] neg_lo:[0,1] neg_hi:[0,1]
  v_pk_add_f32 v[20:21], v[20:21], v[202:203] op_sel_hi:[1,0] neg_lo:[0,1] neg_hi:[0,1]
  v_pk_add_f32 v[22:23], v[22:23], v[202:203] op_sel_hi:[1,0] neg_lo:[0,1] neg_hi:[0,1]
  v_max_f32 v196, 0, v196
  v_cvt_pk_bf16_f32 v72, v16, v17
  v_cvt_pk_bf16_f32 v73, v18, v19
  v_cvt_pk_bf16_f32 v74, v20, v21
  v_cvt_pk_bf16_f32 v75, v22, v23
  ds_write_b64 v215, v[72:73] offset:8192
  ds_write_b64 v215, v[74:75] offset:8448
  v_pk_add_f32 v[24:25], v[24:25], v[202:203] op_sel_hi:[1,0] neg_lo:[0,1] neg_hi:[0,1]
  v_pk_add_f32 v[26:27], v[26:27], v[202:203] op_sel_hi:[1,0] neg_lo:[0,1] neg_hi:[0,1]
  v_pk_add_f32 v[28:29], v[28:29], v[202:203] op_sel_hi:[1,0] neg_lo:[0,1] neg_hi:[0,1]
  v_pk_add_f32 v[30:31], v[30:31], v[202:203] op_sel_hi:[1,0] neg_lo:[0,1] neg_hi:[0,1]
  v_cvt_pk_bf16_f32 v196, v196, v196
  v_cvt_pk_bf16_f32 v76, v24, v25
  v_cvt_pk_bf16_f32 v77, v26, v27
  v_cvt_pk_bf16_f32 v78, v28, v29
  v_cvt_pk_bf16_f32 v79, v30, v31
  ds_write_b64 v215, v[76:77] offset:12288
  ds_write_b64 v215, v[78:79] offset:12544
  s_add_u32 m0, s64, 65536
  s_add_u32 s13, s13, s14
  s_cmp_eq_u32 s13, s27
  s_cselect_b32 s13, 0, s13
  buffer_load_dwordx4 v236, s[40:43], s13 offen offset:0 lds
  v_pk_add_f32 v[32:33], v[32:33], v[202:203] op_sel_hi:[1,0] neg_lo:[0,1] neg_hi:[0,1]
  v_pk_add_f32 v[34:35], v[34:35], v[202:203] op_sel_hi:[1,0] neg_lo:[0,1] neg_hi:[0,1]
  v_pk_add_f32 v[36:37], v[36:37], v[202:203] op_sel_hi:[1,0] neg_lo:[0,1] neg_hi:[0,1]
  v_pk_add_f32 v[38:39], v[38:39], v[202:203] op_sel_hi:[1,0] neg_lo:[0,1] neg_hi:[0,1]
  v_and_b32 v196, 0xffff0000, v196
  v_cvt_pk_bf16_f32 v80, v32, v33
  v_cvt_pk_bf16_f32 v81, v34, v35
  v_cvt_pk_bf16_f32 v82, v36, v37
  v_cvt_pk_bf16_f32 v83, v38, v39
  ds_write_b64 v215, v[80:81] offset:16384
  ds_write_b64 v215, v[82:83] offset:16640
  buffer_load_dwordx4 v237, s[40:43], s13 offen offset:1024 lds
  v_pk_add_f32 v[40:41], v[40:41], v[202:203] op_sel_hi:[1,0] neg_lo:[0,1] neg_hi:[0,1]
  v_pk_add_f32 v[42:43], v[42:43], v[202:203] op_sel_hi:[1,0] neg_lo:[0,1] neg_hi:[0,1]
  v_pk_add_f32 v[44:45], v[44:45], v[202:203] op_sel_hi:[1,0] neg_lo:[0,1] neg_hi:[0,1]
  v_pk_add_f32 v[46:47], v[46:47], v[202:203] op_sel_hi:[1,0] neg_lo:[0,1] neg_hi:[0,1]
  v_add_f32 v196, 0x3727c5ac, v196
  v_cvt_pk_bf16_f32 v84, v40, v41
  v_cvt_pk_bf16_f32 v85, v42, v43
  v_cvt_pk_bf16_f32 v86, v44, v45
  v_cvt_pk_bf16_f32 v87, v46, v47
  ds_write_b64 v215, v[84:85] offset:20480
  ds_write_b64 v215, v[86:87] offset:20736
  buffer_load_dwordx4 v238, s[40:43], s13 offen offset:2048 lds
  v_pk_add_f32 v[48:49], v[48:49], v[202:203] op_sel_hi:[1,0] neg_lo:[0,1] neg_hi:[0,1]
  v_pk_add_f32 v[50:51], v[50:51], v[202:203] op_sel_hi:[1,0] neg_lo:[0,1] neg_hi:[0,1]
  v_pk_add_f32 v[52:53], v[52:53], v[202:203] op_sel_hi:[1,0] neg_lo:[0,1] neg_hi:[0,1]
  v_pk_add_f32 v[54:55], v[54:55], v[202:203] op_sel_hi:[1,0] neg_lo:[0,1] neg_hi:[0,1]
  v_cvt_pk_bf16_f32 v196, v196, v196
  v_cvt_pk_bf16_f32 v88, v48, v49
  v_cvt_pk_bf16_f32 v89, v50, v51
  v_cvt_pk_bf16_f32 v90, v52, v53
  v_cvt_pk_bf16_f32 v91, v54, v55
  ds_write_b64 v215, v[88:89] offset:24576
  ds_write_b64 v215, v[90:91] offset:24832
  buffer_load_dwordx4 v239, s[40:43], s13 offen offset:3072 lds
  v_pk_add_f32 v[56:57], v[56:57], v[202:203] op_sel_hi:[1,0] neg_lo:[0,1] neg_hi:[0,1]
  v_pk_add_f32 v[58:59], v[58:59], v[202:203] op_sel_hi:[1,0] neg_lo:[0,1] neg_hi:[0,1]
  v_pk_add_f32 v[60:61], v[60:61], v[202:203] op_sel_hi:[1,0] neg_lo:[0,1] neg_hi:[0,1]
  v_pk_add_f32 v[62:63], v[62:63], v[202:203] op_sel_hi:[1,0] neg_lo:[0,1] neg_hi:[0,1]
  v_and_b32 v196, 0xffff0000, v196
  v_cvt_pk_bf16_f32 v92, v56, v57
  v_cvt_pk_bf16_f32 v93, v58, v59
  v_cvt_pk_bf16_f32 v94, v60, v61
  v_cvt_pk_bf16_f32 v95, v62, v63
  ds_write_b64 v215, v[92:93] offset:28672
  ds_write_b64 v215, v[94:95] offset:28928
  s_add_u32 m0, s64, 81920
  s_add_u32 s13, s13, s14
  s_cmp_eq_u32 s13, s27
  s_cselect_b32 s13, 0, s13
  buffer_load_dwordx4 v236, s[40:43], s13 offen offset:0 lds
  v_pk_add_f32 v[128:129], v[128:129], v[202:203] op_sel_hi:[1,0] neg_lo:[0,1] neg_hi:[0,1]
  v_pk_add_f32 v[130:131], v[130:131], v[202:203] op_sel_hi:[1,0] neg_lo:[0,1] neg_hi:[0,1]
  v_pk_add_f32 v[132:133], v[132:133], v[202:203] op_sel_hi:[1,0] neg_lo:[0,1] neg_hi:[0,1]
  v_pk_add_f32 v[134:135], v[134:135], v[202:203] op_sel_hi:[1,0] neg_lo:[0,1] neg_hi:[0,1]
  v_sqrt_f32 v196, v196
  v_cvt_pk_bf16_f32 v96, v128, v129
  v_cvt_pk_bf16_f32 v97, v130, v131
  v_cvt_pk_bf16_f32 v98, v132, v133
  v_cvt_pk_bf16_f32 v99, v134, v135
  ds_write_b64 v215, v[96:97] offset:32768
  ds_write_b64 v215, v[98:99] offset:33024
  buffer_load_dwordx4 v237, s[40:43], s13 offen offset:1024 lds
  v_pk_add_f32 v[136:137], v[136:137], v[202:203] op_sel_hi:[1,0] neg_lo:[0,1] neg_hi:[0,1]
  v_pk_add_f32 v[138:139], v[138:139], v[202:203] op_sel_hi:[1,0] neg_lo:[0,1] neg_hi:[0,1]
  v_pk_add_f32 v[140:141], v[140:141], v[202:203] op_sel_hi:[1,0] neg_lo:[0,1] neg_hi:[0,1]
  v_pk_add_f32 v[142:143], v[142:143], v[202:203] op_sel_hi:[1,0] neg_lo:[0,1] neg_hi:[0,1]
  v_cvt_pk_bf16_f32 v196, v196, v196
  v_cvt_pk_bf16_f32 v100, v136, v137
  v_cvt_pk_bf16_f32 v101, v138, v139
  v_cvt_pk_bf16_f32 v102, v140, v141
  v_cvt_pk_bf16_f32 v103, v142, v143
  ds_write_b64 v215, v[100:101] offset:36864
  ds_write_b64 v215, v[102:103] offset:37120
  buffer_load_dwordx4 v238, s[40:43], s13 offen offset:2048 lds
  v_pk_add_f32 v[144:145], v[144:145], v[202:203] op_sel_hi:[1,0] neg_lo:[0,1] neg_hi:[0,1]
  v_pk_add_f32 v[146:147], v[146:147], v[202:203] op_sel_hi:[1,0] neg_lo:[0,1] neg_hi:[0,1]
  v_pk_add_f32 v[148:149], v[148:149], v[202:203] op_sel_hi:[1,0] neg_lo:[0,1] neg_hi:[0,1]
  v_pk_add_f32 v[150:151], v[150:151], v[202:203] op_sel_hi:[1,0] neg_lo:[0,1] neg_hi:[0,1]
  v_and_b32 v196, 0xffff0000, v196
  v_cvt_pk_bf16_f32 v104, v144, v145
  v_cvt_pk_bf16_f32 v105, v146, v147
  v_cvt_pk_bf16_f32 v106, v148, v149
  v_cvt_pk_bf16_f32 v107, v150, v151
  ds_write_b64 v215, v[104:105] offset:40960
  ds_write_b64 v215, v[106:107] offset:41216
  buffer_load_dwordx4 v239, s[40:43], s13 offen offset:3072 lds
  v_pk_add_f32 v[152:153], v[152:153], v[202:203] op_sel_hi:[1,0] neg_lo:[0,1] neg_hi:[0,1]
  v_pk_add_f32 v[154:155], v[154:155], v[202:203] op_sel_hi:[1,0] neg_lo:[0,1] neg_hi:[0,1]
  v_pk_add_f32 v[156:157], v[156:157], v[202:203] op_sel_hi:[1,0] neg_lo:[0,1] neg_hi:[0,1]
  v_pk_add_f32 v[158:159], v[158:159], v[202:203] op_sel_hi:[1,0] neg_lo:[0,1] neg_hi:[0,1]
  v_rcp_f32 v196, v196
  v_cvt_pk_bf16_f32 v108, v152, v153
  v_cvt_pk_bf16_f32 v109, v154, v155
  v_cvt_pk_bf16_f32 v110, v156, v157
  v_cvt_pk_bf16_f32 v111, v158, v159
  ds_write_b64 v215, v[108:109] offset:45056
  ds_write_b64 v215, v[110:111] offset:45312
  s_add_u32 m0, s64, 0
  s_add_u32 s13, s13, s14
  s_cmp_eq_u32 s13, s27
  s_cselect_b32 s13, 0, s13
  buffer_load_dwordx4 v236, s[40:43], s13 offen offset:0 lds
  v_pk_add_f32 v[160:161], v[160:161], v[202:203] op_sel_hi:[1,0] neg_lo:[0,1] neg_hi:[0,1]
  v_pk_add_f32 v[162:163], v[162:163], v[202:203] op_sel_hi:[1,0] neg_lo:[0,1] neg_hi:[0,1]
  v_pk_add_f32 v[164:165], v[164:165], v[202:203] op_sel_hi:[1,0] neg_lo:[0,1] neg_hi:[0,1]
  v_pk_add_f32 v[166:167], v[166:167], v[202:203] op_sel_hi:[1,0] neg_lo:[0,1] neg_hi:[0,1]
  ds_write_b32 v210, v196
  v_cvt_pk_bf16_f32 v112, v160, v161
  v_cvt_pk_bf16_f32 v113, v162, v163
  v_cvt_pk_bf16_f32 v114, v164, v165
  v_cvt_pk_bf16_f32 v115, v166, v167
  ds_write_b64 v215, v[112:113] offset:49152
  ds_write_b64 v215, v[114:115] offset:49408
  buffer_load_dwordx4 v237, s[40:43], s13 offen offset:1024 lds
  v_pk_add_f32 v[168:169], v[168:169], v[202:203] op_sel_hi:[1,0] neg_lo:[0,1] neg_hi:[0,1]
  v_pk_add_f32 v[170:171], v[170:171], v[202:203] op_sel_hi:[1,0] neg_lo:[0,1] neg_hi:[0,1]
  v_pk_add_f32 v[172:173], v[172:173], v[202:203] op_sel_hi:[1,0] neg_lo:[0,1] neg_hi:[0,1]
  v_pk_add_f32 v[174:175], v[174:175], v[202:203] op_sel_hi:[1,0] neg_lo:[0,1] neg_hi:[0,1]
  v_cvt_pk_bf16_f32 v116, v168, v169
  v_cvt_pk_bf16_f32 v117, v170, v171
  v_cvt_pk_bf16_f32 v118, v172, v173
  v_cvt_pk_bf16_f32 v119, v174, v175
  ds_write_b64 v215, v[116:117] offset:53248
  ds_write_b64 v215, v[118:119] offset:53504
  buffer_load_dwordx4 v238, s[40:43], s13 offen offset:2048 lds
  v_pk_add_f32 v[176:177], v[176:177], v[202:203] op_sel_hi:[1,0] neg_lo:[0,1] neg_hi:[0,1]
  v_pk_add_f32 v[178:179], v[178:179], v[202:203] op_sel_hi:[1,0] neg_lo:[0,1] neg_hi:[0,1]
  v_pk_add_f32 v[180:181], v[180:181], v[202:203] op_sel_hi:[1,0] neg_lo:[0,1] neg_hi:[0,1]
  v_pk_add_f32 v[182:183], v[182:183], v[202:203] op_sel_hi:[1,0] neg_lo:[0,1] neg_hi:[0,1]
  v_cvt_pk_bf16_f32 v120, v176, v177
  v_cvt_pk_bf16_f32 v121, v178, v179
  v_cvt_pk_bf16_f32 v122, v180, v181
  v_cvt_pk_bf16_f32 v123, v182, v183
  ds_write_b64 v215, v[120:121] offset:57344
  ds_write_b64 v215, v[122:123] offset:57600
  buffer_load_dwordx4 v239, s[40:43], s13 offen offset:3072 lds
  v_pk_add_f32 v[184:185], v[184:185], v[202:203] op_sel_hi:[1,0] neg_lo:[0,1] neg_hi:[0,1]
  v_pk_add_f32 v[186:187], v[186:187], v[202:203] op_sel_hi:[1,0] neg_lo:[0,1] neg_hi:[0,1]
  v_pk_add_f32 v[188:189], v[188:189], v[202:203] op_sel_hi:[1,0] neg_lo:[0,1] neg_hi:[0,1]
  v_pk_add_f32 v[190:191], v[190:191], v[202:203] op_sel_hi:[1,0] neg_lo:[0,1] neg_hi:[0,1]
  v_cvt_pk_bf16_f32 v124, v184, v185
  v_cvt_pk_bf16_f32 v125, v186, v187
  v_cvt_pk_bf16_f32 v126, v188, v189
  v_cvt_pk_bf16_f32 v127, v190, v191
  ds_write_b64 v215, v[124:125] offset:61440
  ds_write_b64 v215, v[126:127] offset:61696
  s_branch L_gst
L_gst_ret:
  s_waitcnt vmcnt(12) lgkmcnt(0)
  ds_read_b64_tr_b16 v[64:65], v240 offset:32768
  ds_read_b64_tr_b16 v[66:67], v240 offset:34816
  ds_read_b64_tr_b16 v[68:69], v241 offset:32768
  ds_read_b64_tr_b16 v[70:71], v241 offset:34816
  ds_read_b64_tr_b16 v[72:73], v242 offset:32768
  ds_read_b64_tr_b16 v[74:75], v242 offset:34816
  ds_read_b64_tr_b16 v[76:77], v243 offset:32768
  ds_read_b64_tr_b16 v[78:79], v243 offset:34816
  ds_read_b64_tr_b16 v[80:81], v244 offset:0
  ds_read_b64_tr_b16 v[82:83], v244 offset:2048
  ds_read_b64_tr_b16 v[84:85], v245 offset:0
  ds_read_b64_tr_b16 v[86:87], v245 offset:2048
  ds_read_b64_tr_b16 v[88:89], v246 offset:0
  ds_read_b64_tr_b16 v[90:91], v246 offset:2048
  ds_read_b64_tr_b16 v[92:93], v247 offset:0
  ds_read_b64_tr_b16 v[94:95], v247 offset:2048
  s_barrier
  ds_read_b32 v160, v235 offset:0
  ds_read_b32 v161, v235 offset:64
  ds_read_b32 v162, v235 offset:128
  ds_read_b32 v163, v235 offset:192
  s_lshl_b32 s70, s4, 6
  v_add_u32 v235, s70, v235
  ds_read_b32 v235, v235
  s_lshl_b32 s3, s100, 12
  s_mov_b32 s7, 65536
  v_add_u32 v210, s3, v213
  ds_read_b128 v[96:99], v210 offset:0
  ds_read_b128 v[100:103], v210 offset:1024
  ds_read_b128 v[104:107], v210 offset:2048
  ds_read_b128 v[108:111], v210 offset:3072
  s_add_u32 s3, s3, 4096
  s_cmp_eq_u32 s3, s7
  s_cselect_b32 s3, 0, s3
  v_add_u32 v210, s3, v213
  ds_read_b128 v[112:115], v210 offset:0
  ds_read_b128 v[116:119], v210 offset:1024
  ds_read_b128 v[120:123], v210 offset:2048
  ds_read_b128 v[124:127], v210 offset:3072
  s_add_u32 s3, s3, 4096
  s_cmp_eq_u32 s3, s7
  s_cselect_b32 s3, 0, s3
  v_add_u32 v210, s3, v213
  s_waitcnt lgkmcnt(8)
  s_add_u32 m0, s64, 16384
  s_add_u32 s13, s13, s14
  s_cmp_eq_u32 s13, s27
  s_cselect_b32 s13, 0, s13
  buffer_load_dwordx4 v236, s[40:43], s13 offen offset:0 lds
  buffer_load_dwordx4 v237, s[40:43], s13 offen offset:1024 lds
  buffer_load_dwordx4 v238, s[40:43], s13 offen offset:2048 lds
  buffer_load_dwordx4 v239, s[40:43], s13 offen offset:3072 lds
  s_add_u32 m0, s64, 32768
  s_add_u32 s13, s13, s14
  s_cmp_eq_u32 s13, s27
  s_cselect_b32 s13, 0, s13
  buffer_load_dwordx4 v236, s[40:43], s13 offen offset:0 lds
  buffer_load_dwordx4 v237, s[40:43], s13 offen offset:1024 lds
  buffer_load_dwordx4 v238, s[40:43], s13 offen offset:2048 lds
  buffer_load_dwordx4 v239, s[40:43], s13 offen offset:3072 lds
  s_mov_b32 s70, 0x3e0293ee
  v_mul_f32 v160, s70, v160
  v_mul_f32 v161, s70, v161
  v_mul_f32 v162, s70, v162
  v_mul_f32 v163, s70, v163
  s_cmp_lg_u32 s42, 0
  s_cbranch_scc0 L_w3
  s_waitcnt vmcnt(16) lgkmcnt(0)
  v_mfma_f32_16x16x32_bf16 v[0:3], v[64:67], v[96:99], 0
  ds_read_b128 a[224:227], v210 offset:0
  s_add_u32 s3, s3, 4096
  v_mfma_f32_16x16x32_bf16 v[0:3], v[80:83], v[112:115], v[0:3]
  ds_read_b128 a[228:231], v210 offset:1024
  s_cmp_eq_u32 s3, s7
  v_mfma_f32_16x16x32_bf16 v[4:7], v[80:83], v[116:119], 0
  ds_read_b128 a[232:235], v210 offset:2048
  s_cselect_b32 s3, 0, s3
  v_mfma_f32_16x16x32_bf16 v[4:7], v[64:67], v[100:103], v[4:7]
  ds_read_b128 a[236:239], v210 offset:3072
  v_add_u32 v210, s3, v213
  v_mfma_f32_16x16x32_bf16 v[8:11], v[64:67], v[104:107], 0
  ds_read_b64_tr_b16 a[192:193], v244 offset:16384
  s_add_u32 s13, s13, s14
  v_mfma_f32_16x16x32_bf16 v[8:11], v[80:83], v[120:123], v[8:11]
  ds_read_b64_tr_b16 a[194:195], v244 offset:18432
  s_cmp_eq_u32 s13, s27
  v_mfma_f32_16x16x32_bf16 v[12:15], v[80:83], v[124:127], 0
  ds_read_b64_tr_b16 a[196:197], v245 offset:16384
  s_cselect_b32 s13, 0, s13
  v_mfma_f32_16x16x32_bf16 v[12:15], v[64:67], v[108:111], v[12:15]
  ds_read_b64_tr_b16 a[198:199], v245 offset:18432
  s_add_u32 m0, s64, 49152
  v_mfma_f32_16x16x32_bf16 v[28:31], v[68:71], v[108:111], 0
  ds_read_b64_tr_b16 a[200:201], v246 offset:16384
  v_mfma_f32_16x16x32_bf16 v[28:31], v[84:87], v[124:127], v[28:31]
  ds_read_b64_tr_b16 a[202:203], v246 offset:18432
  v_mfma_f32_16x16x32_bf16 v[24:27], v[84:87], v[120:123], 0
  ds_read_b64_tr_b16 a[204:205], v247 offset:16384
  v_mfma_f32_16x16x32_bf16 v[24:27], v[68:71], v[104:107], v[24:27]
  ds_read_b64_tr_b16 a[206:207], v247 offset:18432
  v_mfma_f32_16x16x32_bf16 v[20:23], v[68:71], v[100:103], 0
  buffer_load_dwordx4 v236, s[40:43], s13 offen offset:0 lds
  v_mfma_f32_16x16x32_bf16 v[20:23], v[84:87], v[116:119], v[20:23]
  buffer_load_dwordx4 v237, s[40:43], s13 offen offset:1024 lds
  v_mfma_f32_16x16x32_bf16 v[16:19], v[84:87], v[112:115], 0
  buffer_load_dwordx4 v238, s[40:43], s13 offen offset:2048 lds
  v_mfma_f32_16x16x32_bf16 v[16:19], v[68:71], v[96:99], v[16:19]
  buffer_load_dwordx4 v239, s[40:43], s13 offen offset:3072 lds
  s_waitcnt vmcnt(16) lgkmcnt(0)
  v_mfma_f32_16x16x32_bf16 v[32:35], v[72:75], v[96:99], 0
  ds_read_b128 a[240:243], v210 offset:0
  s_add_u32 s3, s3, 4096
  v_mfma_f32_16x16x32_bf16 v[32:35], v[88:91], v[112:115], v[32:35]
  ds_read_b128 a[244:247], v210 offset:1024
  s_cmp_eq_u32 s3, s7
  v_mfma_f32_16x16x32_bf16 v[36:39], v[88:91], v[116:119], 0
  ds_read_b128 a[248:251], v210 offset:2048
  s_cselect_b32 s3, 0, s3
  v_mfma_f32_16x16x32_bf16 v[36:39], v[72:75], v[100:103], v[36:39]
  ds_read_b128 a[252:255], v210 offset:3072
  v_add_u32 v210, s3, v213
  v_mfma_f32_16x16x32_bf16 v[40:43], v[72:75], v[104:107], 0
  ds_read_b64_tr_b16 a[208:209], v244 offset:32768
  s_add_u32 s13, s13, s14
  v_mfma_f32_16x16x32_bf16 v[40:43], v[88:91], v[120:123], v[40:43]
  ds_read_b64_tr_b16 a[210:211], v244 offset:34816
  s_cmp_eq_u32 s13, s27
  v_mfma_f32_16x16x32_bf16 v[44:47], v[88:91], v[124:127], 0
  ds_read_b64_tr_b16 a[212:213], v245 offset:32768
  s_cselect_b32 s13, 0, s13
  v_mfma_f32_16x16x32_bf16 v[44:47], v[72:75], v[108:111], v[44:47]
  ds_read_b64_tr_b16 a[214:215], v245 offset:34816
  s_add_u32 m0, s64, 65536
  v_mfma_f32_16x16x32_bf16 v[60:63], v[76:79], v[108:111], 0
  ds_read_b64_tr_b16 a[216:217], v246 offset:32768
  v_mfma_f32_16x16x32_bf16 v[60:63], v[92:95], v[124:127], v[60:63]
  ds_read_b64_tr_b16 a[218:219], v246 offset:34816
  v_mfma_f32_16x16x32_bf16 v[56:59], v[92:95], v[120:123], 0
  ds_read_b64_tr_b16 a[220:221], v247 offset:32768
  v_mfma_f32_16x16x32_bf16 v[56:59], v[76:79], v[104:107], v[56:59]
  ds_read_b64_tr_b16 a[222:223], v247 offset:34816
  v_mfma_f32_16x16x32_bf16 v[52:55], v[76:79], v[100:103], 0
  buffer_load_dwordx4 v236, s[40:43], s13 offen offset:0 lds
  v_mfma_f32_16x16x32_bf16 v[52:55], v[92:95], v[116:119], v[52:55]
  buffer_load_dwordx4 v237, s[40:43], s13 offen offset:1024 lds
  v_mfma_f32_16x16x32_bf16 v[48:51], v[92:95], v[112:115], 0
  buffer_load_dwordx4 v238, s[40:43], s13 offen offset:2048 lds
  v_mfma_f32_16x16x32_bf16 v[48:51], v[76:79], v[96:99], v[48:51]
  buffer_load_dwordx4 v239, s[40:43], s13 offen offset:3072 lds
  s_mov_b32 s10, 3
  s_call_b64 s[8:9], L_gemm2
  s_mov_b32 s40, s22
  s_mov_b32 s41, s23
  s_mov_b32 s42, 4194304
  s_mov_b32 s70, 8192
  v_mad_u32_u24 v236, v208, s70, v209
  s_lshl_b32 s70, s5, 10
  s_lshl_b32 s71, s4, 8
  s_add_u32 s70, s70, s71
  s_add_u32 s70, s70, s67
  v_add_u32 v236, s70, v236
  v_add_u32 v237, 64512, v236
  v_add_u32 v238, 129024, v236
  v_add_u32 v239, 193536, v236
  s_mov_b32 s14, 262144
  s_mov_b32 s27, 4194304
  s_mul_i32 s13, s100, 262144
  s_sub_u32 s13, s13, s14
  s_mov_b32 s10, 3
  s_call_b64 s[8:9], L_gemm9
  s_nop 7
.p2align 3
  v_cvt_pk_bf16_f32 v176, v0, v1
  v_cvt_pk_bf16_f32 v177, v2, v3
  v_cvt_pk_bf16_f32 v178, v16, v17
  v_cvt_pk_bf16_f32 v179, v18, v19
  v_pk_max_i16 v176, v176, 0
  v_pk_max_i16 v177, v177, 0
  v_pk_max_i16 v178, v178, 0
  v_pk_max_i16 v179, v179, 0
  v_cvt_pk_bf16_f32 v180, v4, v5
  v_cvt_pk_bf16_f32 v181, v6, v7
  v_cvt_pk_bf16_f32 v182, v20, v21
  v_cvt_pk_bf16_f32 v183, v22, v23
  v_pk_max_i16 v180, v180, 0
  v_pk_max_i16 v181, v181, 0
  v_pk_max_i16 v182, v182, 0
  v_pk_max_i16 v183, v183, 0
  v_cvt_pk_bf16_f32 v184, v8, v9
  v_cvt_pk_bf16_f32 v185, v10, v11
  v_cvt_pk_bf16_f32 v186, v24, v25
  v_cvt_pk_bf16_f32 v187, v26, v27
  v_pk_max_i16 v184, v184, 0
  v_pk_max_i16 v185, v185, 0
  v_pk_max_i16 v186, v186, 0
  v_pk_max_i16 v187, v187, 0
  v_cvt_pk_bf16_f32 v188, v12, v13
  v_cvt_pk_bf16_f32 v189, v14, v15
  v_cvt_pk_bf16_f32 v190, v28, v29
  v_cvt_pk_bf16_f32 v191, v30, v31
  v_pk_max_i16 v188, v188, 0
  v_pk_max_i16 v189, v189, 0
  v_pk_max_i16 v190, v190, 0
  v_pk_max_i16 v191, v191, 0
  v_cvt_pk_bf16_f32 v192, v32, v33
  v_cvt_pk_bf16_f32 v193, v34, v35
  v_cvt_pk_bf16_f32 v194, v48, v49
  v_cvt_pk_bf16_f32 v195, v50, v51
  v_pk_max_i16 v192, v192, 0
  v_pk_max_i16 v193, v193, 0
  v_pk_max_i16 v194, v194, 0
  v_pk_max_i16 v195, v195, 0
  v_cvt_pk_bf16_f32 v196, v36, v37
  v_cvt_pk_bf16_f32 v197, v38, v39
  v_cvt_pk_bf16_f32 v198, v52, v53
  v_cvt_pk_bf16_f32 v199, v54, v55
  v_pk_max_i16 v196, v196, 0
  v_pk_max_i16 v197, v197, 0
  v_pk_max_i16 v198, v198, 0
  v_pk_max_i16 v199, v199, 0
  v_cvt_pk_bf16_f32 v200, v40, v41
  v_cvt_pk_bf16_f32 v201, v42, v43
  v_cvt_pk_bf16_f32 v202, v56, v57
  v_cvt_pk_bf16_f32 v203, v58, v59
  v_pk_max_i16 v200, v200, 0
  v_pk_max_i16 v201, v201, 0
  v_pk_max_i16 v202, v202, 0
  v_pk_max_i16 v203, v203, 0
  v_cvt_pk_bf16_f32 v204, v44, v45
  v_cvt_pk_bf16_f32 v205, v46, v47
  v_cvt_pk_bf16_f32 v206, v60, v61
  v_cvt_pk_bf16_f32 v207, v62, v63
  v_pk_max_i16 v204, v204, 0
  v_pk_max_i16 v205, v205, 0
  v_pk_max_i16 v206, v206, 0
  v_pk_max_i16 v207, v207, 0
L_qstart:
  s_waitcnt vmcnt(16) lgkmcnt(0)
  v_mfma_f32_16x16x32_bf16 v[0:3], v[64:67], v[96:99], 0
  ds_read_b128 a[224:227], v210 offset:0
  s_add_u32 s3, s3, 4096
  v_mfma_f32_16x16x32_bf16 v[0:3], v[80:83], v[112:115], v[0:3]
  ds_read_b128 a[228:231], v210 offset:1024
  s_cmp_eq_u32 s3, s7
  v_mfma_f32_16x16x32_bf16 v[4:7], v[80:83], v[116:119], 0
  ds_read_b128 a[232:235], v210 offset:2048
  s_cselect_b32 s3, 0, s3
  v_mfma_f32_16x16x32_bf16 v[4:7], v[64:67], v[100:103], v[4:7]
  ds_read_b128 a[236:239], v210 offset:3072
  v_add_u32 v210, s3, v213
  v_mfma_f32_16x16x32_bf16 v[8:11], v[64:67], v[104:107], 0
  ds_read_b64_tr_b16 a[192:193], v240 offset:32768
  s_add_u32 s13, s13, s14
  v_mfma_f32_16x16x32_bf16 v[8:11], v[80:83], v[120:123], v[8:11]
  ds_read_b64_tr_b16 a[194:195], v240 offset:34816
  s_cmp_eq_u32 s13, s27
  v_mfma_f32_16x16x32_bf16 v[12:15], v[80:83], v[124:127], 0
  ds_read_b64_tr_b16 a[196:197], v241 offset:32768
  s_cselect_b32 s13, 0, s13
  v_mfma_f32_16x16x32_bf16 v[12:15], v[64:67], v[108:111], v[12:15]
  ds_read_b64_tr_b16 a[198:199], v241 offset:34816
  s_add_u32 m0, s64, 16384
  v_mfma_f32_16x16x32_bf16 v[28:31], v[68:71], v[108:111], 0
  ds_read_b64_tr_b16 a[200:201], v242 offset:32768
  v_mfma_f32_16x16x32_bf16 v[28:31], v[84:87], v[124:127], v[28:31]
  ds_read_b64_tr_b16 a[202:203], v242 offset:34816
  v_mfma_f32_16x16x32_bf16 v[24:27], v[84:87], v[120:123], 0
  ds_read_b64_tr_b16 a[204:205], v243 offset:32768
  v_mfma_f32_16x16x32_bf16 v[24:27], v[68:71], v[104:107], v[24:27]
  ds_read_b64_tr_b16 a[206:207], v243 offset:34816
  v_mfma_f32_16x16x32_bf16 v[20:23], v[68:71], v[100:103], 0
  buffer_load_dwordx4 v236, s[40:43], s13 offen offset:0 lds
  v_mfma_f32_16x16x32_bf16 v[20:23], v[84:87], v[116:119], v[20:23]
  buffer_load_dwordx4 v237, s[40:43], s13 offen offset:1024 lds
  v_mfma_f32_16x16x32_bf16 v[16:19], v[84:87], v[112:115], 0
  buffer_load_dwordx4 v238, s[40:43], s13 offen offset:2048 lds
  v_mfma_f32_16x16x32_bf16 v[16:19], v[68:71], v[96:99], v[16:19]
  buffer_load_dwordx4 v239, s[40:43], s13 offen offset:3072 lds
  s_waitcnt vmcnt(16) lgkmcnt(0)
  v_mfma_f32_16x16x32_bf16 v[32:35], v[72:75], v[96:99], 0
  ds_read_b128 a[240:243], v210 offset:0
  s_add_u32 s3, s3, 4096
  v_mfma_f32_16x16x32_bf16 v[32:35], v[88:91], v[112:115], v[32:35]
  ds_read_b128 a[244:247], v210 offset:1024
  s_cmp_eq_u32 s3, s7
  v_mfma_f32_16x16x32_bf16 v[36:39], v[88:91], v[116:119], 0
  ds_read_b128 a[248:251], v210 offset:2048
  s_cselect_b32 s3, 0, s3
  v_mfma_f32_16x16x32_bf16 v[36:39], v[72:75], v[100:103], v[36:39]
  ds_read_b128 a[252:255], v210 offset:3072
  v_add_u32 v210, s3, v213
  v_mfma_f32_16x16x32_bf16 v[40:43], v[72:75], v[104:107], 0
  ds_read_b64_tr_b16 a[208:209], v244 offset:0
  s_add_u32 s13, s13, s14
  v_mfma_f32_16x16x32_bf16 v[40:43], v[88:91], v[120:123], v[40:43]
  ds_read_b64_tr_b16 a[210:211], v244 offset:2048
  s_cmp_eq_u32 s13, s27
  v_mfma_f32_16x16x32_bf16 v[44:47], v[88:91], v[124:127], 0
  ds_read_b64_tr_b16 a[212:213], v245 offset:0
  s_cselect_b32 s13, 0, s13
  v_mfma_f32_16x16x32_bf16 v[44:47], v[72:75], v[108:111], v[44:47]
  ds_read_b64_tr_b16 a[214:215], v245 offset:2048
  s_add_u32 m0, s64, 32768
  v_mfma_f32_16x16x32_bf16 v[60:63], v[76:79], v[108:111], 0
  ds_read_b64_tr_b16 a[216:217], v246 offset:0
  v_mfma_f32_16x16x32_bf16 v[60:63], v[92:95], v[124:127], v[60:63]
  ds_read_b64_tr_b16 a[218:219], v246 offset:2048
  v_mfma_f32_16x16x32_bf16 v[56:59], v[92:95], v[120:123], 0
  ds_read_b64_tr_b16 a[220:221], v247 offset:0
  v_mfma_f32_16x16x32_bf16 v[56:59], v[76:79], v[104:107], v[56:59]
  ds_read_b64_tr_b16 a[222:223], v247 offset:2048
  v_mfma_f32_16x16x32_bf16 v[52:55], v[76:79], v[100:103], 0
  buffer_load_dwordx4 v236, s[40:43], s13 offen offset:0 lds
  v_mfma_f32_16x16x32_bf16 v[52:55], v[92:95], v[116:119], v[52:55]
  buffer_load_dwordx4 v237, s[40:43], s13 offen offset:1024 lds
  v_mfma_f32_16x16x32_bf16 v[48:51], v[92:95], v[112:115], 0
  buffer_load_dwordx4 v238, s[40:43], s13 offen offset:2048 lds
  v_mfma_f32_16x16x32_bf16 v[48:51], v[76:79], v[96:99], v[48:51]
  buffer_load_dwordx4 v239, s[40:43], s13 offen offset:3072 lds
  s_mov_b32 s10, 4
  s_call_b64 s[8:9], L_gemm6
  v_xor_b32 v236, 128, v236
  v_xor_b32 v237, 128, v237
  v_xor_b32 v238, 128, v238
  v_xor_b32 v239, 128, v239
  s_mov_b32 s10, 2
  s_call_b64 s[8:9], L_gemm1
  s_nop 7
.p2align 3
  v_pk_mul_f32 v[0:1], v[0:1], v[160:161] op_sel_hi:[1,0]
  v_pk_mul_f32 v[2:3], v[2:3], v[160:161] op_sel_hi:[1,0]
  v_pk_mul_f32 v[16:17], v[16:17], v[160:161] op_sel_hi:[1,0]
  v_pk_mul_f32 v[18:19], v[18:19], v[160:161] op_sel_hi:[1,0]
  v_cvt_pk_bf16_f32 v128, v0, v1
  v_cvt_pk_bf16_f32 v129, v2, v3
  v_cvt_pk_bf16_f32 v130, v16, v17
  v_cvt_pk_bf16_f32 v131, v18, v19
  v_pk_mul_f32 v[4:5], v[4:5], v[160:161] op_sel:[0,1] op_sel_hi:[1,1]
  v_pk_mul_f32 v[6:7], v[6:7], v[160:161] op_sel:[0,1] op_sel_hi:[1,1]
  v_pk_mul_f32 v[20:21], v[20:21], v[160:161] op_sel:[0,1] op_sel_hi:[1,1]
  v_pk_mul_f32 v[22:23], v[22:23], v[160:161] op_sel:[0,1] op_sel_hi:[1,1]
  v_cvt_pk_bf16_f32 v132, v4, v5
  v_cvt_pk_bf16_f32 v133, v6, v7
  v_cvt_pk_bf16_f32 v134, v20, v21
  v_cvt_pk_bf16_f32 v135, v22, v23
  v_pk_mul_f32 v[8:9], v[8:9], v[162:163] op_sel_hi:[1,0]
  v_pk_mul_f32 v[10:11], v[10:11], v[162:163] op_sel_hi:[1,0]
  v_pk_mul_f32 v[24:25], v[24:25], v[162:163] op_sel_hi:[1,0]
  v_pk_mul_f32 v[26:27], v[26:27], v[162:163] op_sel_hi:[1,0]
  v_cvt_pk_bf16_f32 v136, v8, v9
  v_cvt_pk_bf16_f32 v137, v10, v11
  v_cvt_pk_bf16_f32 v138, v24, v25
  v_cvt_pk_bf16_f32 v139, v26, v27
  v_pk_mul_f32 v[12:13], v[12:13], v[162:163] op_sel:[0,1] op_sel_hi:[1,1]
  v_pk_mul_f32 v[14:15], v[14:15], v[162:163] op_sel:[0,1] op_sel_hi:[1,1]
  v_pk_mul_f32 v[28:29], v[28:29], v[162:163] op_sel:[0,1] op_sel_hi:[1,1]
  v_pk_mul_f32 v[30:31], v[30:31], v[162:163] op_sel:[0,1] op_sel_hi:[1,1]
  v_cvt_pk_bf16_f32 v140, v12, v13
  v_cvt_pk_bf16_f32 v141, v14, v15
  v_cvt_pk_bf16_f32 v142, v28, v29
  v_cvt_pk_bf16_f32 v143, v30, v31
  v_pk_mul_f32 v[32:33], v[32:33], v[160:161] op_sel_hi:[1,0]
  v_pk_mul_f32 v[34:35], v[34:35], v[160:161] op_sel_hi:[1,0]
  v_pk_mul_f32 v[48:49], v[48:49], v[160:161] op_sel_hi:[1,0]
  v_pk_mul_f32 v[50:51], v[50:51], v[160:161] op_sel_hi:[1,0]
  v_cvt_pk_bf16_f32 v144, v32, v33
  v_cvt_pk_bf16_f32 v145, v34, v35
  v_cvt_pk_bf16_f32 v146, v48, v49
  v_cvt_pk_bf16_f32 v147, v50, v51
  v_pk_mul_f32 v[36:37], v[36:37], v[160:161] op_sel:[0,1] op_sel_hi:[1,1]
  v_pk_mul_f32 v[38:39], v[38:39], v[160:161] op_sel:[0,1] op_sel_hi:[1,1]
  v_pk_mul_f32 v[52:53], v[52:53], v[160:161] op_sel:[0,1] op_sel_hi:[1,1]
  v_pk_mul_f32 v[54:55], v[54:55], v[160:161] op_sel:[0,1] op_sel_hi:[1,1]
  v_cvt_pk_bf16_f32 v148, v36, v37
  v_cvt_pk_bf16_f32 v149, v38, v39
  v_cvt_pk_bf16_f32 v150, v52, v53
  v_cvt_pk_bf16_f32 v151, v54, v55
  v_pk_mul_f32 v[40:41], v[40:41], v[162:163] op_sel_hi:[1,0]
  v_pk_mul_f32 v[42:43], v[42:43], v[162:163] op_sel_hi:[1,0]
  v_pk_mul_f32 v[56:57], v[56:57], v[162:163] op_sel_hi:[1,0]
  v_pk_mul_f32 v[58:59], v[58:59], v[162:163] op_sel_hi:[1,0]
  v_cvt_pk_bf16_f32 v152, v40, v41
  v_cvt_pk_bf16_f32 v153, v42, v43
  v_cvt_pk_bf16_f32 v154, v56, v57
  v_cvt_pk_bf16_f32 v155, v58, v59
  v_pk_mul_f32 v[44:45], v[44:45], v[162:163] op_sel:[0,1] op_sel_hi:[1,1]
  v_pk_mul_f32 v[46:47], v[46:47], v[162:163] op_sel:[0,1] op_sel_hi:[1,1]
  v_pk_mul_f32 v[60:61], v[60:61], v[162:163] op_sel:[0,1] op_sel_hi:[1,1]
  v_pk_mul_f32 v[62:63], v[62:63], v[162:163] op_sel:[0,1] op_sel_hi:[1,1]
  v_cvt_pk_bf16_f32 v156, v44, v45
  v_cvt_pk_bf16_f32 v157, v46, v47
  v_cvt_pk_bf16_f32 v158, v60, v61
  v_cvt_pk_bf16_f32 v159, v62, v63
  s_nop 0
  v_permlane16_swap_b32 v128, v130
  v_permlane16_swap_b32 v129, v131
  v_permlane16_swap_b32 v132, v134
  v_permlane16_swap_b32 v133, v135
  v_permlane16_swap_b32 v136, v138
  v_permlane16_swap_b32 v137, v139
  v_permlane16_swap_b32 v140, v142
  v_permlane16_swap_b32 v141, v143
  v_permlane16_swap_b32 v144, v146
  v_permlane16_swap_b32 v145, v147
  v_permlane16_swap_b32 v148, v150
  v_permlane16_swap_b32 v149, v151
  v_permlane16_swap_b32 v152, v154
  v_permlane16_swap_b32 v153, v155
  v_permlane16_swap_b32 v156, v158
  v_permlane16_swap_b32 v157, v159
.p2align 3
  v_accvgpr_write_b32 a128, v128
  v_accvgpr_write_b32 a129, v129
  v_accvgpr_write_b32 a130, v130
  v_accvgpr_write_b32 a131, v131
  v_accvgpr_write_b32 a144, v132
  v_accvgpr_write_b32 a145, v133
  v_accvgpr_write_b32 a146, v134
  v_accvgpr_write_b32 a147, v135
  v_accvgpr_write_b32 a160, v136
  v_accvgpr_write_b32 a161, v137
  v_accvgpr_write_b32 a162, v138
  v_accvgpr_write_b32 a163, v139
  v_accvgpr_write_b32 a176, v140
  v_accvgpr_write_b32 a177, v141
  v_accvgpr_write_b32 a178, v142
  v_accvgpr_write_b32 a179, v143
  v_accvgpr_write_b32 a132, v144
  v_accvgpr_write_b32 a133, v145
  v_accvgpr_write_b32 a134, v146
  v_accvgpr_write_b32 a135, v147
  v_accvgpr_write_b32 a148, v148
  v_accvgpr_write_b32 a149, v149
  v_accvgpr_write_b32 a150, v150
  v_accvgpr_write_b32 a151, v151
  v_accvgpr_write_b32 a164, v152
  v_accvgpr_write_b32 a165, v153
  v_accvgpr_write_b32 a166, v154
  v_accvgpr_write_b32 a167, v155
  v_accvgpr_write_b32 a180, v156
  v_accvgpr_write_b32 a181, v157
  v_accvgpr_write_b32 a182, v158
  v_accvgpr_write_b32 a183, v159
  s_waitcnt vmcnt(16) lgkmcnt(0)
  v_mfma_f32_16x16x32_bf16 v[0:3], v[64:67], v[96:99], 0
  ds_read_b128 a[224:227], v210 offset:0
  s_add_u32 s3, s3, 4096
  v_mfma_f32_16x16x32_bf16 v[0:3], v[80:83], v[112:115], v[0:3]
  ds_read_b128 a[228:231], v210 offset:1024
  s_cmp_eq_u32 s3, s7
  v_mfma_f32_16x16x32_bf16 v[4:7], v[80:83], v[116:119], 0
  ds_read_b128 a[232:235], v210 offset:2048
  s_cselect_b32 s3, 0, s3
  v_mfma_f32_16x16x32_bf16 v[4:7], v[64:67], v[100:103], v[4:7]
  ds_read_b128 a[236:239], v210 offset:3072
  v_add_u32 v210, s3, v213
  v_mfma_f32_16x16x32_bf16 v[8:11], v[64:67], v[104:107], 0
  ds_read_b64_tr_b16 a[192:193], v240 offset:0
  s_add_u32 s13, s13, s14
  v_mfma_f32_16x16x32_bf16 v[8:11], v[80:83], v[120:123], v[8:11]
  ds_read_b64_tr_b16 a[194:195], v240 offset:2048
  s_cmp_eq_u32 s13, s27
  v_mfma_f32_16x16x32_bf16 v[12:15], v[80:83], v[124:127], 0
  ds_read_b64_tr_b16 a[196:197], v241 offset:0
  s_cselect_b32 s13, 0, s13
  v_mfma_f32_16x16x32_bf16 v[12:15], v[64:67], v[108:111], v[12:15]
  ds_read_b64_tr_b16 a[198:199], v241 offset:2048
  s_add_u32 m0, s64, 81920
  v_mfma_f32_16x16x32_bf16 v[28:31], v[68:71], v[108:111], 0
  ds_read_b64_tr_b16 a[200:201], v242 offset:0
  v_mfma_f32_16x16x32_bf16 v[28:31], v[84:87], v[124:127], v[28:31]
  ds_read_b64_tr_b16 a[202:203], v242 offset:2048
  v_mfma_f32_16x16x32_bf16 v[24:27], v[84:87], v[120:123], 0
  ds_read_b64_tr_b16 a[204:205], v243 offset:0
  v_mfma_f32_16x16x32_bf16 v[24:27], v[68:71], v[104:107], v[24:27]
  ds_read_b64_tr_b16 a[206:207], v243 offset:2048
  v_mfma_f32_16x16x32_bf16 v[20:23], v[68:71], v[100:103], 0
  buffer_load_dwordx4 v236, s[40:43], s13 offen offset:0 lds
  v_mfma_f32_16x16x32_bf16 v[20:23], v[84:87], v[116:119], v[20:23]
  buffer_load_dwordx4 v237, s[40:43], s13 offen offset:1024 lds
  v_mfma_f32_16x16x32_bf16 v[16:19], v[84:87], v[112:115], 0
  buffer_load_dwordx4 v238, s[40:43], s13 offen offset:2048 lds
  v_mfma_f32_16x16x32_bf16 v[16:19], v[68:71], v[96:99], v[16:19]
  buffer_load_dwordx4 v239, s[40:43], s13 offen offset:3072 lds
  s_waitcnt vmcnt(16) lgkmcnt(0)
  v_mfma_f32_16x16x32_bf16 v[32:35], v[72:75], v[96:99], 0
  ds_read_b128 a[240:243], v210 offset:0
  s_add_u32 s3, s3, 4096
  v_mfma_f32_16x16x32_bf16 v[32:35], v[88:91], v[112:115], v[32:35]
  ds_read_b128 a[244:247], v210 offset:1024
  s_cmp_eq_u32 s3, s7
  v_mfma_f32_16x16x32_bf16 v[36:39], v[88:91], v[116:119], 0
  ds_read_b128 a[248:251], v210 offset:2048
  s_cselect_b32 s3, 0, s3
  v_mfma_f32_16x16x32_bf16 v[36:39], v[72:75], v[100:103], v[36:39]
  ds_read_b128 a[252:255], v210 offset:3072
  v_add_u32 v210, s3, v213
  v_mfma_f32_16x16x32_bf16 v[40:43], v[72:75], v[104:107], 0
  ds_read_b64_tr_b16 a[208:209], v240 offset:16384
  s_add_u32 s13, s13, s14
  v_mfma_f32_16x16x32_bf16 v[40:43], v[88:91], v[120:123], v[40:43]
  ds_read_b64_tr_b16 a[210:211], v240 offset:18432
  s_cmp_eq_u32 s13, s27
  v_mfma_f32_16x16x32_bf16 v[44:47], v[88:91], v[124:127], 0
  ds_read_b64_tr_b16 a[212:213], v241 offset:16384
  s_cselect_b32 s13, 0, s13
  v_mfma_f32_16x16x32_bf16 v[44:47], v[72:75], v[108:111], v[44:47]
  ds_read_b64_tr_b16 a[214:215], v241 offset:18432
  s_add_u32 m0, s64, 0
  v_mfma_f32_16x16x32_bf16 v[60:63], v[76:79], v[108:111], 0
  ds_read_b64_tr_b16 a[216:217], v242 offset:16384
  v_mfma_f32_16x16x32_bf16 v[60:63], v[92:95], v[124:127], v[60:63]
  ds_read_b64_tr_b16 a[218:219], v242 offset:18432
  v_mfma_f32_16x16x32_bf16 v[56:59], v[92:95], v[120:123], 0
  ds_read_b64_tr_b16 a[220:221], v243 offset:16384
  v_mfma_f32_16x16x32_bf16 v[56:59], v[76:79], v[104:107], v[56:59]
  ds_read_b64_tr_b16 a[222:223], v243 offset:18432
  v_mfma_f32_16x16x32_bf16 v[52:55], v[76:79], v[100:103], 0
  buffer_load_dwordx4 v236, s[40:43], s13 offen offset:0 lds
  v_mfma_f32_16x16x32_bf16 v[52:55], v[92:95], v[116:119], v[52:55]
  buffer_load_dwordx4 v237, s[40:43], s13 offen offset:1024 lds
  v_mfma_f32_16x16x32_bf16 v[48:51], v[92:95], v[112:115], 0
  buffer_load_dwordx4 v238, s[40:43], s13 offen offset:2048 lds
  v_mfma_f32_16x16x32_bf16 v[48:51], v[76:79], v[96:99], v[48:51]
  buffer_load_dwordx4 v239, s[40:43], s13 offen offset:3072 lds
  s_mov_b32 s10, 4
  s_call_b64 s[8:9], L_gemm10
  s_mov_b32 s40, s30
  s_mov_b32 s41, s31
  s_mov_b32 s42, 1835008
  s_mov_b32 s70, 1024
  v_mad_u32_u24 v236, v208, s70, v209
  s_lshl_b32 s70, s26, 10
  s_lshl_b32 s71, s4, 8
  s_add_u32 s70, s70, s71
  s_add_u32 s70, s70, s67
  v_add_u32 v236, s70, v236
  v_add_u32 v237, 7168, v236
  v_add_u32 v238, 14336, v236
  v_add_u32 v239, 21504, v236
  s_mov_b32 s14, 32768
  s_lshl_b32 s70, s15, 16
  s_sub_u32 s27, 262144, s70
  s_mul_i32 s13, s101, 32768
  s_sub_u32 s13, s13, s14
  s_mov_b32 s10, 2
  s_call_b64 s[8:9], L_gemm5
  s_lshl_b32 s70, s15, 7
  v_xor_b32 v236, s70, v236
  v_xor_b32 v237, s70, v237
  v_xor_b32 v238, s70, v238
  v_xor_b32 v239, s70, v239
  s_mov_b32 s10, 0
  s_call_b64 s[8:9], L_gemm11
  s_lshl_b32 s70, s15, 2
  s_or_b32 s70, s70, s4
  s_cmp_eq_u32 s70, 7
  s_cbranch_scc1 L_walk
L_walk_ret:
  s_lshl_b32 s70, s4, 13
  v_add_u32 v214, s70, v213
  s_waitcnt lgkmcnt(0)
  s_barrier
  s_nop 3
.p2align 3
  ds_write_b128 v214, v[176:179] offset:0
  v_pk_mul_f32 v[0:1], v[0:1], v[160:161] op_sel_hi:[1,0]
  v_pk_mul_f32 v[2:3], v[2:3], v[160:161] op_sel_hi:[1,0]
  v_pk_mul_f32 v[16:17], v[16:17], v[160:161] op_sel_hi:[1,0]
  v_pk_mul_f32 v[18:19], v[18:19], v[160:161] op_sel_hi:[1,0]
  ds_write_b128 v214, v[180:183] offset:1024
  v_cvt_pk_bf16_f32 v128, v0, v1
  v_cvt_pk_bf16_f32 v129, v2, v3
  v_cvt_pk_bf16_f32 v130, v16, v17
  v_cvt_pk_bf16_f32 v131, v18, v19
  ds_write_b128 v214, v[184:187] offset:2048
  v_pk_mul_f32 v[4:5], v[4:5], v[160:161] op_sel:[0,1] op_sel_hi:[1,1]
  v_pk_mul_f32 v[6:7], v[6:7], v[160:161] op_sel:[0,1] op_sel_hi:[1,1]
  v_pk_mul_f32 v[20:21], v[20:21], v[160:161] op_sel:[0,1] op_sel_hi:[1,1]
  v_pk_mul_f32 v[22:23], v[22:23], v[160:161] op_sel:[0,1] op_sel_hi:[1,1]
  ds_write_b128 v214, v[188:191] offset:3072
  v_cvt_pk_bf16_f32 v132, v4, v5
  v_cvt_pk_bf16_f32 v133, v6, v7
  v_cvt_pk_bf16_f32 v134, v20, v21
  v_cvt_pk_bf16_f32 v135, v22, v23
  ds_write_b128 v214, v[192:195] offset:4096
  v_pk_mul_f32 v[8:9], v[8:9], v[162:163] op_sel_hi:[1,0]
  v_pk_mul_f32 v[10:11], v[10:11], v[162:163] op_sel_hi:[1,0]
  v_pk_mul_f32 v[24:25], v[24:25], v[162:163] op_sel_hi:[1,0]
  v_pk_mul_f32 v[26:27], v[26:27], v[162:163] op_sel_hi:[1,0]
  ds_write_b128 v214, v[196:199] offset:5120
  v_cvt_pk_bf16_f32 v136, v8, v9
  v_cvt_pk_bf16_f32 v137, v10, v11
  v_cvt_pk_bf16_f32 v138, v24, v25
  v_cvt_pk_bf16_f32 v139, v26, v27
  ds_write_b128 v214, v[200:203] offset:6144
  v_pk_mul_f32 v[12:13], v[12:13], v[162:163] op_sel:[0,1] op_sel_hi:[1,1]
  v_pk_mul_f32 v[14:15], v[14:15], v[162:163] op_sel:[0,1] op_sel_hi:[1,1]
  v_pk_mul_f32 v[28:29], v[28:29], v[162:163] op_sel:[0,1] op_sel_hi:[1,1]
  v_pk_mul_f32 v[30:31], v[30:31], v[162:163] op_sel:[0,1] op_sel_hi:[1,1]
  ds_write_b128 v214, v[204:207] offset:7168
  v_cvt_pk_bf16_f32 v140, v12, v13
  v_cvt_pk_bf16_f32 v141, v14, v15
  v_cvt_pk_bf16_f32 v142, v28, v29
  v_cvt_pk_bf16_f32 v143, v30, v31
  v_pk_mul_f32 v[32:33], v[32:33], v[160:161] op_sel_hi:[1,0]
  v_pk_mul_f32 v[34:35], v[34:35], v[160:161] op_sel_hi:[1,0]
  v_pk_mul_f32 v[48:49], v[48:49], v[160:161] op_sel_hi:[1,0]
  v_pk_mul_f32 v[50:51], v[50:51], v[160:161] op_sel_hi:[1,0]
  v_cvt_pk_bf16_f32 v144, v32, v33
  v_cvt_pk_bf16_f32 v145, v34, v35
  v_cvt_pk_bf16_f32 v146, v48, v49
  v_cvt_pk_bf16_f32 v147, v50, v51
  v_pk_mul_f32 v[36:37], v[36:37], v[160:161] op_sel:[0,1] op_sel_hi:[1,1]
  v_pk_mul_f32 v[38:39], v[38:39], v[160:161] op_sel:[0,1] op_sel_hi:[1,1]
  v_pk_mul_f32 v[52:53], v[52:53], v[160:161] op_sel:[0,1] op_sel_hi:[1,1]
  v_pk_mul_f32 v[54:55], v[54:55], v[160:161] op_sel:[0,1] op_sel_hi:[1,1]
  v_cvt_pk_bf16_f32 v148, v36, v37
  v_cvt_pk_bf16_f32 v149, v38, v39
  v_cvt_pk_bf16_f32 v150, v52, v53
  v_cvt_pk_bf16_f32 v151, v54, v55
  v_pk_mul_f32 v[40:41], v[40:41], v[162:163] op_sel_hi:[1,0]
  v_pk_mul_f32 v[42:43], v[42:43], v[162:163] op_sel_hi:[1,0]
  v_pk_mul_f32 v[56:57], v[56:57], v[162:163] op_sel_hi:[1,0]
  v_pk_mul_f32 v[58:59], v[58:59], v[162:163] op_sel_hi:[1,0]
  v_cvt_pk_bf16_f32 v152, v40, v41
  v_cvt_pk_bf16_f32 v153, v42, v43
  v_cvt_pk_bf16_f32 v154, v56, v57
  v_cvt_pk_bf16_f32 v155, v58, v59
  v_pk_mul_f32 v[44:45], v[44:45], v[162:163] op_sel:[0,1] op_sel_hi:[1,1]
  v_pk_mul_f32 v[46:47], v[46:47], v[162:163] op_sel:[0,1] op_sel_hi:[1,1]
  v_pk_mul_f32 v[60:61], v[60:61], v[162:163] op_sel:[0,1] op_sel_hi:[1,1]
  v_pk_mul_f32 v[62:63], v[62:63], v[162:163] op_sel:[0,1] op_sel_hi:[1,1]
  v_cvt_pk_bf16_f32 v156, v44, v45
  v_cvt_pk_bf16_f32 v157, v46, v47
  v_cvt_pk_bf16_f32 v158, v60, v61
  v_cvt_pk_bf16_f32 v159, v62, v63
  s_waitcnt lgkmcnt(0)
  s_barrier
  s_lshl_b32 s3, s101, 12
  s_lshr_b32 s7, s27, 3
  v_add_u32 v210, s3, v213
  ds_read_b128 v[96:99], v210 offset:0
  ds_read_b128 v[100:103], v210 offset:1024
  ds_read_b128 v[104:107], v210 offset:2048
  ds_read_b128 v[108:111], v210 offset:3072
  s_add_u32 s3, s3, 4096
  s_cmp_eq_u32 s3, s7
  s_cselect_b32 s3, 0, s3
  v_add_u32 v210, s3, v213
  ds_read_b128 v[112:115], v210 offset:0
  ds_read_b128 v[116:119], v210 offset:1024
  ds_read_b128 v[120:123], v210 offset:2048
  ds_read_b128 v[124:127], v210 offset:3072
  s_add_u32 s3, s3, 4096
  s_cmp_eq_u32 s3, s7
  s_cselect_b32 s3, 0, s3
  v_add_u32 v210, s3, v213
  v_permlane16_swap_b32 v128, v130
  v_permlane16_swap_b32 v129, v131
  v_permlane16_swap_b32 v132, v134
  v_permlane16_swap_b32 v133, v135
  v_permlane16_swap_b32 v136, v138
  v_permlane16_swap_b32 v137, v139
  v_permlane16_swap_b32 v140, v142
  v_permlane16_swap_b32 v141, v143
  v_permlane16_swap_b32 v144, v146
  v_permlane16_swap_b32 v145, v147
  v_permlane16_swap_b32 v148, v150
  v_permlane16_swap_b32 v149, v151
  v_permlane16_swap_b32 v152, v154
  v_permlane16_swap_b32 v153, v155
  v_permlane16_swap_b32 v156, v158
  v_permlane16_swap_b32 v157, v159
.p2align 3
  v_accvgpr_write_b32 a136, v128
  v_accvgpr_write_b32 a137, v129
  v_accvgpr_write_b32 a138, v130
  v_accvgpr_write_b32 a139, v131
  v_accvgpr_write_b32 a152, v132
  v_accvgpr_write_b32 a153, v133
  v_accvgpr_write_b32 a154, v134
  v_accvgpr_write_b32 a155, v135
  v_accvgpr_write_b32 a168, v136
  v_accvgpr_write_b32 a169, v137
  v_accvgpr_write_b32 a170, v138
  v_accvgpr_write_b32 a171, v139
  v_accvgpr_write_b32 a184, v140
  v_accvgpr_write_b32 a185, v141
  v_accvgpr_write_b32 a186, v142
  v_accvgpr_write_b32 a187, v143
  v_accvgpr_write_b32 a140, v144
  v_accvgpr_write_b32 a141, v145
  v_accvgpr_write_b32 a142, v146
  v_accvgpr_write_b32 a143, v147
  v_accvgpr_write_b32 a156, v148
  v_accvgpr_write_b32 a157, v149
  v_accvgpr_write_b32 a158, v150
  v_accvgpr_write_b32 a159, v151
  v_accvgpr_write_b32 a172, v152
  v_accvgpr_write_b32 a173, v153
  v_accvgpr_write_b32 a174, v154
  v_accvgpr_write_b32 a175, v155
  v_accvgpr_write_b32 a188, v156
  v_accvgpr_write_b32 a189, v157
  v_accvgpr_write_b32 a190, v158
  v_accvgpr_write_b32 a191, v159
  s_mov_b32 s61, s69
  s_cmp_lg_u32 s15, 0
  s_cbranch_scc0 L_ffn2_even
L_ffn2_odd:
  s_waitcnt vmcnt(16) lgkmcnt(0)
  v_mfma_f32_16x16x32_bf16 v[0:3], v[64:67], v[96:99], 0
  ds_read_b128 a[224:227], v210 offset:0
  s_add_u32 s3, s3, 4096
  v_mfma_f32_16x16x32_bf16 v[0:3], v[80:83], v[112:115], v[0:3]
  ds_read_b128 a[228:231], v210 offset:1024
  s_cmp_eq_u32 s3, s7
  v_mfma_f32_16x16x32_bf16 v[4:7], v[80:83], v[116:119], 0
  ds_read_b128 a[232:235], v210 offset:2048
  s_cselect_b32 s3, 0, s3
  v_mfma_f32_16x16x32_bf16 v[4:7], v[64:67], v[100:103], v[4:7]
  ds_read_b128 a[236:239], v210 offset:3072
  v_add_u32 v210, s3, v213
  v_mfma_f32_16x16x32_bf16 v[8:11], v[64:67], v[104:107], 0
  ds_read_b64_tr_b16 a[192:193], v244 offset:16384
  s_add_u32 s13, s13, s14
  v_mfma_f32_16x16x32_bf16 v[8:11], v[80:83], v[120:123], v[8:11]
  ds_read_b64_tr_b16 a[194:195], v244 offset:18432
  s_cmp_eq_u32 s13, s27
  v_mfma_f32_16x16x32_bf16 v[12:15], v[80:83], v[124:127], 0
  ds_read_b64_tr_b16 a[196:197], v245 offset:16384
  s_cselect_b32 s13, 0, s13
  v_mfma_f32_16x16x32_bf16 v[12:15], v[64:67], v[108:111], v[12:15]
  ds_read_b64_tr_b16 a[198:199], v245 offset:18432
  s_add_u32 m0, s64, 49152
  v_mfma_f32_16x16x32_bf16 v[28:31], v[68:71], v[108:111], 0
  ds_read_b64_tr_b16 a[200:201], v246 offset:16384
  v_mfma_f32_16x16x32_bf16 v[28:31], v[84:87], v[124:127], v[28:31]
  ds_read_b64_tr_b16 a[202:203], v246 offset:18432
  v_mfma_f32_16x16x32_bf16 v[24:27], v[84:87], v[120:123], 0
  ds_read_b64_tr_b16 a[204:205], v247 offset:16384
  v_mfma_f32_16x16x32_bf16 v[24:27], v[68:71], v[104:107], v[24:27]
  ds_read_b64_tr_b16 a[206:207], v247 offset:18432
  v_mfma_f32_16x16x32_bf16 v[20:23], v[68:71], v[100:103], 0
  buffer_load_dwordx4 v236, s[40:43], s13 offen offset:0 lds
  v_mfma_f32_16x16x32_bf16 v[20:23], v[84:87], v[116:119], v[20:23]
  buffer_load_dwordx4 v237, s[40:43], s13 offen offset:1024 lds
  v_mfma_f32_16x16x32_bf16 v[16:19], v[84:87], v[112:115], 0
  buffer_load_dwordx4 v238, s[40:43], s13 offen offset:2048 lds
  v_mfma_f32_16x16x32_bf16 v[16:19], v[68:71], v[96:99], v[16:19]
  buffer_load_dwordx4 v239, s[40:43], s13 offen offset:3072 lds
  s_waitcnt vmcnt(16) lgkmcnt(0)
  v_mfma_f32_16x16x32_bf16 v[32:35], v[72:75], v[96:99], 0
  ds_read_b128 a[240:243], v210 offset:0
  s_add_u32 s3, s3, 4096
  v_mfma_f32_16x16x32_bf16 v[32:35], v[88:91], v[112:115], v[32:35]
  ds_read_b128 a[244:247], v210 offset:1024
  s_cmp_eq_u32 s3, s7
  v_mfma_f32_16x16x32_bf16 v[36:39], v[88:91], v[116:119], 0
  ds_read_b128 a[248:251], v210 offset:2048
  s_cselect_b32 s3, 0, s3
  v_mfma_f32_16x16x32_bf16 v[36:39], v[72:75], v[100:103], v[36:39]
  ds_read_b128 a[252:255], v210 offset:3072
  v_add_u32 v210, s3, v213
  v_mfma_f32_16x16x32_bf16 v[40:43], v[72:75], v[104:107], 0
  ds_read_b64_tr_b16 a[208:209], v244 offset:32768
  s_add_u32 s13, s13, s14
  v_mfma_f32_16x16x32_bf16 v[40:43], v[88:91], v[120:123], v[40:43]
  ds_read_b64_tr_b16 a[210:211], v244 offset:34816
  s_cmp_eq_u32 s13, s27
  v_mfma_f32_16x16x32_bf16 v[44:47], v[88:91], v[124:127], 0
  ds_read_b64_tr_b16 a[212:213], v245 offset:32768
  s_cselect_b32 s13, 0, s13
  v_mfma_f32_16x16x32_bf16 v[44:47], v[72:75], v[108:111], v[44:47]
  ds_read_b64_tr_b16 a[214:215], v245 offset:34816
  s_add_u32 m0, s64, 65536
  v_mfma_f32_16x16x32_bf16 v[60:63], v[76:79], v[108:111], 0
  ds_read_b64_tr_b16 a[216:217], v246 offset:32768
  v_mfma_f32_16x16x32_bf16 v[60:63], v[92:95], v[124:127], v[60:63]
  ds_read_b64_tr_b16 a[218:219], v246 offset:34816
  v_mfma_f32_16x16x32_bf16 v[56:59], v[92:95], v[120:123], 0
  ds_read_b64_tr_b16 a[220:221], v247 offset:32768
  v_mfma_f32_16x16x32_bf16 v[56:59], v[76:79], v[104:107], v[56:59]
  ds_read_b64_tr_b16 a[222:223], v247 offset:34816
  v_mfma_f32_16x16x32_bf16 v[52:55], v[76:79], v[100:103], 0
  buffer_load_dwordx4 v236, s[40:43], s13 offen offset:0 lds
  v_mfma_f32_16x16x32_bf16 v[52:55], v[92:95], v[116:119], v[52:55]
  buffer_load_dwordx4 v237, s[40:43], s13 offen offset:1024 lds
  v_mfma_f32_16x16x32_bf16 v[48:51], v[92:95], v[112:115], 0
  buffer_load_dwordx4 v238, s[40:43], s13 offen offset:2048 lds
  v_mfma_f32_16x16x32_bf16 v[48:51], v[76:79], v[96:99], v[48:51]
  buffer_load_dwordx4 v239, s[40:43], s13 offen offset:3072 lds
  s_mov_b32 s10, 1
  s_call_b64 s[8:9], L_gemm2
  s_waitcnt vmcnt(16) lgkmcnt(0)
  v_mfma_f32_16x16x32_bf16 v[32:35], v[72:75], v[96:99], v[32:35]
  ds_read_b128 a[240:243], v210 offset:0
  s_add_u32 s3, s3, 4096
  v_mfma_f32_16x16x32_bf16 v[32:35], v[88:91], v[112:115], v[32:35]
  ds_read_b128 a[244:247], v210 offset:1024
  s_cmp_eq_u32 s3, s7
  v_mfma_f32_16x16x32_bf16 v[36:39], v[88:91], v[116:119], v[36:39]
  ds_read_b128 a[248:251], v210 offset:2048
  s_cselect_b32 s3, 0, s3
  v_mfma_f32_16x16x32_bf16 v[36:39], v[72:75], v[100:103], v[36:39]
  ds_read_b128 a[252:255], v210 offset:3072
  v_add_u32 v210, s3, v213
  v_mfma_f32_16x16x32_bf16 v[40:43], v[72:75], v[104:107], v[40:43]
  ds_read_b64_tr_b16 a[208:209], v244 offset:0
  v_mfma_f32_16x16x32_bf16 v[40:43], v[88:91], v[120:123], v[40:43]
  ds_read_b64_tr_b16 a[210:211], v244 offset:2048
  v_mfma_f32_16x16x32_bf16 v[44:47], v[88:91], v[124:127], v[44:47]
  ds_read_b64_tr_b16 a[212:213], v245 offset:0
  v_mfma_f32_16x16x32_bf16 v[44:47], v[72:75], v[108:111], v[44:47]
  ds_read_b64_tr_b16 a[214:215], v245 offset:2048
  v_mfma_f32_16x16x32_bf16 v[60:63], v[76:79], v[108:111], v[60:63]
  ds_read_b64_tr_b16 a[216:217], v246 offset:0
  v_mfma_f32_16x16x32_bf16 v[60:63], v[92:95], v[124:127], v[60:63]
  ds_read_b64_tr_b16 a[218:219], v246 offset:2048
  v_mfma_f32_16x16x32_bf16 v[56:59], v[92:95], v[120:123], v[56:59]
  ds_read_b64_tr_b16 a[220:221], v247 offset:0
  s_add_u32 m0, s63, 32768
  v_mfma_f32_16x16x32_bf16 v[56:59], v[76:79], v[104:107], v[56:59]
  ds_read_b64_tr_b16 a[222:223], v247 offset:2048
  v_mfma_f32_16x16x32_bf16 v[52:55], v[76:79], v[100:103], v[52:55]
  buffer_load_dwordx4 v228, s[44:47], s60 offen offset:0 lds
  v_mfma_f32_16x16x32_bf16 v[52:55], v[92:95], v[116:119], v[52:55]
  buffer_load_dwordx4 v229, s[44:47], s60 offen offset:1024 lds
  v_mfma_f32_16x16x32_bf16 v[48:51], v[92:95], v[112:115], v[48:51]
  buffer_load_dwordx4 v230, s[44:47], s60 offen offset:2048 lds
  v_mfma_f32_16x16x32_bf16 v[48:51], v[76:79], v[96:99], v[48:51]
  buffer_load_dwordx4 v231, s[44:47], s60 offen offset:3072 lds
  s_add_u32 s60, s60, 16384
  s_nop 5
  s_add_u32 s94, s65, 0
  s_add_u32 s95, s94, 4096
.p2align 3
  v_cvt_pk_bf16_f32 v128, v0, v1
  v_cvt_pk_bf16_f32 v129, v2, v3
  v_cvt_pk_bf16_f32 v130, v16, v17
  v_cvt_pk_bf16_f32 v131, v18, v19
  v_cvt_pk_bf16_f32 v132, v4, v5
  v_cvt_pk_bf16_f32 v133, v6, v7
  v_cvt_pk_bf16_f32 v134, v20, v21
  v_cvt_pk_bf16_f32 v135, v22, v23
  v_cvt_pk_bf16_f32 v136, v8, v9
  v_cvt_pk_bf16_f32 v137, v10, v11
  v_cvt_pk_bf16_f32 v138, v24, v25
  v_cvt_pk_bf16_f32 v139, v26, v27
  v_cvt_pk_bf16_f32 v140, v12, v13
  v_cvt_pk_bf16_f32 v141, v14, v15
  v_cvt_pk_bf16_f32 v142, v28, v29
  v_cvt_pk_bf16_f32 v143, v30, v31
  v_cvt_pk_bf16_f32 v144, v32, v33
  v_cvt_pk_bf16_f32 v145, v34, v35
  v_cvt_pk_bf16_f32 v146, v48, v49
  v_cvt_pk_bf16_f32 v147, v50, v51
  v_cvt_pk_bf16_f32 v148, v36, v37
  v_cvt_pk_bf16_f32 v149, v38, v39
  v_cvt_pk_bf16_f32 v150, v52, v53
  v_cvt_pk_bf16_f32 v151, v54, v55
  v_cvt_pk_bf16_f32 v152, v40, v41
  v_cvt_pk_bf16_f32 v153, v42, v43
  v_cvt_pk_bf16_f32 v154, v56, v57
  v_cvt_pk_bf16_f32 v155, v58, v59
  v_cvt_pk_bf16_f32 v156, v44, v45
  v_cvt_pk_bf16_f32 v157, v46, v47
  v_cvt_pk_bf16_f32 v158, v60, v61
  v_cvt_pk_bf16_f32 v159, v62, v63
  s_waitcnt vmcnt(16) lgkmcnt(0)
  v_mfma_f32_16x16x32_bf16 v[0:3], a[192:195], a[224:227], 0
  ds_read_b128 v[96:99], v210 offset:0
  s_add_u32 s3, s3, 4096
  v_mfma_f32_16x16x32_bf16 v[0:3], a[208:211], a[240:243], v[0:3]
  ds_read_b128 v[100:103], v210 offset:1024
  s_cmp_eq_u32 s3, s7
  v_mfma_f32_16x16x32_bf16 v[4:7], a[208:211], a[244:247], 0
  ds_read_b128 v[104:107], v210 offset:2048
  s_cselect_b32 s3, 0, s3
  v_mfma_f32_16x16x32_bf16 v[4:7], a[192:195], a[228:231], v[4:7]
  ds_read_b128 v[108:111], v210 offset:3072
  v_add_u32 v210, s3, v213
  v_mfma_f32_16x16x32_bf16 v[8:11], a[192:195], a[232:235], 0
  ds_read_b64_tr_b16 v[64:65], v244 offset:16384
  v_mfma_f32_16x16x32_bf16 v[8:11], a[208:211], a[248:251], v[8:11]
  ds_read_b64_tr_b16 v[66:67], v244 offset:18432
  v_mfma_f32_16x16x32_bf16 v[12:15], a[208:211], a[252:255], 0
  ds_read_b64_tr_b16 v[68:69], v245 offset:16384
  v_mfma_f32_16x16x32_bf16 v[12:15], a[192:195], a[236:239], v[12:15]
  ds_read_b64_tr_b16 v[70:71], v245 offset:18432
  v_mfma_f32_16x16x32_bf16 v[28:31], a[196:199], a[236:239], 0
  ds_read_b64_tr_b16 v[72:73], v246 offset:16384
  v_mfma_f32_16x16x32_bf16 v[28:31], a[212:215], a[252:255], v[28:31]
  ds_read_b64_tr_b16 v[74:75], v246 offset:18432
  v_mfma_f32_16x16x32_bf16 v[24:27], a[212:215], a[248:251], 0
  ds_read_b64_tr_b16 v[76:77], v247 offset:16384
  s_add_u32 m0, s63, 49152
  v_mfma_f32_16x16x32_bf16 v[24:27], a[196:199], a[232:235], v[24:27]
  ds_read_b64_tr_b16 v[78:79], v247 offset:18432
  v_mfma_f32_16x16x32_bf16 v[20:23], a[196:199], a[228:231], 0
  buffer_load_dwordx4 v228, s[44:47], s60 offen offset:0 lds
  v_mfma_f32_16x16x32_bf16 v[20:23], a[212:215], a[244:247], v[20:23]
  buffer_load_dwordx4 v229, s[44:47], s60 offen offset:1024 lds
  v_mfma_f32_16x16x32_bf16 v[16:19], a[212:215], a[240:243], 0
  buffer_load_dwordx4 v230, s[44:47], s60 offen offset:2048 lds
  v_mfma_f32_16x16x32_bf16 v[16:19], a[196:199], a[224:227], v[16:19]
  buffer_load_dwordx4 v231, s[44:47], s60 offen offset:3072 lds
  s_add_u32 s60, s60, 16384
  s_waitcnt vmcnt(16) lgkmcnt(0)
  v_mfma_f32_16x16x32_bf16 v[32:35], a[200:203], a[224:227], 0
  ds_read_b128 v[112:115], v210 offset:0
  s_add_u32 s3, s3, 4096
  v_mfma_f32_16x16x32_bf16 v[32:35], a[216:219], a[240:243], v[32:35]
  ds_read_b128 v[116:119], v210 offset:1024
  s_cmp_eq_u32 s3, s7
  v_mfma_f32_16x16x32_bf16 v[36:39], a[216:219], a[244:247], 0
  ds_read_b128 v[120:123], v210 offset:2048
  s_cselect_b32 s3, 0, s3
  v_mfma_f32_16x16x32_bf16 v[36:39], a[200:203], a[228:231], v[36:39]
  ds_read_b128 v[124:127], v210 offset:3072
  v_add_u32 v210, s3, v213
  v_mfma_f32_16x16x32_bf16 v[40:43], a[200:203], a[232:235], 0
  ds_read_b64_tr_b16 v[80:81], v244 offset:32768
  v_mfma_f32_16x16x32_bf16 v[40:43], a[216:219], a[248:251], v[40:43]
  ds_read_b64_tr_b16 v[82:83], v244 offset:34816
  v_mfma_f32_16x16x32_bf16 v[44:47], a[216:219], a[252:255], 0
  ds_read_b64_tr_b16 v[84:85], v245 offset:32768
  v_mfma_f32_16x16x32_bf16 v[44:47], a[200:203], a[236:239], v[44:47]
  ds_read_b64_tr_b16 v[86:87], v245 offset:34816
  v_mfma_f32_16x16x32_bf16 v[60:63], a[204:207], a[236:239], 0
L_pad0:
  s_cbranch_execz L_pad4
  ds_read_b64_tr_b16 v[88:89], v246 offset:32768
  v_mfma_f32_16x16x32_bf16 v[60:63], a[220:223], a[252:255], v[60:63]
  ds_read_b64_tr_b16 v[90:91], v246 offset:34816
  v_mfma_f32_16x16x32_bf16 v[56:59], a[220:223], a[248:251], 0
  ds_read_b64_tr_b16 v[92:93], v247 offset:32768
  v_mfma_f32_16x16x32_bf16 v[56:59], a[204:207], a[232:235], v[56:59]
  ds_read_b64_tr_b16 v[94:95], v247 offset:34816
  v_mfma_f32_16x16x32_bf16 v[52:55], a[204:207], a[228:231], 0

  v_mfma_f32_16x16x32_bf16 v[52:55], a[220:223], a[244:247], v[52:55]

  v_mfma_f32_16x16x32_bf16 v[48:51], a[220:223], a[240:243], 0

  v_mfma_f32_16x16x32_bf16 v[48:51], a[204:207], a[224:227], v[48:51]

  s_waitcnt vmcnt(12) lgkmcnt(0)
  v_mfma_f32_16x16x32_bf16 v[0:3], v[64:67], v[96:99], v[0:3]
  ds_read_b128 a[224:227], v210 offset:0
  s_add_u32 s3, s3, 4096
  v_mfma_f32_16x16x32_bf16 v[0:3], v[80:83], v[112:115], v[0:3]
  ds_read_b128 a[228:231], v210 offset:1024
  s_cmp_eq_u32 s3, s7
  v_mfma_f32_16x16x32_bf16 v[4:7], v[80:83], v[116:119], v[4:7]
  ds_read_b128 a[232:235], v210 offset:2048
  s_cselect_b32 s3, 0, s3
  v_mfma_f32_16x16x32_bf16 v[4:7], v[64:67], v[100:103], v[4:7]
  ds_read_b128 a[236:239], v210 offset:3072
  v_add_u32 v210, s3, v213
  v_mfma_f32_16x16x32_bf16 v[8:11], v[64:67], v[104:107], v[8:11]
  ds_read_b64_tr_b16 a[192:193], v240 offset:0
  v_mfma_f32_16x16x32_bf16 v[8:11], v[80:83], v[120:123], v[8:11]
  ds_read_b64_tr_b16 a[194:195], v240 offset:2048
  v_mfma_f32_16x16x32_bf16 v[12:15], v[80:83], v[124:127], v[12:15]
  ds_read_b64_tr_b16 a[196:197], v241 offset:0
  v_mfma_f32_16x16x32_bf16 v[12:15], v[64:67], v[108:111], v[12:15]
  ds_read_b64_tr_b16 a[198:199], v241 offset:2048
  v_mfma_f32_16x16x32_bf16 v[28:31], v[68:71], v[108:111], v[28:31]
  ds_read_b64_tr_b16 a[200:201], v242 offset:0
  v_mfma_f32_16x16x32_bf16 v[28:31], v[84:87], v[124:127], v[28:31]
  ds_read_b64_tr_b16 a[202:203], v242 offset:2048
  v_mfma_f32_16x16x32_bf16 v[24:27], v[84:87], v[120:123], v[24:27]
  ds_read_b64_tr_b16 a[204:205], v243 offset:0
  v_mfma_f32_16x16x32_bf16 v[24:27], v[68:71], v[104:107], v[24:27]
  ds_read_b64_tr_b16 a[206:207], v243 offset:2048
  v_mfma_f32_16x16x32_bf16 v[20:23], v[68:71], v[100:103], v[20:23]

  v_mfma_f32_16x16x32_bf16 v[20:23], v[84:87], v[116:119], v[20:23]

  v_mfma_f32_16x16x32_bf16 v[16:19], v[84:87], v[112:115], v[16:19]

  v_mfma_f32_16x16x32_bf16 v[16:19], v[68:71], v[96:99], v[16:19]

  s_waitcnt vmcnt(8) lgkmcnt(0)
  v_mfma_f32_16x16x32_bf16 v[32:35], v[72:75], v[96:99], v[32:35]
  ds_read_b128 a[240:243], v210 offset:0
  s_add_u32 s3, s3, 4096
  v_mfma_f32_16x16x32_bf16 v[32:35], v[88:91], v[112:115], v[32:35]
  ds_read_b128 a[244:247], v210 offset:1024
  s_cmp_eq_u32 s3, s7
  v_mfma_f32_16x16x32_bf16 v[36:39], v[88:91], v[116:119], v[36:39]
  ds_read_b128 a[248:251], v210 offset:2048
  s_cselect_b32 s3, 0, s3
  v_mfma_f32_16x16x32_bf16 v[36:39], v[72:75], v[100:103], v[36:39]
  ds_read_b128 a[252:255], v210 offset:3072
  v_add_u32 v210, s3, v213
  v_mfma_f32_16x16x32_bf16 v[40:43], v[72:75], v[104:107], v[40:43]
  ds_read_b64_tr_b16 a[208:209], v240 offset:16384
  v_mfma_f32_16x16x32_bf16 v[40:43], v[88:91], v[120:123], v[40:43]
  ds_read_b64_tr_b16 a[210:211], v240 offset:18432
  v_mfma_f32_16x16x32_bf16 v[44:47], v[88:91], v[124:127], v[44:47]
  ds_read_b64_tr_b16 a[212:213], v241 offset:16384
  v_mfma_f32_16x16x32_bf16 v[44:47], v[72:75], v[108:111], v[44:47]
  ds_read_b64_tr_b16 a[214:215], v241 offset:18432
  v_mfma_f32_16x16x32_bf16 v[60:63], v[76:79], v[108:111], v[60:63]
  ds_read_b64_tr_b16 a[216:217], v242 offset:16384
  v_mfma_f32_16x16x32_bf16 v[60:63], v[92:95], v[124:127], v[60:63]
  ds_read_b64_tr_b16 a[218:219], v242 offset:18432
  v_mfma_f32_16x16x32_bf16 v[56:59], v[92:95], v[120:123], v[56:59]
  ds_read_b64_tr_b16 a[220:221], v243 offset:16384
  s_add_u32 m0, s64, 0
  v_mfma_f32_16x16x32_bf16 v[56:59], v[76:79], v[104:107], v[56:59]
  ds_read_b64_tr_b16 a[222:223], v243 offset:18432
  v_mfma_f32_16x16x32_bf16 v[52:55], v[76:79], v[100:103], v[52:55]
  buffer_load_dwordx4 v232, s[48:51], s61 offen offset:0 lds
  v_mfma_f32_16x16x32_bf16 v[52:55], v[92:95], v[116:119], v[52:55]
  buffer_load_dwordx4 v233, s[48:51], s61 offen offset:1024 lds
  v_mfma_f32_16x16x32_bf16 v[48:51], v[92:95], v[112:115], v[48:51]
  buffer_load_dwordx4 v232, s[48:51], s61 offen offset:2048 lds
  v_mfma_f32_16x16x32_bf16 v[48:51], v[76:79], v[96:99], v[48:51]
  buffer_load_dwordx4 v233, s[48:51], s61 offen offset:3072 lds
  s_waitcnt vmcnt(63) lgkmcnt(0)
  v_mfma_f32_16x16x32_bf16 v[0:3], a[192:195], a[224:227], v[0:3]
  s_add_u32 s61, s61, 16384
  s_add_u32 m0, s64, 16384
  v_mov_b32 v112, 0
  v_mfma_f32_16x16x32_bf16 v[0:3], a[208:211], a[240:243], v[0:3]
  buffer_load_dwordx4 v232, s[48:51], s61 offen offset:0 lds
  v_mfma_f32_16x16x32_bf16 v[4:7], a[208:211], a[244:247], v[4:7]
  s_mov_b32 s40, s24
  v_mov_b32 v113, 0
  v_mov_b32 v114, 0
  v_mfma_f32_16x16x32_bf16 v[4:7], a[192:195], a[228:231], v[4:7]
  s_mov_b32 s41, s25
  v_mov_b32 v115, 0
  v_mov_b32 v116, 0
  v_mfma_f32_16x16x32_bf16 v[8:11], a[192:195], a[232:235], v[8:11]
  s_mov_b32 s42, 4194304
  v_mov_b32 v117, 0
  v_mov_b32 v118, 0
  v_mfma_f32_16x16x32_bf16 v[8:11], a[208:211], a[248:251], v[8:11]
  buffer_load_dwordx4 v233, s[48:51], s61 offen offset:1024 lds
  v_mfma_f32_16x16x32_bf16 v[12:15], a[208:211], a[252:255], v[12:15]
  s_mov_b32 s70, 1024
  v_mov_b32 v119, 0
  v_mov_b32 v120, 0
  v_mfma_f32_16x16x32_bf16 v[12:15], a[192:195], a[236:239], v[12:15]
  s_mov_b32 s14, 32768
  v_mov_b32 v121, 0
  v_mov_b32 v122, 0
  v_mfma_f32_16x16x32_bf16 v[28:31], a[196:199], a[236:239], v[28:31]
  s_mov_b32 s27, 524288
  v_mov_b32 v123, 0
  v_and_b32 v214, 3, v212
  v_mfma_f32_16x16x32_bf16 v[28:31], a[212:215], a[252:255], v[28:31]
  buffer_load_dwordx4 v232, s[48:51], s61 offen offset:2048 lds
  v_mfma_f32_16x16x32_bf16 v[24:27], a[212:215], a[248:251], v[24:27]
  s_mul_i32 s13, s100, 32768
  v_cmp_eq_u32 vcc, 0, v214
  v_mov_b32 v214, 0x3f803f80
  v_mfma_f32_16x16x32_bf16 v[24:27], a[196:199], a[232:235], v[24:27]
  v_cndmask_b32 v124, 0, v214, vcc
  v_mov_b32 v125, v124
  v_mfma_f32_16x16x32_bf16 v[20:23], a[196:199], a[228:231], v[20:23]
  v_mov_b32 v126, v124
  v_mov_b32 v127, v124
  v_mfma_f32_16x16x32_bf16 v[20:23], a[212:215], a[244:247], v[20:23]
  buffer_load_dwordx4 v233, s[48:51], s61 offen offset:3072 lds
  v_mfma_f32_16x16x32_bf16 v[16:19], a[212:215], a[240:243], v[16:19]
  s_add_u32 s61, s69, 32768
  v_mad_u32_u24 v236, v208, s70, v209
  s_lshl_b32 s70, s5, 19
  v_mfma_f32_16x16x32_bf16 v[16:19], a[196:199], a[224:227], v[16:19]
  s_lshl_b32 s71, s4, 8
  s_add_u32 s70, s70, s71
  s_add_u32 s70, s70, s67
  v_mfma_f32_16x16x32_bf16 v[32:35], a[200:203], a[224:227], v[32:35]
  s_sub_u32 s13, s13, s14
  v_add_u32 v236, s70, v236
  v_add_u32 v237, 7168, v236
  v_mfma_f32_16x16x32_bf16 v[32:35], a[216:219], a[240:243], v[32:35]
  s_mov_b32 s68, s13
  v_add_u32 v238, 14336, v236
  v_add_u32 v239, 21504, v236
  v_mfma_f32_16x16x32_bf16 v[36:39], a[216:219], a[244:247], v[36:39]
  v_cvt_pk_bf16_f32 v160, v0, v1
  v_mfma_f32_16x16x32_bf16 v[36:39], a[200:203], a[228:231], v[36:39]
  v_cvt_pk_bf16_f32 v161, v2, v3
  v_mfma_f32_16x16x32_bf16 v[40:43], a[200:203], a[232:235], v[40:43]
  v_cvt_pk_bf16_f32 v162, v16, v17
  v_mfma_f32_16x16x32_bf16 v[40:43], a[216:219], a[248:251], v[40:43]
  v_cvt_pk_bf16_f32 v163, v18, v19
  v_mfma_f32_16x16x32_bf16 v[44:47], a[216:219], a[252:255], v[44:47]
  v_cvt_pk_bf16_f32 v164, v4, v5
  v_mfma_f32_16x16x32_bf16 v[44:47], a[200:203], a[236:239], v[44:47]
  v_cvt_pk_bf16_f32 v165, v6, v7
  v_mfma_f32_16x16x32_bf16 v[60:63], a[204:207], a[236:239], v[60:63]
  v_cvt_pk_bf16_f32 v166, v20, v21
  v_mfma_f32_16x16x32_bf16 v[60:63], a[220:223], a[252:255], v[60:63]
  v_cvt_pk_bf16_f32 v167, v22, v23
  v_mfma_f32_16x16x32_bf16 v[56:59], a[220:223], a[248:251], v[56:59]
  v_cvt_pk_bf16_f32 v168, v8, v9
  v_mfma_f32_16x16x32_bf16 v[56:59], a[204:207], a[232:235], v[56:59]
  v_cvt_pk_bf16_f32 v169, v10, v11
  v_mfma_f32_16x16x32_bf16 v[52:55], a[204:207], a[228:231], v[52:55]
  v_cvt_pk_bf16_f32 v170, v24, v25
  v_mfma_f32_16x16x32_bf16 v[52:55], a[220:223], a[244:247], v[52:55]
  v_cvt_pk_bf16_f32 v171, v26, v27
  v_mfma_f32_16x16x32_bf16 v[48:51], a[220:223], a[240:243], v[48:51]
  v_cvt_pk_bf16_f32 v172, v12, v13
  v_mfma_f32_16x16x32_bf16 v[48:51], a[204:207], a[224:227], v[48:51]
  v_cvt_pk_bf16_f32 v173, v14, v15
  v_cvt_pk_bf16_f32 v174, v28, v29
  v_cvt_pk_bf16_f32 v175, v30, v31
L_ffn2_done:
  s_waitcnt vmcnt(12) lgkmcnt(0)
  s_barrier
  ds_read_b128 a[192:195], v216 offset:32768
  ds_read_b128 a[196:199], v217 offset:32768
  ds_read_b128 a[200:203], v218 offset:32768
  ds_read_b128 a[204:207], v219 offset:32768
  ds_read_b128 a[208:211], v216 offset:36864
  ds_read_b128 a[212:215], v217 offset:36864
  ds_read_b128 a[216:219], v218 offset:36864
  ds_read_b128 a[220:223], v219 offset:36864
  ds_read_b128 a[224:227], v216 offset:40960
  ds_read_b128 a[228:231], v217 offset:40960
  ds_read_b128 a[232:235], v218 offset:40960
  ds_read_b128 a[236:239], v219 offset:40960
  s_waitcnt lgkmcnt(11)
  v_mfma_f32_16x16x32_bf16 v[0:3], a[192:195], a[128:131], 0
  ds_read_b128 a[240:243], v216 offset:45056
  v_cvt_pk_bf16_f32 v176, v32, v33
  s_waitcnt lgkmcnt(10)
  v_mfma_f32_16x16x32_bf16 v[0:3], a[196:199], a[132:135], v[0:3]
  ds_read_b128 a[244:247], v217 offset:45056
  v_cvt_pk_bf16_f32 v177, v34, v35
  v_mfma_f32_16x16x32_bf16 v[0:3], a[200:203], a[136:139], v[0:3]
  ds_read_b128 a[248:251], v218 offset:45056
  v_cvt_pk_bf16_f32 v178, v48, v49
  s_waitcnt lgkmcnt(9)
  v_mfma_f32_16x16x32_bf16 v[0:3], a[204:207], a[140:143], v[0:3]
  ds_read_b128 a[252:255], v219 offset:45056
  v_cvt_pk_bf16_f32 v179, v50, v51
  s_waitcnt lgkmcnt(8)
  v_mfma_f32_16x16x32_bf16 v[16:19], a[220:223], a[140:143], 0
  s_add_u32 m0, s63, 0
  v_cvt_pk_bf16_f32 v180, v36, v37
  v_mfma_f32_16x16x32_bf16 v[16:19], a[216:219], a[136:139], v[16:19]
  buffer_load_dwordx4 v228, s[44:47], s60 offen offset:0 lds
  v_mfma_f32_16x16x32_bf16 v[16:19], a[212:215], a[132:135], v[16:19]
  v_cvt_pk_bf16_f32 v181, v38, v39
  v_max3_f32 v96, v0, v1, v2
  v_mfma_f32_16x16x32_bf16 v[16:19], a[208:211], a[128:131], v[16:19]
  v_cvt_pk_bf16_f32 v182, v52, v53
  v_mfma_f32_16x16x32_bf16 v[4:7], a[192:195], a[144:147], 0
  v_cvt_pk_bf16_f32 v183, v54, v55
  v_mfma_f32_16x16x32_bf16 v[4:7], a[196:199], a[148:151], v[4:7]
  buffer_load_dwordx4 v229, s[44:47], s60 offen offset:1024 lds
  v_mfma_f32_16x16x32_bf16 v[4:7], a[200:203], a[152:155], v[4:7]
  v_cvt_pk_bf16_f32 v184, v40, v41
  v_mfma_f32_16x16x32_bf16 v[4:7], a[204:207], a[156:159], v[4:7]
  v_cvt_pk_bf16_f32 v185, v42, v43
  v_max3_f32 v97, v3, v16, v17
  v_mfma_f32_16x16x32_bf16 v[20:23], a[220:223], a[156:159], 0
  v_cvt_pk_bf16_f32 v186, v56, v57
  v_max3_f32 v96, v96, v18, v19
  v_mfma_f32_16x16x32_bf16 v[20:23], a[216:219], a[152:155], v[20:23]
  buffer_load_dwordx4 v230, s[44:47], s60 offen offset:2048 lds
  v_mfma_f32_16x16x32_bf16 v[20:23], a[212:215], a[148:151], v[20:23]
  v_cvt_pk_bf16_f32 v187, v58, v59
  v_max_f32 v96, v96, v97
  v_mfma_f32_16x16x32_bf16 v[20:23], a[208:211], a[144:147], v[20:23]
  v_cvt_pk_bf16_f32 v188, v44, v45
  v_mov_b32 v97, v96
  v_mfma_f32_16x16x32_bf16 v[8:11], a[192:195], a[160:163], 0
  v_cvt_pk_bf16_f32 v189, v46, v47
  v_permlane32_swap_b32 v96, v97
  v_mfma_f32_16x16x32_bf16 v[8:11], a[196:199], a[164:167], v[8:11]
  buffer_load_dwordx4 v231, s[44:47], s60 offen offset:3072 lds
  v_mfma_f32_16x16x32_bf16 v[8:11], a[200:203], a[168:171], v[8:11]
  s_add_u32 s60, s60, 16384
  v_cvt_pk_bf16_f32 v190, v60, v61
  s_add_u32 m0, s63, 16384
  v_mfma_f32_16x16x32_bf16 v[8:11], a[204:207], a[172:175], v[8:11]
  v_cvt_pk_bf16_f32 v191, v62, v63
  v_max_f32 v96, v96, v97
  v_mfma_f32_16x16x32_bf16 v[24:27], a[220:223], a[172:175], 0
  v_mov_b32 v97, v96
  v_max3_f32 v100, v4, v5, v6
  v_mfma_f32_16x16x32_bf16 v[24:27], a[216:219], a[168:171], v[24:27]
  buffer_load_dwordx4 v228, s[44:47], s60 offen offset:0 lds
  v_mfma_f32_16x16x32_bf16 v[24:27], a[212:215], a[164:167], v[24:27]
  v_permlane16_swap_b32 v96, v97
  v_max_f32 v96, v96, v97
  v_mfma_f32_16x16x32_bf16 v[24:27], a[208:211], a[160:163], v[24:27]
  v_sub_f32 v99, 0, v96
  v_sub_f32 v98, 0, v96
  v_mfma_f32_16x16x32_bf16 v[12:15], a[192:195], a[176:179], 0
  v_sub_f32 v97, 0, v96
  v_sub_f32 v96, 0, v96
  v_mfma_f32_16x16x32_bf16 v[12:15], a[196:199], a[180:183], v[12:15]
  buffer_load_dwordx4 v229, s[44:47], s60 offen offset:1024 lds
  v_mfma_f32_16x16x32_bf16 v[12:15], a[200:203], a[184:187], v[12:15]
  v_add_f32 v0, v0, v96
  v_add_f32 v1, v1, v96
  v_mfma_f32_16x16x32_bf16 v[12:15], a[204:207], a[188:191], v[12:15]
  v_add_f32 v2, v2, v96
  v_add_f32 v3, v3, v96
  v_mfma_f32_16x16x32_bf16 v[28:31], a[220:223], a[188:191], 0
  v_add_f32 v16, v16, v96
  v_add_f32 v17, v17, v96
  v_mfma_f32_16x16x32_bf16 v[28:31], a[216:219], a[184:187], v[28:31]
  buffer_load_dwordx4 v230, s[44:47], s60 offen offset:2048 lds
  v_mfma_f32_16x16x32_bf16 v[28:31], a[212:215], a[180:183], v[28:31]
  v_add_f32 v18, v18, v96
  v_add_f32 v19, v19, v96
  v_mfma_f32_16x16x32_bf16 v[28:31], a[208:211], a[176:179], v[28:31]
  v_max3_f32 v101, v7, v20, v21
  v_max3_f32 v100, v100, v22, v23
  s_waitcnt lgkmcnt(0)
  v_mfma_f32_16x16x32_bf16 v[32:35], a[224:227], a[128:131], v[96:99]
  v_max_f32 v100, v100, v101
  v_mov_b32 v101, v100
  v_mfma_f32_16x16x32_bf16 v[32:35], a[228:231], a[132:135], v[32:35]
  buffer_load_dwordx4 v231, s[44:47], s60 offen offset:3072 lds
  v_mfma_f32_16x16x32_bf16 v[32:35], a[232:235], a[136:139], v[32:35]
  s_add_u32 s60, s60, 16384
  s_waitcnt vmcnt(16)
  s_barrier
  v_mfma_f32_16x16x32_bf16 v[32:35], a[236:239], a[140:143], v[32:35]
  ds_read_b128 a[192:195], v216 offset:49152
  v_permlane32_swap_b32 v100, v101
  v_mfma_f32_16x16x32_bf16 v[48:51], a[252:255], a[140:143], v[96:99]
  ds_read_b128 a[196:199], v217 offset:49152
  v_max_f32 v100, v100, v101
  v_mfma_f32_16x16x32_bf16 v[48:51], a[248:251], a[136:139], v[48:51]
  ds_read_b128 a[200:203], v218 offset:49152
  v_mov_b32 v101, v100
  v_mfma_f32_16x16x32_bf16 v[48:51], a[244:247], a[132:135], v[48:51]
  ds_read_b128 a[204:207], v219 offset:49152
  v_permlane16_swap_b32 v100, v101
  v_mfma_f32_16x16x32_bf16 v[48:51], a[240:243], a[128:131], v[48:51]
  ds_read_b128 a[208:211], v216 offset:53248
  v_max_f32 v100, v100, v101
  v_sub_f32 v103, 0, v100
  v_sub_f32 v102, 0, v100
  v_sub_f32 v101, 0, v100
  v_sub_f32 v100, 0, v100
  v_add_f32 v4, v4, v100
  v_add_f32 v5, v5, v100
  v_mfma_f32_16x16x32_bf16 v[36:39], a[224:227], a[144:147], v[100:103]
  ds_read_b128 a[212:215], v217 offset:53248
  v_add_f32 v6, v6, v100
  v_mfma_f32_16x16x32_bf16 v[36:39], a[228:231], a[148:151], v[36:39]
  ds_read_b128 a[216:219], v218 offset:53248
  v_add_f32 v7, v7, v100
  v_mfma_f32_16x16x32_bf16 v[36:39], a[232:235], a[152:155], v[36:39]
  ds_read_b128 a[220:223], v219 offset:53248
  v_add_f32 v20, v20, v100
  v_mfma_f32_16x16x32_bf16 v[36:39], a[236:239], a[156:159], v[36:39]
  s_add_u32 m0, s63, 32768
  v_add_f32 v21, v21, v100
  v_add_f32 v22, v22, v100
  v_mfma_f32_16x16x32_bf16 v[52:55], a[252:255], a[156:159], v[100:103]
  buffer_load_dwordx4 v228, s[44:47], s60 offen offset:0 lds
  v_mfma_f32_16x16x32_bf16 v[52:55], a[248:251], a[152:155], v[52:55]
  v_add_f32 v23, v23, v100
  v_max3_f32 v104, v8, v9, v10
  v_mfma_f32_16x16x32_bf16 v[52:55], a[244:247], a[148:151], v[52:55]
  v_max3_f32 v105, v11, v24, v25
  v_max3_f32 v104, v104, v26, v27
  v_mfma_f32_16x16x32_bf16 v[52:55], a[240:243], a[144:147], v[52:55]
  v_max_f32 v104, v104, v105
  v_mov_b32 v105, v104
  v_max3_f32 v108, v12, v13, v14
  v_max3_f32 v109, v15, v28, v29
  v_permlane32_swap_b32 v104, v105
  v_max_f32 v104, v104, v105
  v_mov_b32 v105, v104
  v_max3_f32 v108, v108, v30, v31
  v_max_f32 v108, v108, v109
  v_permlane16_swap_b32 v104, v105
  v_max_f32 v104, v104, v105
  v_sub_f32 v107, 0, v104
  v_sub_f32 v106, 0, v104
  v_sub_f32 v105, 0, v104
  v_sub_f32 v104, 0, v104
  v_add_f32 v8, v8, v104
  v_add_f32 v9, v9, v104
  v_mfma_f32_16x16x32_bf16 v[40:43], a[224:227], a[160:163], v[104:107]
  buffer_load_dwordx4 v229, s[44:47], s60 offen offset:1024 lds
  v_mfma_f32_16x16x32_bf16 v[40:43], a[228:231], a[164:167], v[40:43]
  v_add_f32 v10, v10, v104
  v_add_f32 v11, v11, v104
  v_mfma_f32_16x16x32_bf16 v[40:43], a[232:235], a[168:171], v[40:43]
  v_add_f32 v24, v24, v104
  v_add_f32 v25, v25, v104
  v_mfma_f32_16x16x32_bf16 v[40:43], a[236:239], a[172:175], v[40:43]
  v_add_f32 v26, v26, v104
  v_add_f32 v27, v27, v104
  v_mfma_f32_16x16x32_bf16 v[56:59], a[252:255], a[172:175], v[104:107]
  buffer_load_dwordx4 v230, s[44:47], s60 offen offset:2048 lds
  v_mfma_f32_16x16x32_bf16 v[56:59], a[248:251], a[168:171], v[56:59]
  v_mov_b32 v109, v108
  v_mfma_f32_16x16x32_bf16 v[56:59], a[244:247], a[164:167], v[56:59]
  v_exp_f32 v0, v0
  v_mfma_f32_16x16x32_bf16 v[56:59], a[240:243], a[160:163], v[56:59]
  v_permlane32_swap_b32 v108, v109
  v_max_f32 v108, v108, v109
  v_mov_b32 v109, v108
  v_add_f32 v112, v112, v0
  v_exp_f32 v1, v1
  v_permlane16_swap_b32 v108, v109
  v_max_f32 v108, v108, v109
  v_sub_f32 v111, 0, v108
  v_sub_f32 v110, 0, v108
  v_sub_f32 v109, 0, v108
  v_sub_f32 v108, 0, v108
  v_add_f32 v12, v12, v108
  v_add_f32 v13, v13, v108
  v_mfma_f32_16x16x32_bf16 v[44:47], a[224:227], a[176:179], v[108:111]
  buffer_load_dwordx4 v231, s[44:47], s60 offen offset:3072 lds
  v_mfma_f32_16x16x32_bf16 v[44:47], a[228:231], a[180:183], v[44:47]
  s_add_u32 s60, s60, 16384
  v_add_f32 v14, v14, v108
  v_add_f32 v15, v15, v108
  v_mfma_f32_16x16x32_bf16 v[44:47], a[232:235], a[184:187], v[44:47]
  v_add_f32 v28, v28, v108
  v_add_f32 v29, v29, v108
  v_mfma_f32_16x16x32_bf16 v[44:47], a[236:239], a[188:191], v[44:47]
  v_add_f32 v30, v30, v108
  v_add_f32 v31, v31, v108
  v_mfma_f32_16x16x32_bf16 v[60:63], a[252:255], a[188:191], v[108:111]
  v_add_f32 v112, v112, v1
  v_cvt_pk_bf16_f32 v64, v0, v1
  v_mfma_f32_16x16x32_bf16 v[60:63], a[248:251], a[184:187], v[60:63]
  v_exp_f32 v2, v2
  v_mfma_f32_16x16x32_bf16 v[60:63], a[244:247], a[180:183], v[60:63]
  v_add_f32 v112, v112, v2
  v_mfma_f32_16x16x32_bf16 v[60:63], a[240:243], a[176:179], v[60:63]
  v_exp_f32 v3, v3
  v_exp_f32 v16, v16
  v_add_f32 v112, v112, v3
  v_cvt_pk_bf16_f32 v65, v2, v3
  s_waitcnt lgkmcnt(0)
  v_mfma_f32_16x16x32_bf16 v[0:3], a[192:195], a[128:131], v[96:99]
  s_add_u32 m0, s64, 32768
  v_add_f32 v112, v112, v16
  v_mfma_f32_16x16x32_bf16 v[0:3], a[196:199], a[132:135], v[0:3]
  buffer_load_dwordx4 v232, s[48:51], s61 offen offset:0 lds
  v_mfma_f32_16x16x32_bf16 v[0:3], a[200:203], a[136:139], v[0:3]
  v_exp_f32 v17, v17
  v_mfma_f32_16x16x32_bf16 v[0:3], a[204:207], a[140:143], v[0:3]
  v_add_f32 v112, v112, v17
  v_cvt_pk_bf16_f32 v66, v16, v17
  v_exp_f32 v18, v18
  v_exp_f32 v19, v19
  v_add_f32 v112, v112, v18
  v_add_f32 v112, v112, v19
  v_cvt_pk_bf16_f32 v67, v18, v19
  v_mfma_f32_16x16x32_bf16 v[16:19], a[220:223], a[140:143], v[96:99]
  buffer_load_dwordx4 v233, s[48:51], s61 offen offset:1024 lds
  v_mfma_f32_16x16x32_bf16 v[16:19], a[216:219], a[136:139], v[16:19]
  v_exp_f32 v4, v4
  v_mfma_f32_16x16x32_bf16 v[16:19], a[212:215], a[132:135], v[16:19]
  v_add_f32 v113, v113, v4
  v_mfma_f32_16x16x32_bf16 v[16:19], a[208:211], a[128:131], v[16:19]
  v_exp_f32 v5, v5
  v_exp_f32 v6, v6
  v_add_f32 v113, v113, v5
  v_cvt_pk_bf16_f32 v68, v4, v5
  v_add_f32 v113, v113, v6
  v_exp_f32 v7, v7
  v_exp_f32 v20, v20
  v_add_f32 v113, v113, v7
  v_cvt_pk_bf16_f32 v69, v6, v7
  v_mfma_f32_16x16x32_bf16 v[4:7], a[192:195], a[144:147], v[100:103]
  buffer_load_dwordx4 v232, s[48:51], s61 offen offset:2048 lds
  v_mfma_f32_16x16x32_bf16 v[4:7], a[196:199], a[148:151], v[4:7]
  v_add_f32 v113, v113, v20
  v_mfma_f32_16x16x32_bf16 v[4:7], a[200:203], a[152:155], v[4:7]
  v_exp_f32 v21, v21
  v_mfma_f32_16x16x32_bf16 v[4:7], a[204:207], a[156:159], v[4:7]
  v_add_f32 v113, v113, v21
  v_cvt_pk_bf16_f32 v70, v20, v21
  v_exp_f32 v22, v22
  v_exp_f32 v23, v23
  v_add_f32 v113, v113, v22
  v_add_f32 v113, v113, v23
  v_cvt_pk_bf16_f32 v71, v22, v23
  v_mfma_f32_16x16x32_bf16 v[20:23], a[220:223], a[156:159], v[100:103]
  buffer_load_dwordx4 v233, s[48:51], s61 offen offset:3072 lds
  v_mfma_f32_16x16x32_bf16 v[20:23], a[216:219], a[152:155], v[20:23]
  s_add_u32 s61, s61, 16384
  v_exp_f32 v8, v8
  v_mfma_f32_16x16x32_bf16 v[20:23], a[212:215], a[148:151], v[20:23]
  v_exp_f32 v9, v9
  v_mfma_f32_16x16x32_bf16 v[20:23], a[208:211], a[144:147], v[20:23]
  v_cvt_pk_bf16_f32 v72, v8, v9
  v_exp_f32 v10, v10
  v_exp_f32 v11, v11
  v_exp_f32 v24, v24
  v_cvt_pk_bf16_f32 v73, v10, v11
  v_mfma_f32_16x16x32_bf16 v[8:11], a[192:195], a[160:163], v[104:107]
  v_exp_f32 v25, v25
  v_mfma_f32_16x16x32_bf16 v[8:11], a[196:199], a[164:167], v[8:11]
  v_cvt_pk_bf16_f32 v74, v24, v25
  v_mfma_f32_16x16x32_bf16 v[8:11], a[200:203], a[168:171], v[8:11]
  v_exp_f32 v26, v26
  v_mfma_f32_16x16x32_bf16 v[8:11], a[204:207], a[172:175], v[8:11]
  v_exp_f32 v27, v27
  v_exp_f32 v12, v12
  v_cvt_pk_bf16_f32 v75, v26, v27
  v_mfma_f32_16x16x32_bf16 v[24:27], a[220:223], a[172:175], v[104:107]
  v_exp_f32 v13, v13
  v_mfma_f32_16x16x32_bf16 v[24:27], a[216:219], a[168:171], v[24:27]
  v_cvt_pk_bf16_f32 v76, v12, v13
  v_mfma_f32_16x16x32_bf16 v[24:27], a[212:215], a[164:167], v[24:27]
  v_exp_f32 v14, v14
  v_mfma_f32_16x16x32_bf16 v[24:27], a[208:211], a[160:163], v[24:27]
  v_exp_f32 v15, v15
  v_exp_f32 v28, v28
  v_cvt_pk_bf16_f32 v77, v14, v15
  v_mfma_f32_16x16x32_bf16 v[12:15], a[192:195], a[176:179], v[108:111]
  ds_read_b128 a[192:195], v216 offset:57344
  v_mfma_f32_16x16x32_bf16 v[12:15], a[196:199], a[180:183], v[12:15]
  ds_read_b128 a[196:199], v217 offset:57344
  v_mfma_f32_16x16x32_bf16 v[12:15], a[200:203], a[184:187], v[12:15]
  ds_read_b128 a[200:203], v218 offset:57344
  v_mfma_f32_16x16x32_bf16 v[12:15], a[204:207], a[188:191], v[12:15]
  ds_read_b128 a[204:207], v219 offset:57344
  v_exp_f32 v29, v29
  v_exp_f32 v30, v30
  v_cvt_pk_bf16_f32 v78, v28, v29
  v_exp_f32 v31, v31
  v_exp_f32 v32, v32
  v_cvt_pk_bf16_f32 v79, v30, v31
  v_mfma_f32_16x16x32_bf16 v[28:31], a[220:223], a[188:191], v[108:111]
  v_add_f32 v112, v112, v32
  v_mfma_f32_16x16x32_bf16 v[28:31], a[216:219], a[184:187], v[28:31]
  v_exp_f32 v33, v33
  v_mfma_f32_16x16x32_bf16 v[28:31], a[212:215], a[180:183], v[28:31]
  v_add_f32 v112, v112, v33
  v_cvt_pk_bf16_f32 v80, v32, v33
  v_mfma_f32_16x16x32_bf16 v[28:31], a[208:211], a[176:179], v[28:31]
  ds_read_b128 a[208:211], v216 offset:61440
  v_exp_f32 v34, v34
  v_exp_f32 v35, v35
  v_add_f32 v112, v112, v34
  v_add_f32 v112, v112, v35
  v_cvt_pk_bf16_f32 v81, v34, v35
  v_exp_f32 v48, v48
  v_exp_f32 v49, v49
  v_add_f32 v112, v112, v48
  v_add_f32 v112, v112, v49
  v_cvt_pk_bf16_f32 v82, v48, v49
  v_exp_f32 v50, v50
  v_exp_f32 v51, v51
  v_add_f32 v112, v112, v50
  v_add_f32 v112, v112, v51
  v_cvt_pk_bf16_f32 v83, v50, v51
  v_exp_f32 v36, v36
  v_exp_f32 v37, v37
  v_add_f32 v113, v113, v36
  v_add_f32 v113, v113, v37
  v_cvt_pk_bf16_f32 v84, v36, v37
  v_exp_f32 v38, v38
  v_exp_f32 v39, v39
  v_add_f32 v113, v113, v38
  v_add_f32 v113, v113, v39
  v_cvt_pk_bf16_f32 v85, v38, v39
  v_exp_f32 v52, v52
  v_exp_f32 v53, v53
  v_add_f32 v113, v113, v52
  v_add_f32 v113, v113, v53
  v_cvt_pk_bf16_f32 v86, v52, v53
  v_exp_f32 v54, v54
  v_exp_f32 v55, v55
  v_add_f32 v113, v113, v54
  v_add_f32 v113, v113, v55
  v_cvt_pk_bf16_f32 v87, v54, v55
  v_exp_f32 v40, v40
  v_exp_f32 v41, v41
  v_exp_f32 v42, v42
  v_cvt_pk_bf16_f32 v88, v40, v41
  v_exp_f32 v43, v43
  v_exp_f32 v56, v56
  v_cvt_pk_bf16_f32 v89, v42, v43
  v_exp_f32 v57, v57
  v_exp_f32 v58, v58
  v_cvt_pk_bf16_f32 v90, v56, v57
  v_exp_f32 v59, v59
  v_exp_f32 v44, v44
  v_cvt_pk_bf16_f32 v91, v58, v59
  v_exp_f32 v45, v45
  v_exp_f32 v46, v46
  v_cvt_pk_bf16_f32 v92, v44, v45
  v_exp_f32 v47, v47
  v_exp_f32 v60, v60
  v_cvt_pk_bf16_f32 v93, v46, v47
  v_exp_f32 v61, v61
  v_exp_f32 v62, v62
  v_cvt_pk_bf16_f32 v94, v60, v61
  v_exp_f32 v63, v63
  ds_read_b128 a[212:215], v217 offset:61440
  v_cvt_pk_bf16_f32 v95, v62, v63
  ds_read_b128 a[216:219], v218 offset:61440
  ds_read_b128 a[220:223], v219 offset:61440
  s_mov_b32 s62, 7
  s_and_b32 s26, s6, 3
  s_mov_b32 s101, 0
  s_waitcnt vmcnt(12)
  s_branch L_p2
.p2align 12
L_padL:
  s_branch L_padR
  s_nop 0
L_loop:
  s_waitcnt vmcnt(16) lgkmcnt(0)
  s_barrier
  v_mfma_f32_16x16x32_bf16 v[32:35], a[192:195], a[128:131], v[96:99]
  v_exp_f32 v0, v0
  v_mfma_f32_16x16x32_bf16 v[32:35], a[196:199], a[132:135], v[32:35]
  ds_read_b64_tr_b16 a[224:225], v220 offset:49152
  v_add_f32 v112, v112, v0
  v_mfma_f32_16x16x32_bf16 v[32:35], a[200:203], a[136:139], v[32:35]
  v_exp_f32 v1, v1
  v_mfma_f32_16x16x32_bf16 v[32:35], a[204:207], a[140:143], v[32:35]
  ds_read_b64_tr_b16 a[226:227], v220 offset:53248
  v_add_f32 v112, v112, v1
  v_mfma_f32_16x16x32_bf16 v[36:39], a[204:207], a[156:159], v[100:103]
  v_exp_f32 v2, v2
  v_mfma_f32_16x16x32_bf16 v[36:39], a[200:203], a[152:155], v[36:39]
  ds_read_b64_tr_b16 a[228:229], v220 offset:57344
  v_cvt_pk_bf16_f32 v64, v0, v1
  v_mfma_f32_16x16x32_bf16 v[36:39], a[196:199], a[148:151], v[36:39]
  v_exp_f32 v3, v3
  v_mfma_f32_16x16x32_bf16 v[36:39], a[192:195], a[144:147], v[36:39]
  ds_read_b64_tr_b16 a[230:231], v220 offset:61440
  v_add_f32 v112, v112, v2
  v_mfma_f32_16x16x32_bf16 v[40:43], a[192:195], a[160:163], v[104:107]
  v_exp_f32 v8, v8
  v_mfma_f32_16x16x32_bf16 v[40:43], a[196:199], a[164:167], v[40:43]
  ds_read_b64_tr_b16 a[232:233], v221 offset:49152
  v_add_f32 v112, v112, v3
  v_mfma_f32_16x16x32_bf16 v[40:43], a[200:203], a[168:171], v[40:43]
  v_exp_f32 v9, v9
  v_mfma_f32_16x16x32_bf16 v[40:43], a[204:207], a[172:175], v[40:43]
  ds_read_b64_tr_b16 a[234:235], v221 offset:53248
  v_cvt_pk_bf16_f32 v65, v2, v3
  v_mfma_f32_16x16x32_bf16 v[44:47], a[204:207], a[188:191], v[108:111]
  v_exp_f32 v10, v10
  v_mfma_f32_16x16x32_bf16 v[44:47], a[200:203], a[184:187], v[44:47]
  ds_read_b64_tr_b16 a[236:237], v221 offset:57344
  v_cvt_pk_bf16_f32 v72, v8, v9
  v_mfma_f32_16x16x32_bf16 v[44:47], a[196:199], a[180:183], v[44:47]
  v_exp_f32 v11, v11
  v_mfma_f32_16x16x32_bf16 v[44:47], a[192:195], a[176:179], v[44:47]
  ds_read_b64_tr_b16 a[238:239], v221 offset:61440
  v_cvt_pk_bf16_f32 v73, v10, v11
  v_mfma_f32_16x16x32_bf16 v[60:63], a[208:211], a[176:179], v[108:111]
  v_exp_f32 v4, v4
  v_mfma_f32_16x16x32_bf16 v[60:63], a[212:215], a[180:183], v[60:63]
  ds_read_b64_tr_b16 a[240:241], v222 offset:49152
  v_add_f32 v113, v113, v4
  v_mfma_f32_16x16x32_bf16 v[60:63], a[216:219], a[184:187], v[60:63]
  v_exp_f32 v5, v5
  v_mfma_f32_16x16x32_bf16 v[60:63], a[220:223], a[188:191], v[60:63]
  ds_read_b64_tr_b16 a[242:243], v222 offset:53248
  v_add_f32 v113, v113, v5
  v_mfma_f32_16x16x32_bf16 v[56:59], a[220:223], a[172:175], v[104:107]
  v_exp_f32 v6, v6
  v_mfma_f32_16x16x32_bf16 v[56:59], a[216:219], a[168:171], v[56:59]
  ds_read_b64_tr_b16 a[244:245], v222 offset:57344
  v_cvt_pk_bf16_f32 v68, v4, v5
  v_mfma_f32_16x16x32_bf16 v[56:59], a[212:215], a[164:167], v[56:59]
  v_exp_f32 v7, v7
  v_mfma_f32_16x16x32_bf16 v[56:59], a[208:211], a[160:163], v[56:59]
  ds_read_b64_tr_b16 a[246:247], v222 offset:61440
  v_add_f32 v113, v113, v6
  v_mfma_f32_16x16x32_bf16 v[52:55], a[208:211], a[144:147], v[100:103]
  v_exp_f32 v12, v12
  v_mfma_f32_16x16x32_bf16 v[52:55], a[212:215], a[148:151], v[52:55]
  ds_read_b64_tr_b16 a[248:249], v223 offset:49152
  v_add_f32 v113, v113, v7
  v_mfma_f32_16x16x32_bf16 v[52:55], a[216:219], a[152:155], v[52:55]
  v_exp_f32 v13, v13
  v_mfma_f32_16x16x32_bf16 v[52:55], a[220:223], a[156:159], v[52:55]
  ds_read_b64_tr_b16 a[250:251], v223 offset:53248
  v_cvt_pk_bf16_f32 v69, v6, v7
  v_mfma_f32_16x16x32_bf16 v[48:51], a[220:223], a[140:143], v[96:99]
  v_exp_f32 v14, v14
  v_mfma_f32_16x16x32_bf16 v[48:51], a[216:219], a[136:139], v[48:51]
  ds_read_b64_tr_b16 a[252:253], v223 offset:57344
  v_cvt_pk_bf16_f32 v76, v12, v13
  v_mfma_f32_16x16x32_bf16 v[48:51], a[212:215], a[132:135], v[48:51]
  s_waitcnt lgkmcnt(3)
  v_exp_f32 v15, v15
  v_mfma_f32_16x16x32_bf16 v[48:51], a[208:211], a[128:131], v[48:51]
  ds_read_b64_tr_b16 a[254:255], v223 offset:61440
  v_cvt_pk_bf16_f32 v77, v14, v15
  v_mfma_f32_16x16x32_bf16 a[12:15], a[224:227], v[204:207], a[12:15]
  s_add_u32 m0, s63, 32768
  v_exp_f32 v16, v16
  v_mfma_f32_16x16x32_bf16 a[12:15], a[228:231], v[252:255], a[12:15]
  ds_read_b128 a[192:195], v216 offset:49152
  v_add_f32 v112, v112, v16
  v_mfma_f32_16x16x32_bf16 a[8:11], a[228:231], v[248:251], a[8:11]
  v_exp_f32 v17, v17
  v_mfma_f32_16x16x32_bf16 a[8:11], a[224:227], v[200:203], a[8:11]
  ds_read_b128 a[196:199], v217 offset:49152
  v_add_f32 v112, v112, v17
  v_mfma_f32_16x16x32_bf16 a[4:7], a[224:227], v[196:199], a[4:7]
  v_exp_f32 v18, v18
  v_mfma_f32_16x16x32_bf16 a[4:7], a[228:231], v[244:247], a[4:7]
  buffer_load_dwordx4 v228, s[44:47], s60 offen offset:0 lds
  v_mfma_f32_16x16x32_bf16 a[0:3], a[228:231], v[208:211], a[0:3]
  v_exp_f32 v19, v19
  v_mfma_f32_16x16x32_bf16 a[0:3], a[224:227], v[192:195], a[0:3]
  ds_read_b128 a[200:203], v218 offset:49152
  v_cvt_pk_bf16_f32 v66, v16, v17
  v_mfma_f32_16x16x32_bf16 a[16:19], a[232:235], v[192:195], a[16:19]
  v_exp_f32 v24, v24
  v_mfma_f32_16x16x32_bf16 a[16:19], a[236:239], v[208:211], a[16:19]
  ds_read_b128 a[204:207], v219 offset:49152
  v_add_f32 v112, v112, v18
  v_mfma_f32_16x16x32_bf16 a[20:23], a[236:239], v[244:247], a[20:23]
  v_exp_f32 v25, v25
  v_mfma_f32_16x16x32_bf16 a[20:23], a[232:235], v[196:199], a[20:23]
  ds_read_b128 a[208:211], v216 offset:53248
  v_add_f32 v112, v112, v19
  v_mfma_f32_16x16x32_bf16 a[24:27], a[232:235], v[200:203], a[24:27]
  v_exp_f32 v26, v26
  v_mfma_f32_16x16x32_bf16 a[24:27], a[236:239], v[248:251], a[24:27]
  buffer_load_dwordx4 v229, s[44:47], s60 offen offset:1024 lds
  v_mfma_f32_16x16x32_bf16 a[28:31], a[236:239], v[252:255], a[28:31]
  v_exp_f32 v27, v27
  v_mfma_f32_16x16x32_bf16 a[28:31], a[232:235], v[204:207], a[28:31]
  ds_read_b128 a[212:215], v217 offset:53248
  v_cvt_pk_bf16_f32 v67, v18, v19
  v_mfma_f32_16x16x32_bf16 a[44:47], a[240:243], v[204:207], a[44:47]
  v_exp_f32 v20, v20
  v_mfma_f32_16x16x32_bf16 a[44:47], a[244:247], v[252:255], a[44:47]
  ds_read_b128 a[216:219], v218 offset:53248
  v_cvt_pk_bf16_f32 v74, v24, v25
  v_mfma_f32_16x16x32_bf16 a[40:43], a[244:247], v[248:251], a[40:43]
  v_exp_f32 v21, v21
  v_mfma_f32_16x16x32_bf16 a[40:43], a[240:243], v[200:203], a[40:43]
  ds_read_b128 a[220:223], v219 offset:53248
  v_cvt_pk_bf16_f32 v75, v26, v27
  v_mfma_f32_16x16x32_bf16 a[36:39], a[240:243], v[196:199], a[36:39]
  v_exp_f32 v22, v22
  v_mfma_f32_16x16x32_bf16 a[36:39], a[244:247], v[244:247], a[36:39]
  buffer_load_dwordx4 v230, s[44:47], s60 offen offset:2048 lds
  v_mfma_f32_16x16x32_bf16 a[32:35], a[244:247], v[208:211], a[32:35]
  s_waitcnt lgkmcnt(8)
  v_exp_f32 v23, v23
  v_mfma_f32_16x16x32_bf16 a[32:35], a[240:243], v[192:195], a[32:35]
  v_add_f32 v113, v113, v20
  v_add_f32 v113, v113, v21
  v_mfma_f32_16x16x32_bf16 a[48:51], a[248:251], v[192:195], a[48:51]
  v_exp_f32 v28, v28
  v_mfma_f32_16x16x32_bf16 a[48:51], a[252:255], v[208:211], a[48:51]
  v_cvt_pk_bf16_f32 v70, v20, v21
  v_add_f32 v113, v113, v22
  v_mfma_f32_16x16x32_bf16 a[52:55], a[252:255], v[244:247], a[52:55]
  v_exp_f32 v29, v29
  v_mfma_f32_16x16x32_bf16 a[52:55], a[248:251], v[196:199], a[52:55]
  v_add_f32 v113, v113, v23
  v_cvt_pk_bf16_f32 v71, v22, v23
  v_mfma_f32_16x16x32_bf16 a[56:59], a[248:251], v[200:203], a[56:59]
  v_exp_f32 v30, v30
  v_mfma_f32_16x16x32_bf16 a[56:59], a[252:255], v[248:251], a[56:59]
  buffer_load_dwordx4 v231, s[44:47], s60 offen offset:3072 lds
  v_mfma_f32_16x16x32_bf16 a[60:63], a[252:255], v[252:255], a[60:63]
  v_exp_f32 v31, v31
  v_mfma_f32_16x16x32_bf16 a[60:63], a[248:251], v[204:207], a[60:63]
  v_cvt_pk_bf16_f32 v78, v28, v29
  v_cvt_pk_bf16_f32 v79, v30, v31
  v_mfma_f32_16x16x32_bf16 v[120:123], v[124:127], v[204:207], v[120:123]
  s_add_u32 s60, s60, 16384
  v_mfma_f32_16x16x32_bf16 v[120:123], v[124:127], v[252:255], v[120:123]
  s_waitcnt lgkmcnt(0)
  v_mfma_f32_16x16x32_bf16 v[0:3], a[192:195], a[128:131], v[96:99]
  v_exp_f32 v32, v32
  v_mfma_f32_16x16x32_bf16 v[0:3], a[196:199], a[132:135], v[0:3]
  ds_read_b64_tr_b16 a[224:225], v224 offset:49152
  v_add_f32 v112, v112, v32
  v_mfma_f32_16x16x32_bf16 v[0:3], a[200:203], a[136:139], v[0:3]
  v_exp_f32 v33, v33
  v_mfma_f32_16x16x32_bf16 v[0:3], a[204:207], a[140:143], v[0:3]
  ds_read_b64_tr_b16 a[226:227], v224 offset:53248
  v_add_f32 v112, v112, v33
  v_mfma_f32_16x16x32_bf16 v[4:7], a[204:207], a[156:159], v[100:103]
  v_exp_f32 v34, v34
  v_mfma_f32_16x16x32_bf16 v[4:7], a[200:203], a[152:155], v[4:7]
  ds_read_b64_tr_b16 a[228:229], v224 offset:57344
  v_cvt_pk_bf16_f32 v80, v32, v33
  v_mfma_f32_16x16x32_bf16 v[4:7], a[196:199], a[148:151], v[4:7]
  v_exp_f32 v35, v35
  v_mfma_f32_16x16x32_bf16 v[4:7], a[192:195], a[144:147], v[4:7]
  ds_read_b64_tr_b16 a[230:231], v224 offset:61440
  v_add_f32 v112, v112, v34
  v_mfma_f32_16x16x32_bf16 v[8:11], a[192:195], a[160:163], v[104:107]
  v_exp_f32 v40, v40
  v_mfma_f32_16x16x32_bf16 v[8:11], a[196:199], a[164:167], v[8:11]
  ds_read_b64_tr_b16 a[232:233], v225 offset:49152
  v_add_f32 v112, v112, v35
  v_mfma_f32_16x16x32_bf16 v[8:11], a[200:203], a[168:171], v[8:11]
  v_exp_f32 v41, v41
  v_mfma_f32_16x16x32_bf16 v[8:11], a[204:207], a[172:175], v[8:11]
  ds_read_b64_tr_b16 a[234:235], v225 offset:53248
  v_cvt_pk_bf16_f32 v81, v34, v35
  v_mfma_f32_16x16x32_bf16 v[12:15], a[204:207], a[188:191], v[108:111]
  v_exp_f32 v42, v42
  v_mfma_f32_16x16x32_bf16 v[12:15], a[200:203], a[184:187], v[12:15]
  ds_read_b64_tr_b16 a[236:237], v225 offset:57344
  v_cvt_pk_bf16_f32 v88, v40, v41
  v_mfma_f32_16x16x32_bf16 v[12:15], a[196:199], a[180:183], v[12:15]
  v_exp_f32 v43, v43
  v_mfma_f32_16x16x32_bf16 v[12:15], a[192:195], a[176:179], v[12:15]
  ds_read_b64_tr_b16 a[238:239], v225 offset:61440
  v_cvt_pk_bf16_f32 v89, v42, v43
  v_mfma_f32_16x16x32_bf16 v[28:31], a[208:211], a[176:179], v[108:111]
  v_exp_f32 v36, v36
  v_mfma_f32_16x16x32_bf16 v[28:31], a[212:215], a[180:183], v[28:31]
  ds_read_b64_tr_b16 a[240:241], v226 offset:49152
  v_add_f32 v113, v113, v36
  v_mfma_f32_16x16x32_bf16 v[28:31], a[216:219], a[184:187], v[28:31]
  v_exp_f32 v37, v37
  v_mfma_f32_16x16x32_bf16 v[28:31], a[220:223], a[188:191], v[28:31]
  ds_read_b64_tr_b16 a[242:243], v226 offset:53248
  v_add_f32 v113, v113, v37
  v_mfma_f32_16x16x32_bf16 v[24:27], a[220:223], a[172:175], v[104:107]
  v_exp_f32 v38, v38
  v_mfma_f32_16x16x32_bf16 v[24:27], a[216:219], a[168:171], v[24:27]
  ds_read_b64_tr_b16 a[244:245], v226 offset:57344
  v_cvt_pk_bf16_f32 v84, v36, v37
  v_mfma_f32_16x16x32_bf16 v[24:27], a[212:215], a[164:167], v[24:27]
  v_exp_f32 v39, v39
  v_mfma_f32_16x16x32_bf16 v[24:27], a[208:211], a[160:163], v[24:27]
  ds_read_b64_tr_b16 a[246:247], v226 offset:61440
  v_add_f32 v113, v113, v38
  v_mfma_f32_16x16x32_bf16 v[20:23], a[208:211], a[144:147], v[100:103]
  v_exp_f32 v44, v44
  v_mfma_f32_16x16x32_bf16 v[20:23], a[212:215], a[148:151], v[20:23]
  ds_read_b64_tr_b16 a[248:249], v227 offset:49152
  v_add_f32 v113, v113, v39
  v_mfma_f32_16x16x32_bf16 v[20:23], a[216:219], a[152:155], v[20:23]
  v_exp_f32 v45, v45
  v_mfma_f32_16x16x32_bf16 v[20:23], a[220:223], a[156:159], v[20:23]
  ds_read_b64_tr_b16 a[250:251], v227 offset:53248
  v_cvt_pk_bf16_f32 v85, v38, v39
  v_mfma_f32_16x16x32_bf16 v[16:19], a[220:223], a[140:143], v[96:99]
  v_exp_f32 v46, v46
  v_mfma_f32_16x16x32_bf16 v[16:19], a[216:219], a[136:139], v[16:19]
  ds_read_b64_tr_b16 a[252:253], v227 offset:57344
  v_cvt_pk_bf16_f32 v92, v44, v45
  v_mfma_f32_16x16x32_bf16 v[16:19], a[212:215], a[132:135], v[16:19]
  s_waitcnt lgkmcnt(3)
  v_exp_f32 v47, v47
  v_mfma_f32_16x16x32_bf16 v[16:19], a[208:211], a[128:131], v[16:19]
  ds_read_b64_tr_b16 a[254:255], v227 offset:61440
  v_cvt_pk_bf16_f32 v93, v46, v47
  v_mfma_f32_16x16x32_bf16 a[76:79], a[224:227], v[204:207], a[76:79]
  s_add_u32 m0, s64, 32768
  v_exp_f32 v48, v48
  v_mfma_f32_16x16x32_bf16 a[76:79], a[228:231], v[252:255], a[76:79]
  ds_read_b128 a[192:195], v216 offset:57344
  v_add_f32 v112, v112, v48
  v_mfma_f32_16x16x32_bf16 a[72:75], a[228:231], v[248:251], a[72:75]
  v_exp_f32 v49, v49
  v_mfma_f32_16x16x32_bf16 a[72:75], a[224:227], v[200:203], a[72:75]
  ds_read_b128 a[196:199], v217 offset:57344
  v_add_f32 v112, v112, v49
  v_mfma_f32_16x16x32_bf16 a[68:71], a[224:227], v[196:199], a[68:71]
  v_exp_f32 v50, v50
  v_mfma_f32_16x16x32_bf16 a[68:71], a[228:231], v[244:247], a[68:71]
  buffer_load_dwordx4 v232, s[48:51], s61 offen offset:0 lds
  v_mfma_f32_16x16x32_bf16 a[64:67], a[228:231], v[208:211], a[64:67]
  v_exp_f32 v51, v51
  v_mfma_f32_16x16x32_bf16 a[64:67], a[224:227], v[192:195], a[64:67]
  ds_read_b128 a[200:203], v218 offset:57344
  v_cvt_pk_bf16_f32 v82, v48, v49
  v_mfma_f32_16x16x32_bf16 a[80:83], a[232:235], v[192:195], a[80:83]
  v_exp_f32 v56, v56
  v_mfma_f32_16x16x32_bf16 a[80:83], a[236:239], v[208:211], a[80:83]
  ds_read_b128 a[204:207], v219 offset:57344
  v_add_f32 v112, v112, v50
  v_mfma_f32_16x16x32_bf16 a[84:87], a[236:239], v[244:247], a[84:87]
  v_exp_f32 v57, v57
  v_mfma_f32_16x16x32_bf16 a[84:87], a[232:235], v[196:199], a[84:87]
  ds_read_b128 a[208:211], v216 offset:61440
  v_add_f32 v112, v112, v51
  v_mfma_f32_16x16x32_bf16 a[88:91], a[232:235], v[200:203], a[88:91]
  v_exp_f32 v58, v58
  v_mfma_f32_16x16x32_bf16 a[88:91], a[236:239], v[248:251], a[88:91]
  buffer_load_dwordx4 v233, s[48:51], s61 offen offset:1024 lds
  v_mfma_f32_16x16x32_bf16 a[92:95], a[236:239], v[252:255], a[92:95]
  v_exp_f32 v59, v59
  v_mfma_f32_16x16x32_bf16 a[92:95], a[232:235], v[204:207], a[92:95]
  ds_read_b128 a[212:215], v217 offset:61440
  v_cvt_pk_bf16_f32 v83, v50, v51
  v_mfma_f32_16x16x32_bf16 a[108:111], a[240:243], v[204:207], a[108:111]
  v_exp_f32 v52, v52
  v_mfma_f32_16x16x32_bf16 a[108:111], a[244:247], v[252:255], a[108:111]
  ds_read_b128 a[216:219], v218 offset:61440
  v_cvt_pk_bf16_f32 v90, v56, v57
  v_mfma_f32_16x16x32_bf16 a[104:107], a[244:247], v[248:251], a[104:107]
  v_exp_f32 v53, v53
  v_mfma_f32_16x16x32_bf16 a[104:107], a[240:243], v[200:203], a[104:107]
  ds_read_b128 a[220:223], v219 offset:61440
  v_cvt_pk_bf16_f32 v91, v58, v59
  v_mfma_f32_16x16x32_bf16 a[100:103], a[240:243], v[196:199], a[100:103]
  v_exp_f32 v54, v54
  v_mfma_f32_16x16x32_bf16 a[100:103], a[244:247], v[244:247], a[100:103]
  buffer_load_dwordx4 v232, s[48:51], s61 offen offset:2048 lds
  v_mfma_f32_16x16x32_bf16 a[96:99], a[244:247], v[208:211], a[96:99]
  s_waitcnt lgkmcnt(8)
  v_exp_f32 v55, v55
  v_mfma_f32_16x16x32_bf16 a[96:99], a[240:243], v[192:195], a[96:99]
  v_add_f32 v113, v113, v52
  v_add_f32 v113, v113, v53
  v_mfma_f32_16x16x32_bf16 a[112:115], a[248:251], v[192:195], a[112:115]
  v_exp_f32 v60, v60
  v_mfma_f32_16x16x32_bf16 a[112:115], a[252:255], v[208:211], a[112:115]
  v_cvt_pk_bf16_f32 v86, v52, v53
  v_add_f32 v113, v113, v54
  v_mfma_f32_16x16x32_bf16 a[116:119], a[252:255], v[244:247], a[116:119]
  v_exp_f32 v61, v61
  v_mfma_f32_16x16x32_bf16 a[116:119], a[248:251], v[196:199], a[116:119]
  v_add_f32 v113, v113, v55
  v_cvt_pk_bf16_f32 v87, v54, v55
  v_mfma_f32_16x16x32_bf16 a[120:123], a[248:251], v[200:203], a[120:123]
  v_exp_f32 v62, v62
  v_mfma_f32_16x16x32_bf16 a[120:123], a[252:255], v[248:251], a[120:123]
  buffer_load_dwordx4 v233, s[48:51], s61 offen offset:3072 lds
  v_mfma_f32_16x16x32_bf16 a[124:127], a[252:255], v[252:255], a[124:127]
  v_exp_f32 v63, v63
  v_mfma_f32_16x16x32_bf16 a[124:127], a[248:251], v[204:207], a[124:127]
  v_cvt_pk_bf16_f32 v94, v60, v61
  v_cvt_pk_bf16_f32 v95, v62, v63
  v_mfma_f32_16x16x32_bf16 v[116:119], v[124:127], v[200:203], v[116:119]
  s_add_u32 s61, s61, 16384
  v_mfma_f32_16x16x32_bf16 v[116:119], v[124:127], v[248:251], v[116:119]
L_p2:
L_pad1:
  s_cbranch_execz L_pad5
  s_waitcnt vmcnt(16) lgkmcnt(0)
  s_barrier
  v_mfma_f32_16x16x32_bf16 v[32:35], a[192:195], a[128:131], v[96:99]
  v_exp_f32 v0, v0
  v_mfma_f32_16x16x32_bf16 v[32:35], a[196:199], a[132:135], v[32:35]
  ds_read_b64_tr_b16 a[224:225], v220 offset:0
  v_add_f32 v112, v112, v0
  v_mfma_f32_16x16x32_bf16 v[32:35], a[200:203], a[136:139], v[32:35]
  v_exp_f32 v1, v1
  v_mfma_f32_16x16x32_bf16 v[32:35], a[204:207], a[140:143], v[32:35]
  ds_read_b64_tr_b16 a[226:227], v220 offset:4096
  v_add_f32 v112, v112, v1
  v_mfma_f32_16x16x32_bf16 v[36:39], a[204:207], a[156:159], v[100:103]
  v_exp_f32 v2, v2
  v_mfma_f32_16x16x32_bf16 v[36:39], a[200:203], a[152:155], v[36:39]
  ds_read_b64_tr_b16 a[228:229], v220 offset:8192
  v_cvt_pk_bf16_f32 v192, v0, v1
  v_mfma_f32_16x16x32_bf16 v[36:39], a[196:199], a[148:151], v[36:39]
  v_exp_f32 v3, v3
  v_mfma_f32_16x16x32_bf16 v[36:39], a[192:195], a[144:147], v[36:39]
  ds_read_b64_tr_b16 a[230:231], v220 offset:12288
  v_add_f32 v112, v112, v2
  v_mfma_f32_16x16x32_bf16 v[40:43], a[192:195], a[160:163], v[104:107]
  v_exp_f32 v8, v8
  v_mfma_f32_16x16x32_bf16 v[40:43], a[196:199], a[164:167], v[40:43]
  ds_read_b64_tr_b16 a[232:233], v221 offset:0
  v_add_f32 v112, v112, v3
  v_mfma_f32_16x16x32_bf16 v[40:43], a[200:203], a[168:171], v[40:43]
  v_exp_f32 v9, v9
  v_mfma_f32_16x16x32_bf16 v[40:43], a[204:207], a[172:175], v[40:43]
  ds_read_b64_tr_b16 a[234:235], v221 offset:4096
  v_cvt_pk_bf16_f32 v193, v2, v3
  v_mfma_f32_16x16x32_bf16 v[44:47], a[204:207], a[188:191], v[108:111]
  v_exp_f32 v10, v10
  v_mfma_f32_16x16x32_bf16 v[44:47], a[200:203], a[184:187], v[44:47]
  ds_read_b64_tr_b16 a[236:237], v221 offset:8192
  v_cvt_pk_bf16_f32 v200, v8, v9
  v_mfma_f32_16x16x32_bf16 v[44:47], a[196:199], a[180:183], v[44:47]
  v_exp_f32 v11, v11
  v_mfma_f32_16x16x32_bf16 v[44:47], a[192:195], a[176:179], v[44:47]
  ds_read_b64_tr_b16 a[238:239], v221 offset:12288
  v_cvt_pk_bf16_f32 v201, v10, v11
  v_mfma_f32_16x16x32_bf16 v[60:63], a[208:211], a[176:179], v[108:111]
  v_exp_f32 v4, v4
  v_mfma_f32_16x16x32_bf16 v[60:63], a[212:215], a[180:183], v[60:63]
  ds_read_b64_tr_b16 a[240:241], v222 offset:0
  v_add_f32 v113, v113, v4
  v_mfma_f32_16x16x32_bf16 v[60:63], a[216:219], a[184:187], v[60:63]
  v_exp_f32 v5, v5
  v_mfma_f32_16x16x32_bf16 v[60:63], a[220:223], a[188:191], v[60:63]
  ds_read_b64_tr_b16 a[242:243], v222 offset:4096
  v_add_f32 v113, v113, v5
  v_mfma_f32_16x16x32_bf16 v[56:59], a[220:223], a[172:175], v[104:107]
  v_exp_f32 v6, v6
  v_mfma_f32_16x16x32_bf16 v[56:59], a[216:219], a[168:171], v[56:59]
  ds_read_b64_tr_b16 a[244:245], v222 offset:8192
  v_cvt_pk_bf16_f32 v196, v4, v5
  v_mfma_f32_16x16x32_bf16 v[56:59], a[212:215], a[164:167], v[56:59]
  v_exp_f32 v7, v7
  v_mfma_f32_16x16x32_bf16 v[56:59], a[208:211], a[160:163], v[56:59]
  ds_read_b64_tr_b16 a[246:247], v222 offset:12288
  v_add_f32 v113, v113, v6
  v_mfma_f32_16x16x32_bf16 v[52:55], a[208:211], a[144:147], v[100:103]
  v_exp_f32 v12, v12
  v_mfma_f32_16x16x32_bf16 v[52:55], a[212:215], a[148:151], v[52:55]
  ds_read_b64_tr_b16 a[248:249], v223 offset:0
  v_add_f32 v113, v113, v7
  v_mfma_f32_16x16x32_bf16 v[52:55], a[216:219], a[152:155], v[52:55]
  v_exp_f32 v13, v13
  v_mfma_f32_16x16x32_bf16 v[52:55], a[220:223], a[156:159], v[52:55]
  ds_read_b64_tr_b16 a[250:251], v223 offset:4096
  v_cvt_pk_bf16_f32 v197, v6, v7
  v_mfma_f32_16x16x32_bf16 v[48:51], a[220:223], a[140:143], v[96:99]
  v_exp_f32 v14, v14
  v_mfma_f32_16x16x32_bf16 v[48:51], a[216:219], a[136:139], v[48:51]
  ds_read_b64_tr_b16 a[252:253], v223 offset:8192
  v_cvt_pk_bf16_f32 v204, v12, v13
  v_mfma_f32_16x16x32_bf16 v[48:51], a[212:215], a[132:135], v[48:51]
  s_waitcnt lgkmcnt(3)
  v_exp_f32 v15, v15
  v_mfma_f32_16x16x32_bf16 v[48:51], a[208:211], a[128:131], v[48:51]
  ds_read_b64_tr_b16 a[254:255], v223 offset:12288
  v_cvt_pk_bf16_f32 v205, v14, v15
  v_mfma_f32_16x16x32_bf16 a[12:15], a[224:227], v[76:79], a[12:15]
  s_add_u32 m0, s63, 49152
  v_exp_f32 v16, v16
  v_mfma_f32_16x16x32_bf16 a[12:15], a[228:231], v[92:95], a[12:15]
  ds_read_b128 a[192:195], v216 offset:0
  v_add_f32 v112, v112, v16
  v_mfma_f32_16x16x32_bf16 a[8:11], a[228:231], v[88:91], a[8:11]
  v_exp_f32 v17, v17
  v_mfma_f32_16x16x32_bf16 a[8:11], a[224:227], v[72:75], a[8:11]
  ds_read_b128 a[196:199], v217 offset:0
  v_add_f32 v112, v112, v17
  v_mfma_f32_16x16x32_bf16 a[4:7], a[224:227], v[68:71], a[4:7]
  v_exp_f32 v18, v18
  v_mfma_f32_16x16x32_bf16 a[4:7], a[228:231], v[84:87], a[4:7]
  buffer_load_dwordx4 v228, s[44:47], s60 offen offset:0 lds
  v_mfma_f32_16x16x32_bf16 a[0:3], a[228:231], v[80:83], a[0:3]
  v_exp_f32 v19, v19
  v_mfma_f32_16x16x32_bf16 a[0:3], a[224:227], v[64:67], a[0:3]
  ds_read_b128 a[200:203], v218 offset:0
  v_cvt_pk_bf16_f32 v194, v16, v17
  v_mfma_f32_16x16x32_bf16 a[16:19], a[232:235], v[64:67], a[16:19]
  v_exp_f32 v24, v24
  v_mfma_f32_16x16x32_bf16 a[16:19], a[236:239], v[80:83], a[16:19]
  ds_read_b128 a[204:207], v219 offset:0
  v_add_f32 v112, v112, v18
  v_mfma_f32_16x16x32_bf16 a[20:23], a[236:239], v[84:87], a[20:23]
  v_exp_f32 v25, v25
  v_mfma_f32_16x16x32_bf16 a[20:23], a[232:235], v[68:71], a[20:23]
  ds_read_b128 a[208:211], v216 offset:4096
  v_add_f32 v112, v112, v19
  v_mfma_f32_16x16x32_bf16 a[24:27], a[232:235], v[72:75], a[24:27]
  v_exp_f32 v26, v26
  v_mfma_f32_16x16x32_bf16 a[24:27], a[236:239], v[88:91], a[24:27]
  buffer_load_dwordx4 v229, s[44:47], s60 offen offset:1024 lds
  v_mfma_f32_16x16x32_bf16 a[28:31], a[236:239], v[92:95], a[28:31]
  v_exp_f32 v27, v27
  v_mfma_f32_16x16x32_bf16 a[28:31], a[232:235], v[76:79], a[28:31]
  ds_read_b128 a[212:215], v217 offset:4096
  v_cvt_pk_bf16_f32 v195, v18, v19
  v_mfma_f32_16x16x32_bf16 a[44:47], a[240:243], v[76:79], a[44:47]
  v_exp_f32 v20, v20
  v_mfma_f32_16x16x32_bf16 a[44:47], a[244:247], v[92:95], a[44:47]
  ds_read_b128 a[216:219], v218 offset:4096
  v_cvt_pk_bf16_f32 v202, v24, v25
  v_mfma_f32_16x16x32_bf16 a[40:43], a[244:247], v[88:91], a[40:43]
  v_exp_f32 v21, v21
  v_mfma_f32_16x16x32_bf16 a[40:43], a[240:243], v[72:75], a[40:43]
  ds_read_b128 a[220:223], v219 offset:4096
  v_cvt_pk_bf16_f32 v203, v26, v27
  v_mfma_f32_16x16x32_bf16 a[36:39], a[240:243], v[68:71], a[36:39]
  v_exp_f32 v22, v22
  v_mfma_f32_16x16x32_bf16 a[36:39], a[244:247], v[84:87], a[36:39]
  buffer_load_dwordx4 v230, s[44:47], s60 offen offset:2048 lds
  v_mfma_f32_16x16x32_bf16 a[32:35], a[244:247], v[80:83], a[32:35]
  s_waitcnt lgkmcnt(8)
  v_exp_f32 v23, v23
  v_mfma_f32_16x16x32_bf16 a[32:35], a[240:243], v[64:67], a[32:35]
  v_add_f32 v113, v113, v20
  v_add_f32 v113, v113, v21
  v_mfma_f32_16x16x32_bf16 a[48:51], a[248:251], v[64:67], a[48:51]
  v_exp_f32 v28, v28
  v_mfma_f32_16x16x32_bf16 a[48:51], a[252:255], v[80:83], a[48:51]
  v_cvt_pk_bf16_f32 v198, v20, v21
  v_add_f32 v113, v113, v22
  v_mfma_f32_16x16x32_bf16 a[52:55], a[252:255], v[84:87], a[52:55]
  v_exp_f32 v29, v29
  v_mfma_f32_16x16x32_bf16 a[52:55], a[248:251], v[68:71], a[52:55]
  v_add_f32 v113, v113, v23
  v_cvt_pk_bf16_f32 v199, v22, v23
  v_mfma_f32_16x16x32_bf16 a[56:59], a[248:251], v[72:75], a[56:59]
  v_exp_f32 v30, v30
  v_mfma_f32_16x16x32_bf16 a[56:59], a[252:255], v[88:91], a[56:59]
  buffer_load_dwordx4 v231, s[44:47], s60 offen offset:3072 lds
  v_mfma_f32_16x16x32_bf16 a[60:63], a[252:255], v[92:95], a[60:63]
  v_exp_f32 v31, v31
  v_mfma_f32_16x16x32_bf16 a[60:63], a[248:251], v[76:79], a[60:63]
  v_cvt_pk_bf16_f32 v206, v28, v29
  v_cvt_pk_bf16_f32 v207, v30, v31
  v_mfma_f32_16x16x32_bf16 v[120:123], v[124:127], v[76:79], v[120:123]
  s_add_u32 s60, s60, 16384
  v_mfma_f32_16x16x32_bf16 v[120:123], v[124:127], v[92:95], v[120:123]
  s_waitcnt lgkmcnt(0)
  v_mfma_f32_16x16x32_bf16 v[0:3], a[192:195], a[128:131], v[96:99]
  v_exp_f32 v32, v32
  v_mfma_f32_16x16x32_bf16 v[0:3], a[196:199], a[132:135], v[0:3]
  ds_read_b64_tr_b16 a[224:225], v224 offset:0
  v_add_f32 v112, v112, v32
  v_mfma_f32_16x16x32_bf16 v[0:3], a[200:203], a[136:139], v[0:3]
  v_exp_f32 v33, v33
  v_mfma_f32_16x16x32_bf16 v[0:3], a[204:207], a[140:143], v[0:3]
  ds_read_b64_tr_b16 a[226:227], v224 offset:4096
  v_add_f32 v112, v112, v33
  v_mfma_f32_16x16x32_bf16 v[4:7], a[204:207], a[156:159], v[100:103]
  v_exp_f32 v34, v34
  v_mfma_f32_16x16x32_bf16 v[4:7], a[200:203], a[152:155], v[4:7]
  ds_read_b64_tr_b16 a[228:229], v224 offset:8192
  v_cvt_pk_bf16_f32 v208, v32, v33
  v_mfma_f32_16x16x32_bf16 v[4:7], a[196:199], a[148:151], v[4:7]
  v_exp_f32 v35, v35
  v_mfma_f32_16x16x32_bf16 v[4:7], a[192:195], a[144:147], v[4:7]
  ds_read_b64_tr_b16 a[230:231], v224 offset:12288
  v_add_f32 v112, v112, v34
  v_mfma_f32_16x16x32_bf16 v[8:11], a[192:195], a[160:163], v[104:107]
  v_exp_f32 v40, v40
  v_mfma_f32_16x16x32_bf16 v[8:11], a[196:199], a[164:167], v[8:11]
  ds_read_b64_tr_b16 a[232:233], v225 offset:0
  v_add_f32 v112, v112, v35
  v_mfma_f32_16x16x32_bf16 v[8:11], a[200:203], a[168:171], v[8:11]
  v_exp_f32 v41, v41
  v_mfma_f32_16x16x32_bf16 v[8:11], a[204:207], a[172:175], v[8:11]
  ds_read_b64_tr_b16 a[234:235], v225 offset:4096
  v_cvt_pk_bf16_f32 v209, v34, v35
  v_mfma_f32_16x16x32_bf16 v[12:15], a[204:207], a[188:191], v[108:111]
  v_exp_f32 v42, v42
  v_mfma_f32_16x16x32_bf16 v[12:15], a[200:203], a[184:187], v[12:15]
  ds_read_b64_tr_b16 a[236:237], v225 offset:8192
  v_cvt_pk_bf16_f32 v248, v40, v41
  v_mfma_f32_16x16x32_bf16 v[12:15], a[196:199], a[180:183], v[12:15]
  v_exp_f32 v43, v43
  v_mfma_f32_16x16x32_bf16 v[12:15], a[192:195], a[176:179], v[12:15]
  ds_read_b64_tr_b16 a[238:239], v225 offset:12288
  v_cvt_pk_bf16_f32 v249, v42, v43
  v_mfma_f32_16x16x32_bf16 v[28:31], a[208:211], a[176:179], v[108:111]
  v_exp_f32 v36, v36
  v_mfma_f32_16x16x32_bf16 v[28:31], a[212:215], a[180:183], v[28:31]
  ds_read_b64_tr_b16 a[240:241], v226 offset:0
  v_add_f32 v113, v113, v36
  v_mfma_f32_16x16x32_bf16 v[28:31], a[216:219], a[184:187], v[28:31]
  v_exp_f32 v37, v37
  v_mfma_f32_16x16x32_bf16 v[28:31], a[220:223], a[188:191], v[28:31]
  ds_read_b64_tr_b16 a[242:243], v226 offset:4096
  v_add_f32 v113, v113, v37
  v_mfma_f32_16x16x32_bf16 v[24:27], a[220:223], a[172:175], v[104:107]
  v_exp_f32 v38, v38
  v_mfma_f32_16x16x32_bf16 v[24:27], a[216:219], a[168:171], v[24:27]
  ds_read_b64_tr_b16 a[244:245], v226 offset:8192
  v_cvt_pk_bf16_f32 v244, v36, v37
  v_mfma_f32_16x16x32_bf16 v[24:27], a[212:215], a[164:167], v[24:27]
  v_exp_f32 v39, v39
  v_mfma_f32_16x16x32_bf16 v[24:27], a[208:211], a[160:163], v[24:27]
  ds_read_b64_tr_b16 a[246:247], v226 offset:12288
  v_add_f32 v113, v113, v38
  v_mfma_f32_16x16x32_bf16 v[20:23], a[208:211], a[144:147], v[100:103]
  v_exp_f32 v44, v44
  v_mfma_f32_16x16x32_bf16 v[20:23], a[212:215], a[148:151], v[20:23]
  ds_read_b64_tr_b16 a[248:249], v227 offset:0
  v_add_f32 v113, v113, v39
  v_mfma_f32_16x16x32_bf16 v[20:23], a[216:219], a[152:155], v[20:23]
  v_exp_f32 v45, v45
  v_mfma_f32_16x16x32_bf16 v[20:23], a[220:223], a[156:159], v[20:23]
  ds_read_b64_tr_b16 a[250:251], v227 offset:4096
  v_cvt_pk_bf16_f32 v245, v38, v39
  v_mfma_f32_16x16x32_bf16 v[16:19], a[220:223], a[140:143], v[96:99]
  v_exp_f32 v46, v46
  v_mfma_f32_16x16x32_bf16 v[16:19], a[216:219], a[136:139], v[16:19]
  ds_read_b64_tr_b16 a[252:253], v227 offset:8192
  v_cvt_pk_bf16_f32 v252, v44, v45
  v_mfma_f32_16x16x32_bf16 v[16:19], a[212:215], a[132:135], v[16:19]
  s_waitcnt lgkmcnt(3)
  v_exp_f32 v47, v47
  v_mfma_f32_16x16x32_bf16 v[16:19], a[208:211], a[128:131], v[16:19]
  ds_read_b64_tr_b16 a[254:255], v227 offset:12288
  v_cvt_pk_bf16_f32 v253, v46, v47
  v_mfma_f32_16x16x32_bf16 a[76:79], a[224:227], v[76:79], a[76:79]
  s_add_u32 m0, s64, 49152
  v_exp_f32 v48, v48
  v_mfma_f32_16x16x32_bf16 a[76:79], a[228:231], v[92:95], a[76:79]
  ds_read_b128 a[192:195], v216 offset:8192
  v_add_f32 v112, v112, v48
  v_mfma_f32_16x16x32_bf16 a[72:75], a[228:231], v[88:91], a[72:75]
  v_exp_f32 v49, v49
  v_mfma_f32_16x16x32_bf16 a[72:75], a[224:227], v[72:75], a[72:75]
  ds_read_b128 a[196:199], v217 offset:8192
  v_add_f32 v112, v112, v49
  v_mfma_f32_16x16x32_bf16 a[68:71], a[224:227], v[68:71], a[68:71]
  v_exp_f32 v50, v50
  v_mfma_f32_16x16x32_bf16 a[68:71], a[228:231], v[84:87], a[68:71]
  buffer_load_dwordx4 v232, s[48:51], s61 offen offset:0 lds
  v_mfma_f32_16x16x32_bf16 a[64:67], a[228:231], v[80:83], a[64:67]
  v_exp_f32 v51, v51
  v_mfma_f32_16x16x32_bf16 a[64:67], a[224:227], v[64:67], a[64:67]
  ds_read_b128 a[200:203], v218 offset:8192
  v_cvt_pk_bf16_f32 v210, v48, v49
  v_mfma_f32_16x16x32_bf16 a[80:83], a[232:235], v[64:67], a[80:83]
  v_exp_f32 v56, v56
  v_mfma_f32_16x16x32_bf16 a[80:83], a[236:239], v[80:83], a[80:83]
  ds_read_b128 a[204:207], v219 offset:8192
  v_add_f32 v112, v112, v50
  v_mfma_f32_16x16x32_bf16 a[84:87], a[236:239], v[84:87], a[84:87]
  v_exp_f32 v57, v57
  v_mfma_f32_16x16x32_bf16 a[84:87], a[232:235], v[68:71], a[84:87]
  ds_read_b128 a[208:211], v216 offset:12288
  v_add_f32 v112, v112, v51
  v_mfma_f32_16x16x32_bf16 a[88:91], a[232:235], v[72:75], a[88:91]
  v_exp_f32 v58, v58
  v_mfma_f32_16x16x32_bf16 a[88:91], a[236:239], v[88:91], a[88:91]
  buffer_load_dwordx4 v233, s[48:51], s61 offen offset:1024 lds
  v_mfma_f32_16x16x32_bf16 a[92:95], a[236:239], v[92:95], a[92:95]
L_pad2:
  s_cbranch_execz L_pad6
  v_exp_f32 v59, v59
  v_mfma_f32_16x16x32_bf16 a[92:95], a[232:235], v[76:79], a[92:95]
  ds_read_b128 a[212:215], v217 offset:12288
  v_cvt_pk_bf16_f32 v211, v50, v51
  v_mfma_f32_16x16x32_bf16 a[108:111], a[240:243], v[76:79], a[108:111]
  v_exp_f32 v52, v52
  v_mfma_f32_16x16x32_bf16 a[108:111], a[244:247], v[92:95], a[108:111]
  ds_read_b128 a[216:219], v218 offset:12288
  v_cvt_pk_bf16_f32 v250, v56, v57
  v_mfma_f32_16x16x32_bf16 a[104:107], a[244:247], v[88:91], a[104:107]
  v_exp_f32 v53, v53
  v_mfma_f32_16x16x32_bf16 a[104:107], a[240:243], v[72:75], a[104:107]
  ds_read_b128 a[220:223], v219 offset:12288
  v_cvt_pk_bf16_f32 v251, v58, v59
  v_mfma_f32_16x16x32_bf16 a[100:103], a[240:243], v[68:71], a[100:103]
  v_exp_f32 v54, v54
  v_mfma_f32_16x16x32_bf16 a[100:103], a[244:247], v[84:87], a[100:103]
  buffer_load_dwordx4 v232, s[48:51], s61 offen offset:2048 lds
  v_mfma_f32_16x16x32_bf16 a[96:99], a[244:247], v[80:83], a[96:99]
  s_waitcnt lgkmcnt(8)
  v_exp_f32 v55, v55
  v_mfma_f32_16x16x32_bf16 a[96:99], a[240:243], v[64:67], a[96:99]
  v_add_f32 v113, v113, v52
  v_add_f32 v113, v113, v53
  v_mfma_f32_16x16x32_bf16 a[112:115], a[248:251], v[64:67], a[112:115]
  v_exp_f32 v60, v60
  v_mfma_f32_16x16x32_bf16 a[112:115], a[252:255], v[80:83], a[112:115]
  v_cvt_pk_bf16_f32 v246, v52, v53
  v_add_f32 v113, v113, v54
  v_mfma_f32_16x16x32_bf16 a[116:119], a[252:255], v[84:87], a[116:119]
  v_exp_f32 v61, v61
  v_mfma_f32_16x16x32_bf16 a[116:119], a[248:251], v[68:71], a[116:119]
  v_add_f32 v113, v113, v55
  v_cvt_pk_bf16_f32 v247, v54, v55
  v_mfma_f32_16x16x32_bf16 a[120:123], a[248:251], v[72:75], a[120:123]
  v_exp_f32 v62, v62
  v_mfma_f32_16x16x32_bf16 a[120:123], a[252:255], v[88:91], a[120:123]
  buffer_load_dwordx4 v233, s[48:51], s61 offen offset:3072 lds
  v_mfma_f32_16x16x32_bf16 a[124:127], a[252:255], v[92:95], a[124:127]
  v_exp_f32 v63, v63
  v_mfma_f32_16x16x32_bf16 a[124:127], a[248:251], v[76:79], a[124:127]
  v_cvt_pk_bf16_f32 v254, v60, v61
  v_cvt_pk_bf16_f32 v255, v62, v63
  v_mfma_f32_16x16x32_bf16 v[116:119], v[124:127], v[72:75], v[116:119]
  s_add_u32 s61, s61, 16384
  v_mfma_f32_16x16x32_bf16 v[116:119], v[124:127], v[88:91], v[116:119]
  s_waitcnt vmcnt(16) lgkmcnt(0)
  s_barrier
  v_mfma_f32_16x16x32_bf16 v[32:35], a[192:195], a[128:131], v[96:99]
  v_exp_f32 v0, v0
  v_mfma_f32_16x16x32_bf16 v[32:35], a[196:199], a[132:135], v[32:35]
  ds_read_b64_tr_b16 a[224:225], v220 offset:16384
  v_add_f32 v112, v112, v0
  v_mfma_f32_16x16x32_bf16 v[32:35], a[200:203], a[136:139], v[32:35]
  v_exp_f32 v1, v1
  v_mfma_f32_16x16x32_bf16 v[32:35], a[204:207], a[140:143], v[32:35]
  ds_read_b64_tr_b16 a[226:227], v220 offset:20480
  v_add_f32 v112, v112, v1
  v_mfma_f32_16x16x32_bf16 v[36:39], a[204:207], a[156:159], v[100:103]
  v_exp_f32 v2, v2
  v_mfma_f32_16x16x32_bf16 v[36:39], a[200:203], a[152:155], v[36:39]
  ds_read_b64_tr_b16 a[228:229], v220 offset:24576
  v_cvt_pk_bf16_f32 v64, v0, v1
  v_mfma_f32_16x16x32_bf16 v[36:39], a[196:199], a[148:151], v[36:39]
  v_exp_f32 v3, v3
  v_mfma_f32_16x16x32_bf16 v[36:39], a[192:195], a[144:147], v[36:39]
  ds_read_b64_tr_b16 a[230:231], v220 offset:28672
  v_add_f32 v112, v112, v2
  v_mfma_f32_16x16x32_bf16 v[40:43], a[192:195], a[160:163], v[104:107]
  v_exp_f32 v8, v8
  v_mfma_f32_16x16x32_bf16 v[40:43], a[196:199], a[164:167], v[40:43]
  ds_read_b64_tr_b16 a[232:233], v221 offset:16384
  v_add_f32 v112, v112, v3
  v_mfma_f32_16x16x32_bf16 v[40:43], a[200:203], a[168:171], v[40:43]
  v_exp_f32 v9, v9
  v_mfma_f32_16x16x32_bf16 v[40:43], a[204:207], a[172:175], v[40:43]
  ds_read_b64_tr_b16 a[234:235], v221 offset:20480
  v_cvt_pk_bf16_f32 v65, v2, v3
  v_mfma_f32_16x16x32_bf16 v[44:47], a[204:207], a[188:191], v[108:111]
  v_exp_f32 v10, v10
  v_mfma_f32_16x16x32_bf16 v[44:47], a[200:203], a[184:187], v[44:47]
  ds_read_b64_tr_b16 a[236:237], v221 offset:24576
  v_cvt_pk_bf16_f32 v72, v8, v9
  v_mfma_f32_16x16x32_bf16 v[44:47], a[196:199], a[180:183], v[44:47]
  v_exp_f32 v11, v11
  v_mfma_f32_16x16x32_bf16 v[44:47], a[192:195], a[176:179], v[44:47]
  ds_read_b64_tr_b16 a[238:239], v221 offset:28672
  v_cvt_pk_bf16_f32 v73, v10, v11
  v_mfma_f32_16x16x32_bf16 v[60:63], a[208:211], a[176:179], v[108:111]
  v_exp_f32 v4, v4
  v_mfma_f32_16x16x32_bf16 v[60:63], a[212:215], a[180:183], v[60:63]
  ds_read_b64_tr_b16 a[240:241], v222 offset:16384
  v_add_f32 v113, v113, v4
  v_mfma_f32_16x16x32_bf16 v[60:63], a[216:219], a[184:187], v[60:63]
  v_exp_f32 v5, v5
  v_mfma_f32_16x16x32_bf16 v[60:63], a[220:223], a[188:191], v[60:63]
  ds_read_b64_tr_b16 a[242:243], v222 offset:20480
  v_add_f32 v113, v113, v5
  v_mfma_f32_16x16x32_bf16 v[56:59], a[220:223], a[172:175], v[104:107]
  v_exp_f32 v6, v6
  v_mfma_f32_16x16x32_bf16 v[56:59], a[216:219], a[168:171], v[56:59]
  ds_read_b64_tr_b16 a[244:245], v222 offset:24576
  v_cvt_pk_bf16_f32 v68, v4, v5
  v_mfma_f32_16x16x32_bf16 v[56:59], a[212:215], a[164:167], v[56:59]
  v_exp_f32 v7, v7
  v_mfma_f32_16x16x32_bf16 v[56:59], a[208:211], a[160:163], v[56:59]
  ds_read_b64_tr_b16 a[246:247], v222 offset:28672
  v_add_f32 v113, v113, v6
  v_mfma_f32_16x16x32_bf16 v[52:55], a[208:211], a[144:147], v[100:103]
  v_exp_f32 v12, v12
  v_mfma_f32_16x16x32_bf16 v[52:55], a[212:215], a[148:151], v[52:55]
  ds_read_b64_tr_b16 a[248:249], v223 offset:16384
  v_add_f32 v113, v113, v7
  v_mfma_f32_16x16x32_bf16 v[52:55], a[216:219], a[152:155], v[52:55]
  v_exp_f32 v13, v13
  v_mfma_f32_16x16x32_bf16 v[52:55], a[220:223], a[156:159], v[52:55]
  ds_read_b64_tr_b16 a[250:251], v223 offset:20480
  v_cvt_pk_bf16_f32 v69, v6, v7
  v_mfma_f32_16x16x32_bf16 v[48:51], a[220:223], a[140:143], v[96:99]
  v_exp_f32 v14, v14
  v_mfma_f32_16x16x32_bf16 v[48:51], a[216:219], a[136:139], v[48:51]
  ds_read_b64_tr_b16 a[252:253], v223 offset:24576
  v_cvt_pk_bf16_f32 v76, v12, v13
  v_mfma_f32_16x16x32_bf16 v[48:51], a[212:215], a[132:135], v[48:51]
  s_waitcnt lgkmcnt(3)
  v_exp_f32 v15, v15
  v_mfma_f32_16x16x32_bf16 v[48:51], a[208:211], a[128:131], v[48:51]
  ds_read_b64_tr_b16 a[254:255], v223 offset:28672
  v_cvt_pk_bf16_f32 v77, v14, v15
  v_mfma_f32_16x16x32_bf16 a[12:15], a[224:227], v[204:207], a[12:15]
  s_add_u32 m0, s63, 0
  v_exp_f32 v16, v16
  v_mfma_f32_16x16x32_bf16 a[12:15], a[228:231], v[252:255], a[12:15]
  ds_read_b128 a[192:195], v216 offset:16384
  v_add_f32 v112, v112, v16
  v_mfma_f32_16x16x32_bf16 a[8:11], a[228:231], v[248:251], a[8:11]
  v_exp_f32 v17, v17
  v_mfma_f32_16x16x32_bf16 a[8:11], a[224:227], v[200:203], a[8:11]
  ds_read_b128 a[196:199], v217 offset:16384
  v_add_f32 v112, v112, v17
  v_mfma_f32_16x16x32_bf16 a[4:7], a[224:227], v[196:199], a[4:7]
  v_exp_f32 v18, v18
  v_mfma_f32_16x16x32_bf16 a[4:7], a[228:231], v[244:247], a[4:7]
  buffer_load_dwordx4 v228, s[44:47], s60 offen offset:0 lds
  v_mfma_f32_16x16x32_bf16 a[0:3], a[228:231], v[208:211], a[0:3]
  v_exp_f32 v19, v19
  v_mfma_f32_16x16x32_bf16 a[0:3], a[224:227], v[192:195], a[0:3]
  ds_read_b128 a[200:203], v218 offset:16384
  v_cvt_pk_bf16_f32 v66, v16, v17
  v_mfma_f32_16x16x32_bf16 a[16:19], a[232:235], v[192:195], a[16:19]
  v_exp_f32 v24, v24
  v_mfma_f32_16x16x32_bf16 a[16:19], a[236:239], v[208:211], a[16:19]
  ds_read_b128 a[204:207], v219 offset:16384
  v_add_f32 v112, v112, v18
  v_mfma_f32_16x16x32_bf16 a[20:23], a[236:239], v[244:247], a[20:23]
  v_exp_f32 v25, v25
  v_mfma_f32_16x16x32_bf16 a[20:23], a[232:235], v[196:199], a[20:23]
  ds_read_b128 a[208:211], v216 offset:20480
  v_add_f32 v112, v112, v19
  v_mfma_f32_16x16x32_bf16 a[24:27], a[232:235], v[200:203], a[24:27]
  v_exp_f32 v26, v26
  v_mfma_f32_16x16x32_bf16 a[24:27], a[236:239], v[248:251], a[24:27]
  buffer_load_dwordx4 v229, s[44:47], s60 offen offset:1024 lds
  v_mfma_f32_16x16x32_bf16 a[28:31], a[236:239], v[252:255], a[28:31]
  v_exp_f32 v27, v27
  v_mfma_f32_16x16x32_bf16 a[28:31], a[232:235], v[204:207], a[28:31]
  ds_read_b128 a[212:215], v217 offset:20480
  v_cvt_pk_bf16_f32 v67, v18, v19
  v_mfma_f32_16x16x32_bf16 a[44:47], a[240:243], v[204:207], a[44:47]
  v_exp_f32 v20, v20
  v_mfma_f32_16x16x32_bf16 a[44:47], a[244:247], v[252:255], a[44:47]
  ds_read_b128 a[216:219], v218 offset:20480
  v_cvt_pk_bf16_f32 v74, v24, v25
  v_mfma_f32_16x16x32_bf16 a[40:43], a[244:247], v[248:251], a[40:43]
  v_exp_f32 v21, v21
  v_mfma_f32_16x16x32_bf16 a[40:43], a[240:243], v[200:203], a[40:43]
  ds_read_b128 a[220:223], v219 offset:20480
  v_cvt_pk_bf16_f32 v75, v26, v27
  v_mfma_f32_16x16x32_bf16 a[36:39], a[240:243], v[196:199], a[36:39]
  v_exp_f32 v22, v22
  v_mfma_f32_16x16x32_bf16 a[36:39], a[244:247], v[244:247], a[36:39]
  buffer_load_dwordx4 v230, s[44:47], s60 offen offset:2048 lds
  v_mfma_f32_16x16x32_bf16 a[32:35], a[244:247], v[208:211], a[32:35]
  s_waitcnt lgkmcnt(8)
  v_exp_f32 v23, v23
  v_mfma_f32_16x16x32_bf16 a[32:35], a[240:243], v[192:195], a[32:35]
  v_add_f32 v113, v113, v20
  v_add_f32 v113, v113, v21
  v_mfma_f32_16x16x32_bf16 a[48:51], a[248:251], v[192:195], a[48:51]
  v_exp_f32 v28, v28
  v_mfma_f32_16x16x32_bf16 a[48:51], a[252:255], v[208:211], a[48:51]
  v_cvt_pk_bf16_f32 v70, v20, v21
  v_add_f32 v113, v113, v22
  v_mfma_f32_16x16x32_bf16 a[52:55], a[252:255], v[244:247], a[52:55]
  v_exp_f32 v29, v29
  v_mfma_f32_16x16x32_bf16 a[52:55], a[248:251], v[196:199], a[52:55]
  v_add_f32 v113, v113, v23
  v_cvt_pk_bf16_f32 v71, v22, v23
  v_mfma_f32_16x16x32_bf16 a[56:59], a[248:251], v[200:203], a[56:59]
  v_exp_f32 v30, v30
  v_mfma_f32_16x16x32_bf16 a[56:59], a[252:255], v[248:251], a[56:59]
  buffer_load_dwordx4 v231, s[44:47], s60 offen offset:3072 lds
  v_mfma_f32_16x16x32_bf16 a[60:63], a[252:255], v[252:255], a[60:63]
  v_exp_f32 v31, v31
  v_mfma_f32_16x16x32_bf16 a[60:63], a[248:251], v[204:207], a[60:63]
  v_cvt_pk_bf16_f32 v78, v28, v29
  v_cvt_pk_bf16_f32 v79, v30, v31
  v_mfma_f32_16x16x32_bf16 v[120:123], v[124:127], v[204:207], v[120:123]
  s_add_u32 s60, s60, 16384
  v_mfma_f32_16x16x32_bf16 v[120:123], v[124:127], v[252:255], v[120:123]
  s_waitcnt lgkmcnt(0)
  v_mfma_f32_16x16x32_bf16 v[0:3], a[192:195], a[128:131], v[96:99]
  v_exp_f32 v32, v32
  v_mfma_f32_16x16x32_bf16 v[0:3], a[196:199], a[132:135], v[0:3]
  ds_read_b64_tr_b16 a[224:225], v224 offset:16384
  v_add_f32 v112, v112, v32
  v_mfma_f32_16x16x32_bf16 v[0:3], a[200:203], a[136:139], v[0:3]
  v_exp_f32 v33, v33
  v_mfma_f32_16x16x32_bf16 v[0:3], a[204:207], a[140:143], v[0:3]
  ds_read_b64_tr_b16 a[226:227], v224 offset:20480
  v_add_f32 v112, v112, v33
  v_mfma_f32_16x16x32_bf16 v[4:7], a[204:207], a[156:159], v[100:103]
  v_exp_f32 v34, v34
  v_mfma_f32_16x16x32_bf16 v[4:7], a[200:203], a[152:155], v[4:7]
  ds_read_b64_tr_b16 a[228:229], v224 offset:24576
  v_cvt_pk_bf16_f32 v80, v32, v33
  v_mfma_f32_16x16x32_bf16 v[4:7], a[196:199], a[148:151], v[4:7]
  v_exp_f32 v35, v35
  v_mfma_f32_16x16x32_bf16 v[4:7], a[192:195], a[144:147], v[4:7]
  ds_read_b64_tr_b16 a[230:231], v224 offset:28672
  v_add_f32 v112, v112, v34
  v_mfma_f32_16x16x32_bf16 v[8:11], a[192:195], a[160:163], v[104:107]
  v_exp_f32 v40, v40
  v_mfma_f32_16x16x32_bf16 v[8:11], a[196:199], a[164:167], v[8:11]
  ds_read_b64_tr_b16 a[232:233], v225 offset:16384
  v_add_f32 v112, v112, v35
  v_mfma_f32_16x16x32_bf16 v[8:11], a[200:203], a[168:171], v[8:11]
  v_exp_f32 v41, v41
  v_mfma_f32_16x16x32_bf16 v[8:11], a[204:207], a[172:175], v[8:11]
  ds_read_b64_tr_b16 a[234:235], v225 offset:20480
  v_cvt_pk_bf16_f32 v81, v34, v35
  v_mfma_f32_16x16x32_bf16 v[12:15], a[204:207], a[188:191], v[108:111]
  v_exp_f32 v42, v42
  v_mfma_f32_16x16x32_bf16 v[12:15], a[200:203], a[184:187], v[12:15]
  ds_read_b64_tr_b16 a[236:237], v225 offset:24576
  v_cvt_pk_bf16_f32 v88, v40, v41
  v_mfma_f32_16x16x32_bf16 v[12:15], a[196:199], a[180:183], v[12:15]
  v_exp_f32 v43, v43
  v_mfma_f32_16x16x32_bf16 v[12:15], a[192:195], a[176:179], v[12:15]
  ds_read_b64_tr_b16 a[238:239], v225 offset:28672
  v_cvt_pk_bf16_f32 v89, v42, v43
  v_mfma_f32_16x16x32_bf16 v[28:31], a[208:211], a[176:179], v[108:111]
  v_exp_f32 v36, v36
  v_mfma_f32_16x16x32_bf16 v[28:31], a[212:215], a[180:183], v[28:31]
  ds_read_b64_tr_b16 a[240:241], v226 offset:16384
  v_add_f32 v113, v113, v36
  v_mfma_f32_16x16x32_bf16 v[28:31], a[216:219], a[184:187], v[28:31]
  v_exp_f32 v37, v37
  v_mfma_f32_16x16x32_bf16 v[28:31], a[220:223], a[188:191], v[28:31]
  ds_read_b64_tr_b16 a[242:243], v226 offset:20480
  v_add_f32 v113, v113, v37
  v_mfma_f32_16x16x32_bf16 v[24:27], a[220:223], a[172:175], v[104:107]
  v_exp_f32 v38, v38
  v_mfma_f32_16x16x32_bf16 v[24:27], a[216:219], a[168:171], v[24:27]
  ds_read_b64_tr_b16 a[244:245], v226 offset:24576
  v_cvt_pk_bf16_f32 v84, v36, v37
  v_mfma_f32_16x16x32_bf16 v[24:27], a[212:215], a[164:167], v[24:27]
  v_exp_f32 v39, v39
  v_mfma_f32_16x16x32_bf16 v[24:27], a[208:211], a[160:163], v[24:27]
  ds_read_b64_tr_b16 a[246:247], v226 offset:28672
  v_add_f32 v113, v113, v38
  v_mfma_f32_16x16x32_bf16 v[20:23], a[208:211], a[144:147], v[100:103]
  v_exp_f32 v44, v44
  v_mfma_f32_16x16x32_bf16 v[20:23], a[212:215], a[148:151], v[20:23]
  ds_read_b64_tr_b16 a[248:249], v227 offset:16384
  v_add_f32 v113, v113, v39
  v_mfma_f32_16x16x32_bf16 v[20:23], a[216:219], a[152:155], v[20:23]
  v_exp_f32 v45, v45
  v_mfma_f32_16x16x32_bf16 v[20:23], a[220:223], a[156:159], v[20:23]
  ds_read_b64_tr_b16 a[250:251], v227 offset:20480
  v_cvt_pk_bf16_f32 v85, v38, v39
  v_mfma_f32_16x16x32_bf16 v[16:19], a[220:223], a[140:143], v[96:99]
  v_exp_f32 v46, v46
  v_mfma_f32_16x16x32_bf16 v[16:19], a[216:219], a[136:139], v[16:19]
  ds_read_b64_tr_b16 a[252:253], v227 offset:24576
  v_cvt_pk_bf16_f32 v92, v44, v45
  v_mfma_f32_16x16x32_bf16 v[16:19], a[212:215], a[132:135], v[16:19]
  s_waitcnt lgkmcnt(3)
  v_exp_f32 v47, v47
  v_mfma_f32_16x16x32_bf16 v[16:19], a[208:211], a[128:131], v[16:19]
  ds_read_b64_tr_b16 a[254:255], v227 offset:28672
  v_cvt_pk_bf16_f32 v93, v46, v47
  v_mfma_f32_16x16x32_bf16 a[76:79], a[224:227], v[204:207], a[76:79]
  s_add_u32 m0, s64, 0
  v_exp_f32 v48, v48
  v_mfma_f32_16x16x32_bf16 a[76:79], a[228:231], v[252:255], a[76:79]
  ds_read_b128 a[192:195], v216 offset:24576
  v_add_f32 v112, v112, v48
  v_mfma_f32_16x16x32_bf16 a[72:75], a[228:231], v[248:251], a[72:75]
  v_exp_f32 v49, v49
  v_mfma_f32_16x16x32_bf16 a[72:75], a[224:227], v[200:203], a[72:75]
  ds_read_b128 a[196:199], v217 offset:24576
  v_add_f32 v112, v112, v49
  v_mfma_f32_16x16x32_bf16 a[68:71], a[224:227], v[196:199], a[68:71]
  v_exp_f32 v50, v50
  v_mfma_f32_16x16x32_bf16 a[68:71], a[228:231], v[244:247], a[68:71]
  buffer_load_dwordx4 v232, s[48:51], s61 offen offset:0 lds
  v_mfma_f32_16x16x32_bf16 a[64:67], a[228:231], v[208:211], a[64:67]
  v_exp_f32 v51, v51
  v_mfma_f32_16x16x32_bf16 a[64:67], a[224:227], v[192:195], a[64:67]
  ds_read_b128 a[200:203], v218 offset:24576
  v_cvt_pk_bf16_f32 v82, v48, v49
  v_mfma_f32_16x16x32_bf16 a[80:83], a[232:235], v[192:195], a[80:83]
  v_exp_f32 v56, v56
  v_mfma_f32_16x16x32_bf16 a[80:83], a[236:239], v[208:211], a[80:83]
  ds_read_b128 a[204:207], v219 offset:24576
  v_add_f32 v112, v112, v50
  v_mfma_f32_16x16x32_bf16 a[84:87], a[236:239], v[244:247], a[84:87]
  v_exp_f32 v57, v57
  v_mfma_f32_16x16x32_bf16 a[84:87], a[232:235], v[196:199], a[84:87]
  ds_read_b128 a[208:211], v216 offset:28672
  v_add_f32 v112, v112, v51
  v_mfma_f32_16x16x32_bf16 a[88:91], a[232:235], v[200:203], a[88:91]
  v_exp_f32 v58, v58
  v_mfma_f32_16x16x32_bf16 a[88:91], a[236:239], v[248:251], a[88:91]
  buffer_load_dwordx4 v233, s[48:51], s61 offen offset:1024 lds
  v_mfma_f32_16x16x32_bf16 a[92:95], a[236:239], v[252:255], a[92:95]
  v_exp_f32 v59, v59
  v_mfma_f32_16x16x32_bf16 a[92:95], a[232:235], v[204:207], a[92:95]
  ds_read_b128 a[212:215], v217 offset:28672
  v_cvt_pk_bf16_f32 v83, v50, v51
  v_mfma_f32_16x16x32_bf16 a[108:111], a[240:243], v[204:207], a[108:111]
  v_exp_f32 v52, v52
  v_mfma_f32_16x16x32_bf16 a[108:111], a[244:247], v[252:255], a[108:111]
  ds_read_b128 a[216:219], v218 offset:28672
  v_cvt_pk_bf16_f32 v90, v56, v57
  v_mfma_f32_16x16x32_bf16 a[104:107], a[244:247], v[248:251], a[104:107]
  v_exp_f32 v53, v53
  v_mfma_f32_16x16x32_bf16 a[104:107], a[240:243], v[200:203], a[104:107]
  ds_read_b128 a[220:223], v219 offset:28672
  v_cvt_pk_bf16_f32 v91, v58, v59
  v_mfma_f32_16x16x32_bf16 a[100:103], a[240:243], v[196:199], a[100:103]
  v_exp_f32 v54, v54
  v_mfma_f32_16x16x32_bf16 a[100:103], a[244:247], v[244:247], a[100:103]
  buffer_load_dwordx4 v232, s[48:51], s61 offen offset:2048 lds
  v_mfma_f32_16x16x32_bf16 a[96:99], a[244:247], v[208:211], a[96:99]
  s_waitcnt lgkmcnt(8)
  v_exp_f32 v55, v55
  v_mfma_f32_16x16x32_bf16 a[96:99], a[240:243], v[192:195], a[96:99]
  v_add_f32 v113, v113, v52
  v_add_f32 v113, v113, v53
  v_mfma_f32_16x16x32_bf16 a[112:115], a[248:251], v[192:195], a[112:115]
  v_exp_f32 v60, v60
  v_mfma_f32_16x16x32_bf16 a[112:115], a[252:255], v[208:211], a[112:115]
  v_cvt_pk_bf16_f32 v86, v52, v53
  v_add_f32 v113, v113, v54
  v_mfma_f32_16x16x32_bf16 a[116:119], a[252:255], v[244:247], a[116:119]
  v_exp_f32 v61, v61
  v_mfma_f32_16x16x32_bf16 a[116:119], a[248:251], v[196:199], a[116:119]
  v_add_f32 v113, v113, v55
  v_cvt_pk_bf16_f32 v87, v54, v55
  v_mfma_f32_16x16x32_bf16 a[120:123], a[248:251], v[200:203], a[120:123]
  v_exp_f32 v62, v62
  v_mfma_f32_16x16x32_bf16 a[120:123], a[252:255], v[248:251], a[120:123]
  buffer_load_dwordx4 v233, s[48:51], s61 offen offset:3072 lds
  v_mfma_f32_16x16x32_bf16 a[124:127], a[252:255], v[252:255], a[124:127]
  v_exp_f32 v63, v63
  v_mfma_f32_16x16x32_bf16 a[124:127], a[248:251], v[204:207], a[124:127]
  v_cvt_pk_bf16_f32 v94, v60, v61
  v_cvt_pk_bf16_f32 v95, v62, v63
  v_mfma_f32_16x16x32_bf16 v[116:119], v[124:127], v[200:203], v[116:119]
  s_add_u32 s61, s61, 16384
  v_mfma_f32_16x16x32_bf16 v[116:119], v[124:127], v[248:251], v[116:119]
  s_waitcnt vmcnt(16) lgkmcnt(0)
  s_barrier
  v_mfma_f32_16x16x32_bf16 v[32:35], a[192:195], a[128:131], v[96:99]
  v_exp_f32 v0, v0
  v_mfma_f32_16x16x32_bf16 v[32:35], a[196:199], a[132:135], v[32:35]
  ds_read_b64_tr_b16 a[224:225], v220 offset:32768
  v_add_f32 v112, v112, v0
  v_mfma_f32_16x16x32_bf16 v[32:35], a[200:203], a[136:139], v[32:35]
  v_exp_f32 v1, v1
  v_mfma_f32_16x16x32_bf16 v[32:35], a[204:207], a[140:143], v[32:35]
  ds_read_b64_tr_b16 a[226:227], v220 offset:36864
  v_add_f32 v112, v112, v1
  v_mfma_f32_16x16x32_bf16 v[36:39], a[204:207], a[156:159], v[100:103]
  v_exp_f32 v2, v2
  v_mfma_f32_16x16x32_bf16 v[36:39], a[200:203], a[152:155], v[36:39]
  ds_read_b64_tr_b16 a[228:229], v220 offset:40960
  v_cvt_pk_bf16_f32 v192, v0, v1
  v_mfma_f32_16x16x32_bf16 v[36:39], a[196:199], a[148:151], v[36:39]
  v_exp_f32 v3, v3
  v_mfma_f32_16x16x32_bf16 v[36:39], a[192:195], a[144:147], v[36:39]
  ds_read_b64_tr_b16 a[230:231], v220 offset:45056
  v_add_f32 v112, v112, v2
  v_mfma_f32_16x16x32_bf16 v[40:43], a[192:195], a[160:163], v[104:107]
  v_exp_f32 v8, v8
  v_mfma_f32_16x16x32_bf16 v[40:43], a[196:199], a[164:167], v[40:43]
  ds_read_b64_tr_b16 a[232:233], v221 offset:32768
  v_add_f32 v112, v112, v3
  v_mfma_f32_16x16x32_bf16 v[40:43], a[200:203], a[168:171], v[40:43]
  v_exp_f32 v9, v9
  v_mfma_f32_16x16x32_bf16 v[40:43], a[204:207], a[172:175], v[40:43]
  ds_read_b64_tr_b16 a[234:235], v221 offset:36864
  v_cvt_pk_bf16_f32 v193, v2, v3
  v_mfma_f32_16x16x32_bf16 v[44:47], a[204:207], a[188:191], v[108:111]
  v_exp_f32 v10, v10
  v_mfma_f32_16x16x32_bf16 v[44:47], a[200:203], a[184:187], v[44:47]
  ds_read_b64_tr_b16 a[236:237], v221 offset:40960
  v_cvt_pk_bf16_f32 v200, v8, v9
  v_mfma_f32_16x16x32_bf16 v[44:47], a[196:199], a[180:183], v[44:47]
  v_exp_f32 v11, v11
  v_mfma_f32_16x16x32_bf16 v[44:47], a[192:195], a[176:179], v[44:47]
  ds_read_b64_tr_b16 a[238:239], v221 offset:45056
  v_cvt_pk_bf16_f32 v201, v10, v11
  v_mfma_f32_16x16x32_bf16 v[60:63], a[208:211], a[176:179], v[108:111]
  v_exp_f32 v4, v4
  v_mfma_f32_16x16x32_bf16 v[60:63], a[212:215], a[180:183], v[60:63]
  ds_read_b64_tr_b16 a[240:241], v222 offset:32768
  v_add_f32 v113, v113, v4
  v_mfma_f32_16x16x32_bf16 v[60:63], a[216:219], a[184:187], v[60:63]
  v_exp_f32 v5, v5
  v_mfma_f32_16x16x32_bf16 v[60:63], a[220:223], a[188:191], v[60:63]
  ds_read_b64_tr_b16 a[242:243], v222 offset:36864
  v_add_f32 v113, v113, v5
  v_mfma_f32_16x16x32_bf16 v[56:59], a[220:223], a[172:175], v[104:107]
  v_exp_f32 v6, v6
  v_mfma_f32_16x16x32_bf16 v[56:59], a[216:219], a[168:171], v[56:59]
  ds_read_b64_tr_b16 a[244:245], v222 offset:40960
  v_cvt_pk_bf16_f32 v196, v4, v5
  v_mfma_f32_16x16x32_bf16 v[56:59], a[212:215], a[164:167], v[56:59]
  v_exp_f32 v7, v7
  v_mfma_f32_16x16x32_bf16 v[56:59], a[208:211], a[160:163], v[56:59]
  ds_read_b64_tr_b16 a[246:247], v222 offset:45056
  v_add_f32 v113, v113, v6
  v_mfma_f32_16x16x32_bf16 v[52:55], a[208:211], a[144:147], v[100:103]
  v_exp_f32 v12, v12
  v_mfma_f32_16x16x32_bf16 v[52:55], a[212:215], a[148:151], v[52:55]
  ds_read_b64_tr_b16 a[248:249], v223 offset:32768
  v_add_f32 v113, v113, v7
  v_mfma_f32_16x16x32_bf16 v[52:55], a[216:219], a[152:155], v[52:55]
  v_exp_f32 v13, v13
  v_mfma_f32_16x16x32_bf16 v[52:55], a[220:223], a[156:159], v[52:55]
  ds_read_b64_tr_b16 a[250:251], v223 offset:36864
  v_cvt_pk_bf16_f32 v197, v6, v7
  v_mfma_f32_16x16x32_bf16 v[48:51], a[220:223], a[140:143], v[96:99]
  v_exp_f32 v14, v14
  v_mfma_f32_16x16x32_bf16 v[48:51], a[216:219], a[136:139], v[48:51]
  ds_read_b64_tr_b16 a[252:253], v223 offset:40960
  v_cvt_pk_bf16_f32 v204, v12, v13
  v_mfma_f32_16x16x32_bf16 v[48:51], a[212:215], a[132:135], v[48:51]
  s_waitcnt lgkmcnt(3)
  v_exp_f32 v15, v15
  v_mfma_f32_16x16x32_bf16 v[48:51], a[208:211], a[128:131], v[48:51]
  ds_read_b64_tr_b16 a[254:255], v223 offset:45056
  v_cvt_pk_bf16_f32 v205, v14, v15
  v_mfma_f32_16x16x32_bf16 a[12:15], a[224:227], v[76:79], a[12:15]
  s_add_u32 m0, s63, 16384
  v_exp_f32 v16, v16
  v_mfma_f32_16x16x32_bf16 a[12:15], a[228:231], v[92:95], a[12:15]
  ds_read_b128 a[192:195], v216 offset:32768
  v_add_f32 v112, v112, v16
  v_mfma_f32_16x16x32_bf16 a[8:11], a[228:231], v[88:91], a[8:11]
  v_exp_f32 v17, v17
  v_mfma_f32_16x16x32_bf16 a[8:11], a[224:227], v[72:75], a[8:11]
  ds_read_b128 a[196:199], v217 offset:32768
  v_add_f32 v112, v112, v17
  v_mfma_f32_16x16x32_bf16 a[4:7], a[224:227], v[68:71], a[4:7]
  v_exp_f32 v18, v18
  v_mfma_f32_16x16x32_bf16 a[4:7], a[228:231], v[84:87], a[4:7]
  buffer_load_dwordx4 v228, s[44:47], s60 offen offset:0 lds
  v_mfma_f32_16x16x32_bf16 a[0:3], a[228:231], v[80:83], a[0:3]
  v_exp_f32 v19, v19
  v_mfma_f32_16x16x32_bf16 a[0:3], a[224:227], v[64:67], a[0:3]
  ds_read_b128 a[200:203], v218 offset:32768
  v_cvt_pk_bf16_f32 v194, v16, v17
  v_mfma_f32_16x16x32_bf16 a[16:19], a[232:235], v[64:67], a[16:19]
  v_exp_f32 v24, v24
  v_mfma_f32_16x16x32_bf16 a[16:19], a[236:239], v[80:83], a[16:19]
  ds_read_b128 a[204:207], v219 offset:32768
  v_add_f32 v112, v112, v18
  v_mfma_f32_16x16x32_bf16 a[20:23], a[236:239], v[84:87], a[20:23]
  v_exp_f32 v25, v25
  v_mfma_f32_16x16x32_bf16 a[20:23], a[232:235], v[68:71], a[20:23]
  ds_read_b128 a[208:211], v216 offset:36864
  v_add_f32 v112, v112, v19
  v_mfma_f32_16x16x32_bf16 a[24:27], a[232:235], v[72:75], a[24:27]
  v_exp_f32 v26, v26
  v_mfma_f32_16x16x32_bf16 a[24:27], a[236:239], v[88:91], a[24:27]
  buffer_load_dwordx4 v229, s[44:47], s60 offen offset:1024 lds
  v_mfma_f32_16x16x32_bf16 a[28:31], a[236:239], v[92:95], a[28:31]
  v_exp_f32 v27, v27
  v_mfma_f32_16x16x32_bf16 a[28:31], a[232:235], v[76:79], a[28:31]
  ds_read_b128 a[212:215], v217 offset:36864
  v_cvt_pk_bf16_f32 v195, v18, v19
  v_mfma_f32_16x16x32_bf16 a[44:47], a[240:243], v[76:79], a[44:47]
  v_exp_f32 v20, v20
  v_mfma_f32_16x16x32_bf16 a[44:47], a[244:247], v[92:95], a[44:47]
  ds_read_b128 a[216:219], v218 offset:36864
  v_cvt_pk_bf16_f32 v202, v24, v25
  v_mfma_f32_16x16x32_bf16 a[40:43], a[244:247], v[88:91], a[40:43]
  v_exp_f32 v21, v21
  v_mfma_f32_16x16x32_bf16 a[40:43], a[240:243], v[72:75], a[40:43]
  ds_read_b128 a[220:223], v219 offset:36864
  v_cvt_pk_bf16_f32 v203, v26, v27
  v_mfma_f32_16x16x32_bf16 a[36:39], a[240:243], v[68:71], a[36:39]
  v_exp_f32 v22, v22
  v_mfma_f32_16x16x32_bf16 a[36:39], a[244:247], v[84:87], a[36:39]
  buffer_load_dwordx4 v230, s[44:47], s60 offen offset:2048 lds
  v_mfma_f32_16x16x32_bf16 a[32:35], a[244:247], v[80:83], a[32:35]
  s_waitcnt lgkmcnt(8)
  v_exp_f32 v23, v23
  v_mfma_f32_16x16x32_bf16 a[32:35], a[240:243], v[64:67], a[32:35]
  v_add_f32 v113, v113, v20
  v_add_f32 v113, v113, v21
  v_mfma_f32_16x16x32_bf16 a[48:51], a[248:251], v[64:67], a[48:51]
  v_exp_f32 v28, v28
  v_mfma_f32_16x16x32_bf16 a[48:51], a[252:255], v[80:83], a[48:51]
  v_cvt_pk_bf16_f32 v198, v20, v21
  v_add_f32 v113, v113, v22
  v_mfma_f32_16x16x32_bf16 a[52:55], a[252:255], v[84:87], a[52:55]
  v_exp_f32 v29, v29
  v_mfma_f32_16x16x32_bf16 a[52:55], a[248:251], v[68:71], a[52:55]
  v_add_f32 v113, v113, v23
  v_cvt_pk_bf16_f32 v199, v22, v23
  v_mfma_f32_16x16x32_bf16 a[56:59], a[248:251], v[72:75], a[56:59]
  v_exp_f32 v30, v30
  v_mfma_f32_16x16x32_bf16 a[56:59], a[252:255], v[88:91], a[56:59]
  buffer_load_dwordx4 v231, s[44:47], s60 offen offset:3072 lds
  v_mfma_f32_16x16x32_bf16 a[60:63], a[252:255], v[92:95], a[60:63]
  v_exp_f32 v31, v31
  v_mfma_f32_16x16x32_bf16 a[60:63], a[248:251], v[76:79], a[60:63]
  v_cvt_pk_bf16_f32 v206, v28, v29
  v_cvt_pk_bf16_f32 v207, v30, v31
  v_mfma_f32_16x16x32_bf16 v[120:123], v[124:127], v[76:79], v[120:123]
  s_add_u32 s60, s60, 16384
  v_mfma_f32_16x16x32_bf16 v[120:123], v[124:127], v[92:95], v[120:123]
  s_waitcnt lgkmcnt(0)
  v_mfma_f32_16x16x32_bf16 v[0:3], a[192:195], a[128:131], v[96:99]
  v_exp_f32 v32, v32
  v_mfma_f32_16x16x32_bf16 v[0:3], a[196:199], a[132:135], v[0:3]
  ds_read_b64_tr_b16 a[224:225], v224 offset:32768
  v_add_f32 v112, v112, v32
  v_mfma_f32_16x16x32_bf16 v[0:3], a[200:203], a[136:139], v[0:3]
  v_exp_f32 v33, v33
  v_mfma_f32_16x16x32_bf16 v[0:3], a[204:207], a[140:143], v[0:3]
  ds_read_b64_tr_b16 a[226:227], v224 offset:36864
  v_add_f32 v112, v112, v33
  v_mfma_f32_16x16x32_bf16 v[4:7], a[204:207], a[156:159], v[100:103]
  v_exp_f32 v34, v34
  v_mfma_f32_16x16x32_bf16 v[4:7], a[200:203], a[152:155], v[4:7]
  ds_read_b64_tr_b16 a[228:229], v224 offset:40960
  v_cvt_pk_bf16_f32 v208, v32, v33
  v_mfma_f32_16x16x32_bf16 v[4:7], a[196:199], a[148:151], v[4:7]
  v_exp_f32 v35, v35
  v_mfma_f32_16x16x32_bf16 v[4:7], a[192:195], a[144:147], v[4:7]
  ds_read_b64_tr_b16 a[230:231], v224 offset:45056
  v_add_f32 v112, v112, v34
  v_mfma_f32_16x16x32_bf16 v[8:11], a[192:195], a[160:163], v[104:107]
  v_exp_f32 v40, v40
  v_mfma_f32_16x16x32_bf16 v[8:11], a[196:199], a[164:167], v[8:11]
  ds_read_b64_tr_b16 a[232:233], v225 offset:32768
  v_add_f32 v112, v112, v35
  v_mfma_f32_16x16x32_bf16 v[8:11], a[200:203], a[168:171], v[8:11]
  v_exp_f32 v41, v41
  v_mfma_f32_16x16x32_bf16 v[8:11], a[204:207], a[172:175], v[8:11]
  ds_read_b64_tr_b16 a[234:235], v225 offset:36864
  v_cvt_pk_bf16_f32 v209, v34, v35
  v_mfma_f32_16x16x32_bf16 v[12:15], a[204:207], a[188:191], v[108:111]
  v_exp_f32 v42, v42
  v_mfma_f32_16x16x32_bf16 v[12:15], a[200:203], a[184:187], v[12:15]
  ds_read_b64_tr_b16 a[236:237], v225 offset:40960
  v_cvt_pk_bf16_f32 v248, v40, v41
  v_mfma_f32_16x16x32_bf16 v[12:15], a[196:199], a[180:183], v[12:15]
  v_exp_f32 v43, v43
  v_mfma_f32_16x16x32_bf16 v[12:15], a[192:195], a[176:179], v[12:15]
  ds_read_b64_tr_b16 a[238:239], v225 offset:45056
  v_cvt_pk_bf16_f32 v249, v42, v43
  v_mfma_f32_16x16x32_bf16 v[28:31], a[208:211], a[176:179], v[108:111]
  v_exp_f32 v36, v36
  v_mfma_f32_16x16x32_bf16 v[28:31], a[212:215], a[180:183], v[28:31]
  ds_read_b64_tr_b16 a[240:241], v226 offset:32768
  v_add_f32 v113, v113, v36
  v_mfma_f32_16x16x32_bf16 v[28:31], a[216:219], a[184:187], v[28:31]
  v_exp_f32 v37, v37
  v_mfma_f32_16x16x32_bf16 v[28:31], a[220:223], a[188:191], v[28:31]
  ds_read_b64_tr_b16 a[242:243], v226 offset:36864
  v_add_f32 v113, v113, v37
  v_mfma_f32_16x16x32_bf16 v[24:27], a[220:223], a[172:175], v[104:107]
  v_exp_f32 v38, v38
  v_mfma_f32_16x16x32_bf16 v[24:27], a[216:219], a[168:171], v[24:27]
  ds_read_b64_tr_b16 a[244:245], v226 offset:40960
  v_cvt_pk_bf16_f32 v244, v36, v37
  v_mfma_f32_16x16x32_bf16 v[24:27], a[212:215], a[164:167], v[24:27]
  v_exp_f32 v39, v39
  v_mfma_f32_16x16x32_bf16 v[24:27], a[208:211], a[160:163], v[24:27]
  ds_read_b64_tr_b16 a[246:247], v226 offset:45056
  v_add_f32 v113, v113, v38
  v_mfma_f32_16x16x32_bf16 v[20:23], a[208:211], a[144:147], v[100:103]
  v_exp_f32 v44, v44
  v_mfma_f32_16x16x32_bf16 v[20:23], a[212:215], a[148:151], v[20:23]
  ds_read_b64_tr_b16 a[248:249], v227 offset:32768
  v_add_f32 v113, v113, v39
  v_mfma_f32_16x16x32_bf16 v[20:23], a[216:219], a[152:155], v[20:23]
  v_exp_f32 v45, v45
  v_mfma_f32_16x16x32_bf16 v[20:23], a[220:223], a[156:159], v[20:23]
  ds_read_b64_tr_b16 a[250:251], v227 offset:36864
  v_cvt_pk_bf16_f32 v245, v38, v39
  v_mfma_f32_16x16x32_bf16 v[16:19], a[220:223], a[140:143], v[96:99]
L_pad3:
  s_cbranch_execz L_pad7
  v_exp_f32 v46, v46
  v_mfma_f32_16x16x32_bf16 v[16:19], a[216:219], a[136:139], v[16:19]
  ds_read_b64_tr_b16 a[252:253], v227 offset:40960
  v_cvt_pk_bf16_f32 v252, v44, v45
  v_mfma_f32_16x16x32_bf16 v[16:19], a[212:215], a[132:135], v[16:19]
  s_waitcnt lgkmcnt(3)
  v_exp_f32 v47, v47
  v_mfma_f32_16x16x32_bf16 v[16:19], a[208:211], a[128:131], v[16:19]
  ds_read_b64_tr_b16 a[254:255], v227 offset:45056
  v_cvt_pk_bf16_f32 v253, v46, v47
  v_mfma_f32_16x16x32_bf16 a[76:79], a[224:227], v[76:79], a[76:79]
  s_add_u32 m0, s64, 16384
  v_exp_f32 v48, v48
  v_mfma_f32_16x16x32_bf16 a[76:79], a[228:231], v[92:95], a[76:79]
  ds_read_b128 a[192:195], v216 offset:40960
  v_add_f32 v112, v112, v48
  v_mfma_f32_16x16x32_bf16 a[72:75], a[228:231], v[88:91], a[72:75]
  v_exp_f32 v49, v49
  v_mfma_f32_16x16x32_bf16 a[72:75], a[224:227], v[72:75], a[72:75]
  ds_read_b128 a[196:199], v217 offset:40960
  v_add_f32 v112, v112, v49
  v_mfma_f32_16x16x32_bf16 a[68:71], a[224:227], v[68:71], a[68:71]
  v_exp_f32 v50, v50
  v_mfma_f32_16x16x32_bf16 a[68:71], a[228:231], v[84:87], a[68:71]
  buffer_load_dwordx4 v232, s[48:51], s61 offen offset:0 lds
  v_mfma_f32_16x16x32_bf16 a[64:67], a[228:231], v[80:83], a[64:67]
  v_exp_f32 v51, v51
  v_mfma_f32_16x16x32_bf16 a[64:67], a[224:227], v[64:67], a[64:67]
  ds_read_b128 a[200:203], v218 offset:40960
  v_cvt_pk_bf16_f32 v210, v48, v49
  v_mfma_f32_16x16x32_bf16 a[80:83], a[232:235], v[64:67], a[80:83]
  v_exp_f32 v56, v56
  v_mfma_f32_16x16x32_bf16 a[80:83], a[236:239], v[80:83], a[80:83]
  ds_read_b128 a[204:207], v219 offset:40960
  v_add_f32 v112, v112, v50
  v_mfma_f32_16x16x32_bf16 a[84:87], a[236:239], v[84:87], a[84:87]
  v_exp_f32 v57, v57
  v_mfma_f32_16x16x32_bf16 a[84:87], a[232:235], v[68:71], a[84:87]
  ds_read_b128 a[208:211], v216 offset:45056
  v_add_f32 v112, v112, v51
  v_mfma_f32_16x16x32_bf16 a[88:91], a[232:235], v[72:75], a[88:91]
  v_exp_f32 v58, v58
  v_mfma_f32_16x16x32_bf16 a[88:91], a[236:239], v[88:91], a[88:91]
  buffer_load_dwordx4 v233, s[48:51], s61 offen offset:1024 lds
  v_mfma_f32_16x16x32_bf16 a[92:95], a[236:239], v[92:95], a[92:95]
  v_exp_f32 v59, v59
  v_mfma_f32_16x16x32_bf16 a[92:95], a[232:235], v[76:79], a[92:95]
  ds_read_b128 a[212:215], v217 offset:45056
  v_cvt_pk_bf16_f32 v211, v50, v51
  v_mfma_f32_16x16x32_bf16 a[108:111], a[240:243], v[76:79], a[108:111]
  v_exp_f32 v52, v52
  v_mfma_f32_16x16x32_bf16 a[108:111], a[244:247], v[92:95], a[108:111]
  ds_read_b128 a[216:219], v218 offset:45056
  v_cvt_pk_bf16_f32 v250, v56, v57
  v_mfma_f32_16x16x32_bf16 a[104:107], a[244:247], v[88:91], a[104:107]
  v_exp_f32 v53, v53
  v_mfma_f32_16x16x32_bf16 a[104:107], a[240:243], v[72:75], a[104:107]
  ds_read_b128 a[220:223], v219 offset:45056
  v_cvt_pk_bf16_f32 v251, v58, v59
  v_mfma_f32_16x16x32_bf16 a[100:103], a[240:243], v[68:71], a[100:103]
  v_exp_f32 v54, v54
  v_mfma_f32_16x16x32_bf16 a[100:103], a[244:247], v[84:87], a[100:103]
  buffer_load_dwordx4 v232, s[48:51], s61 offen offset:2048 lds
  v_mfma_f32_16x16x32_bf16 a[96:99], a[244:247], v[80:83], a[96:99]
  s_waitcnt lgkmcnt(8)
  v_exp_f32 v55, v55
  v_mfma_f32_16x16x32_bf16 a[96:99], a[240:243], v[64:67], a[96:99]
  v_add_f32 v113, v113, v52
  v_add_f32 v113, v113, v53
  v_mfma_f32_16x16x32_bf16 a[112:115], a[248:251], v[64:67], a[112:115]
  v_exp_f32 v60, v60
  v_mfma_f32_16x16x32_bf16 a[112:115], a[252:255], v[80:83], a[112:115]
  v_cvt_pk_bf16_f32 v246, v52, v53
  v_add_f32 v113, v113, v54
  v_mfma_f32_16x16x32_bf16 a[116:119], a[252:255], v[84:87], a[116:119]
  v_exp_f32 v61, v61
  v_mfma_f32_16x16x32_bf16 a[116:119], a[248:251], v[68:71], a[116:119]
  v_add_f32 v113, v113, v55
  v_cvt_pk_bf16_f32 v247, v54, v55
  v_mfma_f32_16x16x32_bf16 a[120:123], a[248:251], v[72:75], a[120:123]
  v_exp_f32 v62, v62
  v_mfma_f32_16x16x32_bf16 a[120:123], a[252:255], v[88:91], a[120:123]
  buffer_load_dwordx4 v233, s[48:51], s61 offen offset:3072 lds
  v_mfma_f32_16x16x32_bf16 a[124:127], a[252:255], v[92:95], a[124:127]
  v_exp_f32 v63, v63
  v_mfma_f32_16x16x32_bf16 a[124:127], a[248:251], v[76:79], a[124:127]
  v_cvt_pk_bf16_f32 v254, v60, v61
  v_cvt_pk_bf16_f32 v255, v62, v63
  v_mfma_f32_16x16x32_bf16 v[116:119], v[124:127], v[72:75], v[116:119]
  s_add_u32 s61, s61, 16384
  v_mfma_f32_16x16x32_bf16 v[116:119], v[124:127], v[88:91], v[116:119]
  s_sub_u32 s62, s62, 1
  s_cmp_eq_u32 s62, 0
  s_cbranch_scc1 L_tail
  s_cmp_lg_u32 s66, 0
  s_cbranch_scc1 L_loop
  s_cmp_lg_u32 s62, 6
  s_cbranch_scc1 L_bk0
  s_add_u32 s70, s65, 0
  buffer_store_dwordx4 v[128:131], v213, s[52:55], s70 offen offset:0 sc1
  buffer_store_dwordx4 v[132:135], v213, s[52:55], s70 offen offset:1024 sc1
  buffer_store_dwordx4 v[136:139], v213, s[52:55], s70 offen offset:2048 sc1
  buffer_store_dwordx4 v[140:143], v213, s[52:55], s70 offen offset:3072 sc1
  s_branch L_loop
L_bk0:
  s_cmp_lg_u32 s62, 5
  s_cbranch_scc1 L_bk1
  s_add_u32 s70, s65, 4096
  buffer_store_dwordx4 v[144:147], v213, s[52:55], s70 offen offset:0 sc1
  buffer_store_dwordx4 v[148:151], v213, s[52:55], s70 offen offset:1024 sc1
  buffer_store_dwordx4 v[152:155], v213, s[52:55], s70 offen offset:2048 sc1
  buffer_store_dwordx4 v[156:159], v213, s[52:55], s70 offen offset:3072 sc1
  s_branch L_loop
L_bk1:
  s_cmp_lg_u32 s62, 4
  s_cbranch_scc1 L_bk2
  s_add_u32 s70, s65, 8388608
  buffer_store_dwordx4 v[160:163], v213, s[52:55], s70 offen offset:0 sc1
  buffer_store_dwordx4 v[164:167], v213, s[52:55], s70 offen offset:1024 sc1
  buffer_store_dwordx4 v[168:171], v213, s[52:55], s70 offen offset:2048 sc1
  buffer_store_dwordx4 v[172:175], v213, s[52:55], s70 offen offset:3072 sc1
  s_branch L_loop
L_bk2:
  s_cmp_lg_u32 s62, 3
  s_cbranch_scc1 L_bk3
  v_and_b32 v214, 31, v212
  v_lshlrev_b32 v214, 2, v214
  v_mov_b32 v234, 0
  s_lshr_b32 s70, s65, 15
  s_lshl_b32 s70, s70, 7
  s_add_u32 s70, s70, 41943040
  buffer_store_dword v234, v214, s[52:55], s70 offen sc1
  s_add_u32 s70, s65, 8392704
  buffer_store_dwordx4 v[176:179], v213, s[52:55], s70 offen offset:0 sc1
  buffer_store_dwordx4 v[180:183], v213, s[52:55], s70 offen offset:1024 sc1
  buffer_store_dwordx4 v[184:187], v213, s[52:55], s70 offen offset:2048 sc1
  buffer_store_dwordx4 v[188:191], v213, s[52:55], s70 offen offset:3072 sc1
  s_branch L_loop
L_bk3:
  s_lshl_b32 s70, s6, 2
  s_cmp_lg_u32 s62, 1
  s_cbranch_scc1 L_bk4
  v_mov_b32 v214, 0
  buffer_load_dword v234, v214, s[96:99], s70 offen sc1
  s_getpc_b64 s[56:57]
L_pc2:
  s_mov_b32 s58, L_code_end-L_pc2
  s_lshr_b32 s70, s2, 3
  s_lshl_b32 s70, s70, 2
  s_add_u32 s70, s70, s4
  s_lshl_b32 s70, s70, 8
  v_lshlrev_b32 v215, 2, v212
  buffer_load_dword v128, v215, s[56:59], s70 offen
  s_branch L_loop
L_bk4:
  s_lshl_b32 s71, s4, 4
  s_or_b32 s71, s71, s62
  s_cmp_lg_u32 s71, 2
  s_cbranch_scc1 L_loop
  v_mov_b32 v214, 1
  v_lshlrev_b32 v215, 2, v212
  buffer_atomic_add v214, v215, s[96:99], s70 offen sc1
  s_branch L_loop
L_tail:
  v_readfirstlane_b32 s70, v234
  s_nop 3
  s_cmp_ge_u32 s70, 8
  s_cbranch_scc1 L_spin1_done
  v_mov_b32 v214, 0
  s_lshl_b32 s72, s6, 2
  s_mov_b32 s71, 200000
L_spin1:
  buffer_load_dword v234, v214, s[96:99], s72 offen sc1
  s_waitcnt vmcnt(0)
  v_readfirstlane_b32 s70, v234
  s_sub_u32 s71, s71, 1
  s_cbranch_scc1 L_spin1_done
  s_cmp_lt_u32 s70, 8
  s_cbranch_scc1 L_spin1
L_spin1_done:
  s_waitcnt vmcnt(8) lgkmcnt(0)
  s_barrier
  v_mfma_f32_16x16x32_bf16 v[32:35], a[192:195], a[128:131], v[96:99]
  v_exp_f32 v0, v0
  v_mfma_f32_16x16x32_bf16 v[32:35], a[196:199], a[132:135], v[32:35]
  ds_read_b64_tr_b16 a[224:225], v220 offset:49152
  v_add_f32 v112, v112, v0
  v_mfma_f32_16x16x32_bf16 v[32:35], a[200:203], a[136:139], v[32:35]
  v_exp_f32 v1, v1
  v_mfma_f32_16x16x32_bf16 v[32:35], a[204:207], a[140:143], v[32:35]
  ds_read_b64_tr_b16 a[226:227], v220 offset:53248
  v_add_f32 v112, v112, v1
  v_mfma_f32_16x16x32_bf16 v[36:39], a[204:207], a[156:159], v[100:103]
  v_exp_f32 v2, v2
  v_mfma_f32_16x16x32_bf16 v[36:39], a[200:203], a[152:155], v[36:39]
  ds_read_b64_tr_b16 a[228:229], v220 offset:57344
  v_cvt_pk_bf16_f32 v64, v0, v1
  v_mfma_f32_16x16x32_bf16 v[36:39], a[196:199], a[148:151], v[36:39]
  v_exp_f32 v3, v3
  v_mfma_f32_16x16x32_bf16 v[36:39], a[192:195], a[144:147], v[36:39]
  ds_read_b64_tr_b16 a[230:231], v220 offset:61440
  v_add_f32 v112, v112, v2
  v_mfma_f32_16x16x32_bf16 v[40:43], a[192:195], a[160:163], v[104:107]
  v_exp_f32 v8, v8
  v_mfma_f32_16x16x32_bf16 v[40:43], a[196:199], a[164:167], v[40:43]
  ds_read_b64_tr_b16 a[232:233], v221 offset:49152
  v_add_f32 v112, v112, v3
  v_mfma_f32_16x16x32_bf16 v[40:43], a[200:203], a[168:171], v[40:43]
  v_exp_f32 v9, v9
  v_mfma_f32_16x16x32_bf16 v[40:43], a[204:207], a[172:175], v[40:43]
  ds_read_b64_tr_b16 a[234:235], v221 offset:53248
  v_cvt_pk_bf16_f32 v65, v2, v3
  v_mfma_f32_16x16x32_bf16 v[44:47], a[204:207], a[188:191], v[108:111]
  v_exp_f32 v10, v10
  v_mfma_f32_16x16x32_bf16 v[44:47], a[200:203], a[184:187], v[44:47]
  ds_read_b64_tr_b16 a[236:237], v221 offset:57344
  v_cvt_pk_bf16_f32 v72, v8, v9
  v_mfma_f32_16x16x32_bf16 v[44:47], a[196:199], a[180:183], v[44:47]
  v_exp_f32 v11, v11
  v_mfma_f32_16x16x32_bf16 v[44:47], a[192:195], a[176:179], v[44:47]
  ds_read_b64_tr_b16 a[238:239], v221 offset:61440
  v_cvt_pk_bf16_f32 v73, v10, v11
  v_mfma_f32_16x16x32_bf16 v[60:63], a[208:211], a[176:179], v[108:111]
  v_exp_f32 v4, v4
  v_mfma_f32_16x16x32_bf16 v[60:63], a[212:215], a[180:183], v[60:63]
  ds_read_b64_tr_b16 a[240:241], v222 offset:49152
  v_add_f32 v113, v113, v4
  v_mfma_f32_16x16x32_bf16 v[60:63], a[216:219], a[184:187], v[60:63]
  v_exp_f32 v5, v5
  v_mfma_f32_16x16x32_bf16 v[60:63], a[220:223], a[188:191], v[60:63]
  ds_read_b64_tr_b16 a[242:243], v222 offset:53248
  v_add_f32 v113, v113, v5
  v_mfma_f32_16x16x32_bf16 v[56:59], a[220:223], a[172:175], v[104:107]
  v_exp_f32 v6, v6
  v_mfma_f32_16x16x32_bf16 v[56:59], a[216:219], a[168:171], v[56:59]
  ds_read_b64_tr_b16 a[244:245], v222 offset:57344
  v_cvt_pk_bf16_f32 v68, v4, v5
  v_mfma_f32_16x16x32_bf16 v[56:59], a[212:215], a[164:167], v[56:59]
  v_exp_f32 v7, v7
  v_mfma_f32_16x16x32_bf16 v[56:59], a[208:211], a[160:163], v[56:59]
  ds_read_b64_tr_b16 a[246:247], v222 offset:61440
  v_add_f32 v113, v113, v6
  v_mfma_f32_16x16x32_bf16 v[52:55], a[208:211], a[144:147], v[100:103]
  v_exp_f32 v12, v12
  v_mfma_f32_16x16x32_bf16 v[52:55], a[212:215], a[148:151], v[52:55]
  ds_read_b64_tr_b16 a[248:249], v223 offset:49152
  v_add_f32 v113, v113, v7
  v_mfma_f32_16x16x32_bf16 v[52:55], a[216:219], a[152:155], v[52:55]
  v_exp_f32 v13, v13
  v_mfma_f32_16x16x32_bf16 v[52:55], a[220:223], a[156:159], v[52:55]
  ds_read_b64_tr_b16 a[250:251], v223 offset:53248
  v_cvt_pk_bf16_f32 v69, v6, v7
  v_mfma_f32_16x16x32_bf16 v[48:51], a[220:223], a[140:143], v[96:99]
  v_exp_f32 v14, v14
  v_mfma_f32_16x16x32_bf16 v[48:51], a[216:219], a[136:139], v[48:51]
  ds_read_b64_tr_b16 a[252:253], v223 offset:57344
  v_cvt_pk_bf16_f32 v76, v12, v13
  v_mfma_f32_16x16x32_bf16 v[48:51], a[212:215], a[132:135], v[48:51]
  s_waitcnt lgkmcnt(3)
  v_exp_f32 v15, v15
  v_mfma_f32_16x16x32_bf16 v[48:51], a[208:211], a[128:131], v[48:51]
  ds_read_b64_tr_b16 a[254:255], v223 offset:61440
  v_cvt_pk_bf16_f32 v77, v14, v15
  v_mfma_f32_16x16x32_bf16 a[12:15], a[224:227], v[204:207], a[12:15]
  v_exp_f32 v16, v16
  v_mfma_f32_16x16x32_bf16 a[12:15], a[228:231], v[252:255], a[12:15]
  ds_read_b128 a[192:195], v216 offset:49152
  v_add_f32 v112, v112, v16
  v_mfma_f32_16x16x32_bf16 a[8:11], a[228:231], v[248:251], a[8:11]
  v_exp_f32 v17, v17
  v_mfma_f32_16x16x32_bf16 a[8:11], a[224:227], v[200:203], a[8:11]
  ds_read_b128 a[196:199], v217 offset:49152
  v_add_f32 v112, v112, v17
  v_mfma_f32_16x16x32_bf16 a[4:7], a[224:227], v[196:199], a[4:7]
  s_add_u32 s72, s11, 0
  v_exp_f32 v18, v18
  v_mfma_f32_16x16x32_bf16 a[4:7], a[228:231], v[244:247], a[4:7]
  buffer_load_dwordx4 v[128:131], v213, s[52:55], s72 offen sc1
  v_mfma_f32_16x16x32_bf16 a[0:3], a[228:231], v[208:211], a[0:3]
  v_exp_f32 v19, v19
  v_mfma_f32_16x16x32_bf16 a[0:3], a[224:227], v[192:195], a[0:3]
  ds_read_b128 a[200:203], v218 offset:49152
  v_cvt_pk_bf16_f32 v66, v16, v17
  v_mfma_f32_16x16x32_bf16 a[16:19], a[232:235], v[192:195], a[16:19]
  v_exp_f32 v24, v24
  v_mfma_f32_16x16x32_bf16 a[16:19], a[236:239], v[208:211], a[16:19]
  ds_read_b128 a[204:207], v219 offset:49152
  v_add_f32 v112, v112, v18
  v_mfma_f32_16x16x32_bf16 a[20:23], a[236:239], v[244:247], a[20:23]
  v_exp_f32 v25, v25
  v_mfma_f32_16x16x32_bf16 a[20:23], a[232:235], v[196:199], a[20:23]
  ds_read_b128 a[208:211], v216 offset:53248
  v_add_f32 v112, v112, v19
  v_mfma_f32_16x16x32_bf16 a[24:27], a[232:235], v[200:203], a[24:27]
  s_add_u32 s72, s11, 32768
  v_exp_f32 v26, v26
  v_mfma_f32_16x16x32_bf16 a[24:27], a[236:239], v[248:251], a[24:27]
  buffer_load_dwordx4 v[132:135], v213, s[52:55], s72 offen sc1
  v_mfma_f32_16x16x32_bf16 a[28:31], a[236:239], v[252:255], a[28:31]
  v_exp_f32 v27, v27
  v_mfma_f32_16x16x32_bf16 a[28:31], a[232:235], v[204:207], a[28:31]
  ds_read_b128 a[212:215], v217 offset:53248
  v_cvt_pk_bf16_f32 v67, v18, v19
  v_mfma_f32_16x16x32_bf16 a[44:47], a[240:243], v[204:207], a[44:47]
  v_exp_f32 v20, v20
  v_mfma_f32_16x16x32_bf16 a[44:47], a[244:247], v[252:255], a[44:47]
  ds_read_b128 a[216:219], v218 offset:53248
  v_cvt_pk_bf16_f32 v74, v24, v25
  v_mfma_f32_16x16x32_bf16 a[40:43], a[244:247], v[248:251], a[40:43]
  v_exp_f32 v21, v21
  v_mfma_f32_16x16x32_bf16 a[40:43], a[240:243], v[200:203], a[40:43]
  ds_read_b128 a[220:223], v219 offset:53248
  v_cvt_pk_bf16_f32 v75, v26, v27
  v_mfma_f32_16x16x32_bf16 a[36:39], a[240:243], v[196:199], a[36:39]
  s_add_u32 s72, s11, 65536
  v_exp_f32 v22, v22
  v_mfma_f32_16x16x32_bf16 a[36:39], a[244:247], v[244:247], a[36:39]
  buffer_load_dwordx4 v[136:139], v213, s[52:55], s72 offen sc1
  v_mfma_f32_16x16x32_bf16 a[32:35], a[244:247], v[208:211], a[32:35]
  s_waitcnt lgkmcnt(8)
  v_exp_f32 v23, v23
  v_mfma_f32_16x16x32_bf16 a[32:35], a[240:243], v[192:195], a[32:35]
  v_add_f32 v113, v113, v20
  v_add_f32 v113, v113, v21
  v_mfma_f32_16x16x32_bf16 a[48:51], a[248:251], v[192:195], a[48:51]
  v_exp_f32 v28, v28
  v_mfma_f32_16x16x32_bf16 a[48:51], a[252:255], v[208:211], a[48:51]
  v_cvt_pk_bf16_f32 v70, v20, v21
  v_add_f32 v113, v113, v22
  v_mfma_f32_16x16x32_bf16 a[52:55], a[252:255], v[244:247], a[52:55]
  v_exp_f32 v29, v29
  v_mfma_f32_16x16x32_bf16 a[52:55], a[248:251], v[196:199], a[52:55]
  v_add_f32 v113, v113, v23
  v_cvt_pk_bf16_f32 v71, v22, v23
  v_mfma_f32_16x16x32_bf16 a[56:59], a[248:251], v[200:203], a[56:59]
  s_add_u32 s72, s11, 98304
  v_exp_f32 v30, v30
  v_mfma_f32_16x16x32_bf16 a[56:59], a[252:255], v[248:251], a[56:59]
  buffer_load_dwordx4 v[140:143], v213, s[52:55], s72 offen sc1
  v_mfma_f32_16x16x32_bf16 a[60:63], a[252:255], v[252:255], a[60:63]
  v_exp_f32 v31, v31
  v_mfma_f32_16x16x32_bf16 a[60:63], a[248:251], v[204:207], a[60:63]
  v_cvt_pk_bf16_f32 v78, v28, v29
  v_cvt_pk_bf16_f32 v79, v30, v31
  v_mfma_f32_16x16x32_bf16 v[120:123], v[124:127], v[204:207], v[120:123]
  v_mfma_f32_16x16x32_bf16 v[120:123], v[124:127], v[252:255], v[120:123]
  s_waitcnt lgkmcnt(0)
  v_mfma_f32_16x16x32_bf16 v[0:3], a[192:195], a[128:131], v[96:99]
  v_exp_f32 v32, v32
  v_mfma_f32_16x16x32_bf16 v[0:3], a[196:199], a[132:135], v[0:3]
  ds_read_b64_tr_b16 a[224:225], v224 offset:49152
  v_add_f32 v112, v112, v32
  v_mfma_f32_16x16x32_bf16 v[0:3], a[200:203], a[136:139], v[0:3]
  v_exp_f32 v33, v33
  v_mfma_f32_16x16x32_bf16 v[0:3], a[204:207], a[140:143], v[0:3]
  ds_read_b64_tr_b16 a[226:227], v224 offset:53248
  v_add_f32 v112, v112, v33
  v_mfma_f32_16x16x32_bf16 v[4:7], a[204:207], a[156:159], v[100:103]
  v_exp_f32 v34, v34
  v_mfma_f32_16x16x32_bf16 v[4:7], a[200:203], a[152:155], v[4:7]
  ds_read_b64_tr_b16 a[228:229], v224 offset:57344
  v_cvt_pk_bf16_f32 v80, v32, v33
  v_mfma_f32_16x16x32_bf16 v[4:7], a[196:199], a[148:151], v[4:7]
  v_exp_f32 v35, v35
  v_mfma_f32_16x16x32_bf16 v[4:7], a[192:195], a[144:147], v[4:7]
  ds_read_b64_tr_b16 a[230:231], v224 offset:61440
  v_add_f32 v112, v112, v34
  v_mfma_f32_16x16x32_bf16 v[8:11], a[192:195], a[160:163], v[104:107]
  v_exp_f32 v40, v40
  v_mfma_f32_16x16x32_bf16 v[8:11], a[196:199], a[164:167], v[8:11]
  ds_read_b64_tr_b16 a[232:233], v225 offset:49152
  v_add_f32 v112, v112, v35
  v_mfma_f32_16x16x32_bf16 v[8:11], a[200:203], a[168:171], v[8:11]
  v_exp_f32 v41, v41
  v_mfma_f32_16x16x32_bf16 v[8:11], a[204:207], a[172:175], v[8:11]
  ds_read_b64_tr_b16 a[234:235], v225 offset:53248
  v_cvt_pk_bf16_f32 v81, v34, v35
  v_mfma_f32_16x16x32_bf16 v[12:15], a[204:207], a[188:191], v[108:111]
  v_exp_f32 v42, v42
  v_mfma_f32_16x16x32_bf16 v[12:15], a[200:203], a[184:187], v[12:15]
  ds_read_b64_tr_b16 a[236:237], v225 offset:57344
  v_cvt_pk_bf16_f32 v88, v40, v41
  v_mfma_f32_16x16x32_bf16 v[12:15], a[196:199], a[180:183], v[12:15]
  v_exp_f32 v43, v43
  v_mfma_f32_16x16x32_bf16 v[12:15], a[192:195], a[176:179], v[12:15]
  ds_read_b64_tr_b16 a[238:239], v225 offset:61440
  v_cvt_pk_bf16_f32 v89, v42, v43
  v_mfma_f32_16x16x32_bf16 v[28:31], a[208:211], a[176:179], v[108:111]
  v_exp_f32 v36, v36
  v_mfma_f32_16x16x32_bf16 v[28:31], a[212:215], a[180:183], v[28:31]
  ds_read_b64_tr_b16 a[240:241], v226 offset:49152
  v_add_f32 v113, v113, v36
  v_mfma_f32_16x16x32_bf16 v[28:31], a[216:219], a[184:187], v[28:31]
  v_exp_f32 v37, v37
  v_mfma_f32_16x16x32_bf16 v[28:31], a[220:223], a[188:191], v[28:31]
  ds_read_b64_tr_b16 a[242:243], v226 offset:53248
  v_add_f32 v113, v113, v37
  v_mfma_f32_16x16x32_bf16 v[24:27], a[220:223], a[172:175], v[104:107]
  v_exp_f32 v38, v38
  v_mfma_f32_16x16x32_bf16 v[24:27], a[216:219], a[168:171], v[24:27]
  ds_read_b64_tr_b16 a[244:245], v226 offset:57344
  v_cvt_pk_bf16_f32 v84, v36, v37
  v_mfma_f32_16x16x32_bf16 v[24:27], a[212:215], a[164:167], v[24:27]
  v_exp_f32 v39, v39
  v_mfma_f32_16x16x32_bf16 v[24:27], a[208:211], a[160:163], v[24:27]
  ds_read_b64_tr_b16 a[246:247], v226 offset:61440
  v_add_f32 v113, v113, v38
  v_mfma_f32_16x16x32_bf16 v[20:23], a[208:211], a[144:147], v[100:103]
  v_exp_f32 v44, v44
  v_mfma_f32_16x16x32_bf16 v[20:23], a[212:215], a[148:151], v[20:23]
  ds_read_b64_tr_b16 a[248:249], v227 offset:49152
  v_add_f32 v113, v113, v39
  v_mfma_f32_16x16x32_bf16 v[20:23], a[216:219], a[152:155], v[20:23]
  v_exp_f32 v45, v45
  v_mfma_f32_16x16x32_bf16 v[20:23], a[220:223], a[156:159], v[20:23]
  ds_read_b64_tr_b16 a[250:251], v227 offset:53248
  v_cvt_pk_bf16_f32 v85, v38, v39
  v_mfma_f32_16x16x32_bf16 v[16:19], a[220:223], a[140:143], v[96:99]
  v_exp_f32 v46, v46
  v_mfma_f32_16x16x32_bf16 v[16:19], a[216:219], a[136:139], v[16:19]
  ds_read_b64_tr_b16 a[252:253], v227 offset:57344
  v_cvt_pk_bf16_f32 v92, v44, v45
  v_mfma_f32_16x16x32_bf16 v[16:19], a[212:215], a[132:135], v[16:19]
  s_waitcnt lgkmcnt(3)
  v_exp_f32 v47, v47
  v_mfma_f32_16x16x32_bf16 v[16:19], a[208:211], a[128:131], v[16:19]
  ds_read_b64_tr_b16 a[254:255], v227 offset:61440
  v_cvt_pk_bf16_f32 v93, v46, v47
  v_mfma_f32_16x16x32_bf16 a[76:79], a[224:227], v[204:207], a[76:79]
  s_add_u32 m0, s64, 32768
  v_exp_f32 v48, v48
  v_mfma_f32_16x16x32_bf16 a[76:79], a[228:231], v[252:255], a[76:79]
  ds_read_b128 a[192:195], v216 offset:57344
  v_add_f32 v112, v112, v48
  v_mfma_f32_16x16x32_bf16 a[72:75], a[228:231], v[248:251], a[72:75]
  v_exp_f32 v49, v49
  v_mfma_f32_16x16x32_bf16 a[72:75], a[224:227], v[200:203], a[72:75]
  ds_read_b128 a[196:199], v217 offset:57344
  v_add_f32 v112, v112, v49
  v_mfma_f32_16x16x32_bf16 a[68:71], a[224:227], v[196:199], a[68:71]
  v_exp_f32 v50, v50
  v_mfma_f32_16x16x32_bf16 a[68:71], a[228:231], v[244:247], a[68:71]
  buffer_load_dwordx4 v232, s[48:51], s61 offen offset:0 lds
  v_mfma_f32_16x16x32_bf16 a[64:67], a[228:231], v[208:211], a[64:67]
  v_exp_f32 v51, v51
  v_mfma_f32_16x16x32_bf16 a[64:67], a[224:227], v[192:195], a[64:67]
  ds_read_b128 a[200:203], v218 offset:57344
  v_cvt_pk_bf16_f32 v82, v48, v49
  v_mfma_f32_16x16x32_bf16 a[80:83], a[232:235], v[192:195], a[80:83]
  v_exp_f32 v56, v56
  v_mfma_f32_16x16x32_bf16 a[80:83], a[236:239], v[208:211], a[80:83]
  ds_read_b128 a[204:207], v219 offset:57344
  v_add_f32 v112, v112, v50
  v_mfma_f32_16x16x32_bf16 a[84:87], a[236:239], v[244:247], a[84:87]
  v_exp_f32 v57, v57
  v_mfma_f32_16x16x32_bf16 a[84:87], a[232:235], v[196:199], a[84:87]
  ds_read_b128 a[208:211], v216 offset:61440
  v_add_f32 v112, v112, v51
  v_mfma_f32_16x16x32_bf16 a[88:91], a[232:235], v[200:203], a[88:91]
  v_exp_f32 v58, v58
  v_mfma_f32_16x16x32_bf16 a[88:91], a[236:239], v[248:251], a[88:91]
  buffer_load_dwordx4 v233, s[48:51], s61 offen offset:1024 lds
  v_mfma_f32_16x16x32_bf16 a[92:95], a[236:239], v[252:255], a[92:95]
  v_exp_f32 v59, v59
  v_mfma_f32_16x16x32_bf16 a[92:95], a[232:235], v[204:207], a[92:95]
  ds_read_b128 a[212:215], v217 offset:61440
  v_cvt_pk_bf16_f32 v83, v50, v51
  v_mfma_f32_16x16x32_bf16 a[108:111], a[240:243], v[204:207], a[108:111]
  v_exp_f32 v52, v52
  v_mfma_f32_16x16x32_bf16 a[108:111], a[244:247], v[252:255], a[108:111]
  ds_read_b128 a[216:219], v218 offset:61440
  v_cvt_pk_bf16_f32 v90, v56, v57
  v_mfma_f32_16x16x32_bf16 a[104:107], a[244:247], v[248:251], a[104:107]
  v_exp_f32 v53, v53
  v_mfma_f32_16x16x32_bf16 a[104:107], a[240:243], v[200:203], a[104:107]
  ds_read_b128 a[220:223], v219 offset:61440
  v_cvt_pk_bf16_f32 v91, v58, v59
  v_mfma_f32_16x16x32_bf16 a[100:103], a[240:243], v[196:199], a[100:103]
  v_exp_f32 v54, v54
  v_mfma_f32_16x16x32_bf16 a[100:103], a[244:247], v[244:247], a[100:103]
  buffer_load_dwordx4 v232, s[48:51], s61 offen offset:2048 lds
  v_mfma_f32_16x16x32_bf16 a[96:99], a[244:247], v[208:211], a[96:99]
  s_waitcnt lgkmcnt(8)
  v_exp_f32 v55, v55
  v_mfma_f32_16x16x32_bf16 a[96:99], a[240:243], v[192:195], a[96:99]
  v_add_f32 v113, v113, v52
  v_add_f32 v113, v113, v53
  v_mfma_f32_16x16x32_bf16 a[112:115], a[248:251], v[192:195], a[112:115]
  v_exp_f32 v60, v60
  v_mfma_f32_16x16x32_bf16 a[112:115], a[252:255], v[208:211], a[112:115]
  v_cvt_pk_bf16_f32 v86, v52, v53
  v_add_f32 v113, v113, v54
  v_mfma_f32_16x16x32_bf16 a[116:119], a[252:255], v[244:247], a[116:119]
  v_exp_f32 v61, v61
  v_mfma_f32_16x16x32_bf16 a[116:119], a[248:251], v[196:199], a[116:119]
  v_add_f32 v113, v113, v55
  v_cvt_pk_bf16_f32 v87, v54, v55
  v_mfma_f32_16x16x32_bf16 a[120:123], a[248:251], v[200:203], a[120:123]
  v_exp_f32 v62, v62
  v_mfma_f32_16x16x32_bf16 a[120:123], a[252:255], v[248:251], a[120:123]
  buffer_load_dwordx4 v233, s[48:51], s61 offen offset:3072 lds
  v_mfma_f32_16x16x32_bf16 a[124:127], a[252:255], v[252:255], a[124:127]
  v_exp_f32 v63, v63
  v_mfma_f32_16x16x32_bf16 a[124:127], a[248:251], v[204:207], a[124:127]
  v_cvt_pk_bf16_f32 v94, v60, v61
  v_cvt_pk_bf16_f32 v95, v62, v63
  v_mfma_f32_16x16x32_bf16 v[116:119], v[124:127], v[200:203], v[116:119]
  s_add_u32 s61, s61, 16384
  v_mfma_f32_16x16x32_bf16 v[116:119], v[124:127], v[248:251], v[116:119]
  s_waitcnt vmcnt(8) lgkmcnt(0)
  s_barrier
  v_mfma_f32_16x16x32_bf16 v[32:35], a[192:195], a[128:131], v[96:99]
  v_exp_f32 v0, v0
  v_mfma_f32_16x16x32_bf16 v[32:35], a[196:199], a[132:135], v[32:35]
  ds_read_b64_tr_b16 a[224:225], v220 offset:0
  v_add_f32 v112, v112, v0
  v_mfma_f32_16x16x32_bf16 v[32:35], a[200:203], a[136:139], v[32:35]
  v_exp_f32 v1, v1
  v_mfma_f32_16x16x32_bf16 v[32:35], a[204:207], a[140:143], v[32:35]
  ds_read_b64_tr_b16 a[226:227], v220 offset:4096
  v_add_f32 v112, v112, v1
  v_mfma_f32_16x16x32_bf16 v[36:39], a[204:207], a[156:159], v[100:103]
  v_exp_f32 v2, v2
  v_mfma_f32_16x16x32_bf16 v[36:39], a[200:203], a[152:155], v[36:39]
  ds_read_b64_tr_b16 a[228:229], v220 offset:8192
  v_cvt_pk_bf16_f32 v192, v0, v1
  v_mfma_f32_16x16x32_bf16 v[36:39], a[196:199], a[148:151], v[36:39]
  v_exp_f32 v3, v3
  v_mfma_f32_16x16x32_bf16 v[36:39], a[192:195], a[144:147], v[36:39]
  ds_read_b64_tr_b16 a[230:231], v220 offset:12288
  v_add_f32 v112, v112, v2
  v_mfma_f32_16x16x32_bf16 v[40:43], a[192:195], a[160:163], v[104:107]
  v_exp_f32 v8, v8
  v_mfma_f32_16x16x32_bf16 v[40:43], a[196:199], a[164:167], v[40:43]
  ds_read_b64_tr_b16 a[232:233], v221 offset:0
  v_add_f32 v112, v112, v3
  v_mfma_f32_16x16x32_bf16 v[40:43], a[200:203], a[168:171], v[40:43]
  v_exp_f32 v9, v9
  v_mfma_f32_16x16x32_bf16 v[40:43], a[204:207], a[172:175], v[40:43]
  ds_read_b64_tr_b16 a[234:235], v221 offset:4096
  v_cvt_pk_bf16_f32 v193, v2, v3
  v_mfma_f32_16x16x32_bf16 v[44:47], a[204:207], a[188:191], v[108:111]
  v_exp_f32 v10, v10
  v_mfma_f32_16x16x32_bf16 v[44:47], a[200:203], a[184:187], v[44:47]
  ds_read_b64_tr_b16 a[236:237], v221 offset:8192
  v_cvt_pk_bf16_f32 v200, v8, v9
  v_mfma_f32_16x16x32_bf16 v[44:47], a[196:199], a[180:183], v[44:47]
  v_exp_f32 v11, v11
  v_mfma_f32_16x16x32_bf16 v[44:47], a[192:195], a[176:179], v[44:47]
  ds_read_b64_tr_b16 a[238:239], v221 offset:12288
  v_cvt_pk_bf16_f32 v201, v10, v11
  v_mfma_f32_16x16x32_bf16 v[60:63], a[208:211], a[176:179], v[108:111]
  v_exp_f32 v4, v4
  v_mfma_f32_16x16x32_bf16 v[60:63], a[212:215], a[180:183], v[60:63]
  ds_read_b64_tr_b16 a[240:241], v222 offset:0
  v_add_f32 v113, v113, v4
  v_mfma_f32_16x16x32_bf16 v[60:63], a[216:219], a[184:187], v[60:63]
  v_exp_f32 v5, v5
  v_mfma_f32_16x16x32_bf16 v[60:63], a[220:223], a[188:191], v[60:63]
  ds_read_b64_tr_b16 a[242:243], v222 offset:4096
  v_add_f32 v113, v113, v5
  v_mfma_f32_16x16x32_bf16 v[56:59], a[220:223], a[172:175], v[104:107]
  v_exp_f32 v6, v6
  v_mfma_f32_16x16x32_bf16 v[56:59], a[216:219], a[168:171], v[56:59]
  ds_read_b64_tr_b16 a[244:245], v222 offset:8192
  v_cvt_pk_bf16_f32 v196, v4, v5
  v_mfma_f32_16x16x32_bf16 v[56:59], a[212:215], a[164:167], v[56:59]
  v_exp_f32 v7, v7
  v_mfma_f32_16x16x32_bf16 v[56:59], a[208:211], a[160:163], v[56:59]
  ds_read_b64_tr_b16 a[246:247], v222 offset:12288
  v_add_f32 v113, v113, v6
  v_mfma_f32_16x16x32_bf16 v[52:55], a[208:211], a[144:147], v[100:103]
  v_exp_f32 v12, v12
  v_mfma_f32_16x16x32_bf16 v[52:55], a[212:215], a[148:151], v[52:55]
  ds_read_b64_tr_b16 a[248:249], v223 offset:0
  v_add_f32 v113, v113, v7
  v_mfma_f32_16x16x32_bf16 v[52:55], a[216:219], a[152:155], v[52:55]
  v_exp_f32 v13, v13
  v_mfma_f32_16x16x32_bf16 v[52:55], a[220:223], a[156:159], v[52:55]
  ds_read_b64_tr_b16 a[250:251], v223 offset:4096
  v_cvt_pk_bf16_f32 v197, v6, v7
  v_mfma_f32_16x16x32_bf16 v[48:51], a[220:223], a[140:143], v[96:99]
  v_exp_f32 v14, v14
  v_mfma_f32_16x16x32_bf16 v[48:51], a[216:219], a[136:139], v[48:51]
  ds_read_b64_tr_b16 a[252:253], v223 offset:8192
  v_cvt_pk_bf16_f32 v204, v12, v13
  v_mfma_f32_16x16x32_bf16 v[48:51], a[212:215], a[132:135], v[48:51]
  s_waitcnt lgkmcnt(3)
  v_exp_f32 v15, v15
  v_mfma_f32_16x16x32_bf16 v[48:51], a[208:211], a[128:131], v[48:51]
  ds_read_b64_tr_b16 a[254:255], v223 offset:12288
  v_cvt_pk_bf16_f32 v205, v14, v15
  v_mfma_f32_16x16x32_bf16 a[12:15], a[224:227], v[76:79], a[12:15]
  v_exp_f32 v16, v16
  v_mfma_f32_16x16x32_bf16 a[12:15], a[228:231], v[92:95], a[12:15]
  ds_read_b128 a[192:195], v216 offset:0
  v_add_f32 v112, v112, v16
  v_mfma_f32_16x16x32_bf16 a[8:11], a[228:231], v[88:91], a[8:11]
  v_exp_f32 v17, v17
  v_mfma_f32_16x16x32_bf16 a[8:11], a[224:227], v[72:75], a[8:11]
  ds_read_b128 a[196:199], v217 offset:0
  v_add_f32 v112, v112, v17
  v_mfma_f32_16x16x32_bf16 a[4:7], a[224:227], v[68:71], a[4:7]
  s_add_u32 s72, s11, 131072
  v_exp_f32 v18, v18
  v_mfma_f32_16x16x32_bf16 a[4:7], a[228:231], v[84:87], a[4:7]
  buffer_load_dwordx4 v[144:147], v213, s[52:55], s72 offen sc1
  v_mfma_f32_16x16x32_bf16 a[0:3], a[228:231], v[80:83], a[0:3]
  v_exp_f32 v19, v19
  v_mfma_f32_16x16x32_bf16 a[0:3], a[224:227], v[64:67], a[0:3]
  ds_read_b128 a[200:203], v218 offset:0
  v_cvt_pk_bf16_f32 v194, v16, v17
  v_mfma_f32_16x16x32_bf16 a[16:19], a[232:235], v[64:67], a[16:19]
  v_exp_f32 v24, v24
  v_mfma_f32_16x16x32_bf16 a[16:19], a[236:239], v[80:83], a[16:19]
  ds_read_b128 a[204:207], v219 offset:0
  v_add_f32 v112, v112, v18
  v_mfma_f32_16x16x32_bf16 a[20:23], a[236:239], v[84:87], a[20:23]
  v_exp_f32 v25, v25
  v_mfma_f32_16x16x32_bf16 a[20:23], a[232:235], v[68:71], a[20:23]
  ds_read_b128 a[208:211], v216 offset:4096
  v_add_f32 v112, v112, v19
  v_mfma_f32_16x16x32_bf16 a[24:27], a[232:235], v[72:75], a[24:27]
  s_add_u32 s72, s11, 163840
  v_exp_f32 v26, v26
  v_mfma_f32_16x16x32_bf16 a[24:27], a[236:239], v[88:91], a[24:27]
  buffer_load_dwordx4 v[148:151], v213, s[52:55], s72 offen sc1
  v_mfma_f32_16x16x32_bf16 a[28:31], a[236:239], v[92:95], a[28:31]
  v_exp_f32 v27, v27
  v_mfma_f32_16x16x32_bf16 a[28:31], a[232:235], v[76:79], a[28:31]
  ds_read_b128 a[212:215], v217 offset:4096
  v_cvt_pk_bf16_f32 v195, v18, v19
  v_mfma_f32_16x16x32_bf16 a[44:47], a[240:243], v[76:79], a[44:47]
L_pad4:
  s_cbranch_execz L_padL
  v_exp_f32 v20, v20
  v_mfma_f32_16x16x32_bf16 a[44:47], a[244:247], v[92:95], a[44:47]
  ds_read_b128 a[216:219], v218 offset:4096
  v_cvt_pk_bf16_f32 v202, v24, v25
  v_mfma_f32_16x16x32_bf16 a[40:43], a[244:247], v[88:91], a[40:43]
  v_exp_f32 v21, v21
  v_mfma_f32_16x16x32_bf16 a[40:43], a[240:243], v[72:75], a[40:43]
  ds_read_b128 a[220:223], v219 offset:4096
  v_cvt_pk_bf16_f32 v203, v26, v27
  v_mfma_f32_16x16x32_bf16 a[36:39], a[240:243], v[68:71], a[36:39]
  s_add_u32 s72, s11, 196608
  v_exp_f32 v22, v22
  v_mfma_f32_16x16x32_bf16 a[36:39], a[244:247], v[84:87], a[36:39]
  buffer_load_dwordx4 v[152:155], v213, s[52:55], s72 offen sc1
  v_mfma_f32_16x16x32_bf16 a[32:35], a[244:247], v[80:83], a[32:35]
  s_waitcnt lgkmcnt(8)
  v_exp_f32 v23, v23
  v_mfma_f32_16x16x32_bf16 a[32:35], a[240:243], v[64:67], a[32:35]
  v_add_f32 v113, v113, v20
  v_add_f32 v113, v113, v21
  v_mfma_f32_16x16x32_bf16 a[48:51], a[248:251], v[64:67], a[48:51]
  v_exp_f32 v28, v28
  v_mfma_f32_16x16x32_bf16 a[48:51], a[252:255], v[80:83], a[48:51]
  v_cvt_pk_bf16_f32 v198, v20, v21
  v_add_f32 v113, v113, v22
  v_mfma_f32_16x16x32_bf16 a[52:55], a[252:255], v[84:87], a[52:55]
  v_exp_f32 v29, v29
  v_mfma_f32_16x16x32_bf16 a[52:55], a[248:251], v[68:71], a[52:55]
  v_add_f32 v113, v113, v23
  v_cvt_pk_bf16_f32 v199, v22, v23
  v_mfma_f32_16x16x32_bf16 a[56:59], a[248:251], v[72:75], a[56:59]
  s_add_u32 s72, s11, 229376
  v_exp_f32 v30, v30
  v_mfma_f32_16x16x32_bf16 a[56:59], a[252:255], v[88:91], a[56:59]
  buffer_load_dwordx4 v[156:159], v213, s[52:55], s72 offen sc1
  v_mfma_f32_16x16x32_bf16 a[60:63], a[252:255], v[92:95], a[60:63]
  v_exp_f32 v31, v31
  v_mfma_f32_16x16x32_bf16 a[60:63], a[248:251], v[76:79], a[60:63]
  v_cvt_pk_bf16_f32 v206, v28, v29
  v_cvt_pk_bf16_f32 v207, v30, v31
  v_mfma_f32_16x16x32_bf16 v[120:123], v[124:127], v[76:79], v[120:123]
  v_mfma_f32_16x16x32_bf16 v[120:123], v[124:127], v[92:95], v[120:123]
  s_waitcnt lgkmcnt(0)
  v_mfma_f32_16x16x32_bf16 v[0:3], a[192:195], a[128:131], v[96:99]
  v_exp_f32 v32, v32
  v_mfma_f32_16x16x32_bf16 v[0:3], a[196:199], a[132:135], v[0:3]
  ds_read_b64_tr_b16 a[224:225], v224 offset:0
  v_add_f32 v112, v112, v32
  v_mfma_f32_16x16x32_bf16 v[0:3], a[200:203], a[136:139], v[0:3]
  v_exp_f32 v33, v33
  v_mfma_f32_16x16x32_bf16 v[0:3], a[204:207], a[140:143], v[0:3]
  ds_read_b64_tr_b16 a[226:227], v224 offset:4096
  v_add_f32 v112, v112, v33
  v_mfma_f32_16x16x32_bf16 v[4:7], a[204:207], a[156:159], v[100:103]
  v_exp_f32 v34, v34
  v_mfma_f32_16x16x32_bf16 v[4:7], a[200:203], a[152:155], v[4:7]
  ds_read_b64_tr_b16 a[228:229], v224 offset:8192
  v_cvt_pk_bf16_f32 v208, v32, v33
  v_mfma_f32_16x16x32_bf16 v[4:7], a[196:199], a[148:151], v[4:7]
  v_exp_f32 v35, v35
  v_mfma_f32_16x16x32_bf16 v[4:7], a[192:195], a[144:147], v[4:7]
  ds_read_b64_tr_b16 a[230:231], v224 offset:12288
  v_add_f32 v112, v112, v34
  v_mfma_f32_16x16x32_bf16 v[8:11], a[192:195], a[160:163], v[104:107]
  v_exp_f32 v40, v40
  v_mfma_f32_16x16x32_bf16 v[8:11], a[196:199], a[164:167], v[8:11]
  ds_read_b64_tr_b16 a[232:233], v225 offset:0
  v_add_f32 v112, v112, v35
  v_mfma_f32_16x16x32_bf16 v[8:11], a[200:203], a[168:171], v[8:11]
  v_exp_f32 v41, v41
  v_mfma_f32_16x16x32_bf16 v[8:11], a[204:207], a[172:175], v[8:11]
  ds_read_b64_tr_b16 a[234:235], v225 offset:4096
  v_cvt_pk_bf16_f32 v209, v34, v35
  v_mfma_f32_16x16x32_bf16 v[12:15], a[204:207], a[188:191], v[108:111]
  v_exp_f32 v42, v42
  v_mfma_f32_16x16x32_bf16 v[12:15], a[200:203], a[184:187], v[12:15]
  ds_read_b64_tr_b16 a[236:237], v225 offset:8192
  v_cvt_pk_bf16_f32 v248, v40, v41
  v_mfma_f32_16x16x32_bf16 v[12:15], a[196:199], a[180:183], v[12:15]
  v_exp_f32 v43, v43
  v_mfma_f32_16x16x32_bf16 v[12:15], a[192:195], a[176:179], v[12:15]
  ds_read_b64_tr_b16 a[238:239], v225 offset:12288
  v_cvt_pk_bf16_f32 v249, v42, v43
  v_mfma_f32_16x16x32_bf16 v[28:31], a[208:211], a[176:179], v[108:111]
  v_exp_f32 v36, v36
  v_mfma_f32_16x16x32_bf16 v[28:31], a[212:215], a[180:183], v[28:31]
  ds_read_b64_tr_b16 a[240:241], v226 offset:0
  v_add_f32 v113, v113, v36
  v_mfma_f32_16x16x32_bf16 v[28:31], a[216:219], a[184:187], v[28:31]
  v_exp_f32 v37, v37
  v_mfma_f32_16x16x32_bf16 v[28:31], a[220:223], a[188:191], v[28:31]
  ds_read_b64_tr_b16 a[242:243], v226 offset:4096
  v_add_f32 v113, v113, v37
  v_mfma_f32_16x16x32_bf16 v[24:27], a[220:223], a[172:175], v[104:107]
  v_exp_f32 v38, v38
  v_mfma_f32_16x16x32_bf16 v[24:27], a[216:219], a[168:171], v[24:27]
  ds_read_b64_tr_b16 a[244:245], v226 offset:8192
  v_cvt_pk_bf16_f32 v244, v36, v37
  v_mfma_f32_16x16x32_bf16 v[24:27], a[212:215], a[164:167], v[24:27]
  v_exp_f32 v39, v39
  v_mfma_f32_16x16x32_bf16 v[24:27], a[208:211], a[160:163], v[24:27]
  ds_read_b64_tr_b16 a[246:247], v226 offset:12288
  v_add_f32 v113, v113, v38
  v_mfma_f32_16x16x32_bf16 v[20:23], a[208:211], a[144:147], v[100:103]
  v_exp_f32 v44, v44
  v_mfma_f32_16x16x32_bf16 v[20:23], a[212:215], a[148:151], v[20:23]
  ds_read_b64_tr_b16 a[248:249], v227 offset:0
  v_add_f32 v113, v113, v39
  v_mfma_f32_16x16x32_bf16 v[20:23], a[216:219], a[152:155], v[20:23]
  v_exp_f32 v45, v45
  v_mfma_f32_16x16x32_bf16 v[20:23], a[220:223], a[156:159], v[20:23]
  ds_read_b64_tr_b16 a[250:251], v227 offset:4096
  v_cvt_pk_bf16_f32 v245, v38, v39
  v_mfma_f32_16x16x32_bf16 v[16:19], a[220:223], a[140:143], v[96:99]
  v_exp_f32 v46, v46
  v_mfma_f32_16x16x32_bf16 v[16:19], a[216:219], a[136:139], v[16:19]
  ds_read_b64_tr_b16 a[252:253], v227 offset:8192
  v_cvt_pk_bf16_f32 v252, v44, v45
  v_mfma_f32_16x16x32_bf16 v[16:19], a[212:215], a[132:135], v[16:19]
  s_waitcnt lgkmcnt(3)
  v_exp_f32 v47, v47
  v_mfma_f32_16x16x32_bf16 v[16:19], a[208:211], a[128:131], v[16:19]
  ds_read_b64_tr_b16 a[254:255], v227 offset:12288
  v_cvt_pk_bf16_f32 v253, v46, v47
  v_mfma_f32_16x16x32_bf16 a[76:79], a[224:227], v[76:79], a[76:79]
  s_add_u32 m0, s64, 49152
  v_exp_f32 v48, v48
  v_mfma_f32_16x16x32_bf16 a[76:79], a[228:231], v[92:95], a[76:79]
  ds_read_b128 a[192:195], v216 offset:8192
  v_add_f32 v112, v112, v48
  v_mfma_f32_16x16x32_bf16 a[72:75], a[228:231], v[88:91], a[72:75]
  v_exp_f32 v49, v49
  v_mfma_f32_16x16x32_bf16 a[72:75], a[224:227], v[72:75], a[72:75]
  ds_read_b128 a[196:199], v217 offset:8192
  v_add_f32 v112, v112, v49
  v_mfma_f32_16x16x32_bf16 a[68:71], a[224:227], v[68:71], a[68:71]
  v_exp_f32 v50, v50
  v_mfma_f32_16x16x32_bf16 a[68:71], a[228:231], v[84:87], a[68:71]
  buffer_load_dwordx4 v232, s[48:51], s61 offen offset:0 lds
  v_mfma_f32_16x16x32_bf16 a[64:67], a[228:231], v[80:83], a[64:67]
  v_exp_f32 v51, v51
  v_mfma_f32_16x16x32_bf16 a[64:67], a[224:227], v[64:67], a[64:67]
  ds_read_b128 a[200:203], v218 offset:8192
  v_cvt_pk_bf16_f32 v210, v48, v49
  v_mfma_f32_16x16x32_bf16 a[80:83], a[232:235], v[64:67], a[80:83]
  v_exp_f32 v56, v56
  v_mfma_f32_16x16x32_bf16 a[80:83], a[236:239], v[80:83], a[80:83]
  ds_read_b128 a[204:207], v219 offset:8192
  v_add_f32 v112, v112, v50
  v_mfma_f32_16x16x32_bf16 a[84:87], a[236:239], v[84:87], a[84:87]
  v_exp_f32 v57, v57
  v_mfma_f32_16x16x32_bf16 a[84:87], a[232:235], v[68:71], a[84:87]
  ds_read_b128 a[208:211], v216 offset:12288
  v_add_f32 v112, v112, v51
  v_mfma_f32_16x16x32_bf16 a[88:91], a[232:235], v[72:75], a[88:91]
  v_exp_f32 v58, v58
  v_mfma_f32_16x16x32_bf16 a[88:91], a[236:239], v[88:91], a[88:91]
  buffer_load_dwordx4 v233, s[48:51], s61 offen offset:1024 lds
  v_mfma_f32_16x16x32_bf16 a[92:95], a[236:239], v[92:95], a[92:95]
  v_exp_f32 v59, v59
  v_mfma_f32_16x16x32_bf16 a[92:95], a[232:235], v[76:79], a[92:95]
  ds_read_b128 a[212:215], v217 offset:12288
  v_cvt_pk_bf16_f32 v211, v50, v51
  v_mfma_f32_16x16x32_bf16 a[108:111], a[240:243], v[76:79], a[108:111]
  v_exp_f32 v52, v52
  v_mfma_f32_16x16x32_bf16 a[108:111], a[244:247], v[92:95], a[108:111]
  ds_read_b128 a[216:219], v218 offset:12288
  v_cvt_pk_bf16_f32 v250, v56, v57
  v_mfma_f32_16x16x32_bf16 a[104:107], a[244:247], v[88:91], a[104:107]
  v_exp_f32 v53, v53
  v_mfma_f32_16x16x32_bf16 a[104:107], a[240:243], v[72:75], a[104:107]
  ds_read_b128 a[220:223], v219 offset:12288
  v_cvt_pk_bf16_f32 v251, v58, v59
  v_mfma_f32_16x16x32_bf16 a[100:103], a[240:243], v[68:71], a[100:103]
  v_exp_f32 v54, v54
  v_mfma_f32_16x16x32_bf16 a[100:103], a[244:247], v[84:87], a[100:103]
  buffer_load_dwordx4 v232, s[48:51], s61 offen offset:2048 lds
  v_mfma_f32_16x16x32_bf16 a[96:99], a[244:247], v[80:83], a[96:99]
  s_waitcnt lgkmcnt(8)
  v_exp_f32 v55, v55
  v_mfma_f32_16x16x32_bf16 a[96:99], a[240:243], v[64:67], a[96:99]
  v_add_f32 v113, v113, v52
  v_add_f32 v113, v113, v53
  v_mfma_f32_16x16x32_bf16 a[112:115], a[248:251], v[64:67], a[112:115]
  v_exp_f32 v60, v60
  v_mfma_f32_16x16x32_bf16 a[112:115], a[252:255], v[80:83], a[112:115]
  v_cvt_pk_bf16_f32 v246, v52, v53
  v_add_f32 v113, v113, v54
  v_mfma_f32_16x16x32_bf16 a[116:119], a[252:255], v[84:87], a[116:119]
  v_exp_f32 v61, v61
  v_mfma_f32_16x16x32_bf16 a[116:119], a[248:251], v[68:71], a[116:119]
  v_add_f32 v113, v113, v55
  v_cvt_pk_bf16_f32 v247, v54, v55
  v_mfma_f32_16x16x32_bf16 a[120:123], a[248:251], v[72:75], a[120:123]
  v_exp_f32 v62, v62
  v_mfma_f32_16x16x32_bf16 a[120:123], a[252:255], v[88:91], a[120:123]
  buffer_load_dwordx4 v233, s[48:51], s61 offen offset:3072 lds
  v_mfma_f32_16x16x32_bf16 a[124:127], a[252:255], v[92:95], a[124:127]
  v_exp_f32 v63, v63
  v_mfma_f32_16x16x32_bf16 a[124:127], a[248:251], v[76:79], a[124:127]
  v_cvt_pk_bf16_f32 v254, v60, v61
  v_cvt_pk_bf16_f32 v255, v62, v63
  v_mfma_f32_16x16x32_bf16 v[116:119], v[124:127], v[72:75], v[116:119]
  s_add_u32 s61, s61, 16384
  v_mfma_f32_16x16x32_bf16 v[116:119], v[124:127], v[88:91], v[116:119]
  s_waitcnt vmcnt(8) lgkmcnt(0)
  s_barrier
  v_mfma_f32_16x16x32_bf16 v[32:35], a[192:195], a[128:131], v[96:99]
  v_exp_f32 v0, v0
  v_mfma_f32_16x16x32_bf16 v[32:35], a[196:199], a[132:135], v[32:35]
  ds_read_b64_tr_b16 a[224:225], v220 offset:16384
  v_add_f32 v112, v112, v0
  v_mfma_f32_16x16x32_bf16 v[32:35], a[200:203], a[136:139], v[32:35]
  v_exp_f32 v1, v1
  v_mfma_f32_16x16x32_bf16 v[32:35], a[204:207], a[140:143], v[32:35]
  ds_read_b64_tr_b16 a[226:227], v220 offset:20480
  v_add_f32 v112, v112, v1
  v_mfma_f32_16x16x32_bf16 v[36:39], a[204:207], a[156:159], v[100:103]
  v_exp_f32 v2, v2
  v_mfma_f32_16x16x32_bf16 v[36:39], a[200:203], a[152:155], v[36:39]
  ds_read_b64_tr_b16 a[228:229], v220 offset:24576
  v_cvt_pk_bf16_f32 v64, v0, v1
  v_mfma_f32_16x16x32_bf16 v[36:39], a[196:199], a[148:151], v[36:39]
  v_exp_f32 v3, v3
  v_mfma_f32_16x16x32_bf16 v[36:39], a[192:195], a[144:147], v[36:39]
  ds_read_b64_tr_b16 a[230:231], v220 offset:28672
  v_add_f32 v112, v112, v2
  v_mfma_f32_16x16x32_bf16 v[40:43], a[192:195], a[160:163], v[104:107]
  v_exp_f32 v8, v8
  v_mfma_f32_16x16x32_bf16 v[40:43], a[196:199], a[164:167], v[40:43]
  ds_read_b64_tr_b16 a[232:233], v221 offset:16384
  v_add_f32 v112, v112, v3
  v_mfma_f32_16x16x32_bf16 v[40:43], a[200:203], a[168:171], v[40:43]
  v_exp_f32 v9, v9
  v_mfma_f32_16x16x32_bf16 v[40:43], a[204:207], a[172:175], v[40:43]
  ds_read_b64_tr_b16 a[234:235], v221 offset:20480
  v_cvt_pk_bf16_f32 v65, v2, v3
  v_mfma_f32_16x16x32_bf16 v[44:47], a[204:207], a[188:191], v[108:111]
  v_exp_f32 v10, v10
  v_mfma_f32_16x16x32_bf16 v[44:47], a[200:203], a[184:187], v[44:47]
  ds_read_b64_tr_b16 a[236:237], v221 offset:24576
  v_cvt_pk_bf16_f32 v72, v8, v9
  v_mfma_f32_16x16x32_bf16 v[44:47], a[196:199], a[180:183], v[44:47]
  v_exp_f32 v11, v11
  v_mfma_f32_16x16x32_bf16 v[44:47], a[192:195], a[176:179], v[44:47]
  ds_read_b64_tr_b16 a[238:239], v221 offset:28672
  v_cvt_pk_bf16_f32 v73, v10, v11
  v_mfma_f32_16x16x32_bf16 v[60:63], a[208:211], a[176:179], v[108:111]
  v_exp_f32 v4, v4
  v_mfma_f32_16x16x32_bf16 v[60:63], a[212:215], a[180:183], v[60:63]
  ds_read_b64_tr_b16 a[240:241], v222 offset:16384
  v_add_f32 v113, v113, v4
  v_mfma_f32_16x16x32_bf16 v[60:63], a[216:219], a[184:187], v[60:63]
  v_exp_f32 v5, v5
  v_mfma_f32_16x16x32_bf16 v[60:63], a[220:223], a[188:191], v[60:63]
  ds_read_b64_tr_b16 a[242:243], v222 offset:20480
  v_add_f32 v113, v113, v5
  v_mfma_f32_16x16x32_bf16 v[56:59], a[220:223], a[172:175], v[104:107]
  v_exp_f32 v6, v6
  v_mfma_f32_16x16x32_bf16 v[56:59], a[216:219], a[168:171], v[56:59]
  ds_read_b64_tr_b16 a[244:245], v222 offset:24576
  v_cvt_pk_bf16_f32 v68, v4, v5
  v_mfma_f32_16x16x32_bf16 v[56:59], a[212:215], a[164:167], v[56:59]
  v_exp_f32 v7, v7
  v_mfma_f32_16x16x32_bf16 v[56:59], a[208:211], a[160:163], v[56:59]
  ds_read_b64_tr_b16 a[246:247], v222 offset:28672
  v_add_f32 v113, v113, v6
  v_mfma_f32_16x16x32_bf16 v[52:55], a[208:211], a[144:147], v[100:103]
  v_exp_f32 v12, v12
  v_mfma_f32_16x16x32_bf16 v[52:55], a[212:215], a[148:151], v[52:55]
  ds_read_b64_tr_b16 a[248:249], v223 offset:16384
  v_add_f32 v113, v113, v7
  v_mfma_f32_16x16x32_bf16 v[52:55], a[216:219], a[152:155], v[52:55]
  v_exp_f32 v13, v13
  v_mfma_f32_16x16x32_bf16 v[52:55], a[220:223], a[156:159], v[52:55]
  ds_read_b64_tr_b16 a[250:251], v223 offset:20480
  v_cvt_pk_bf16_f32 v69, v6, v7
  v_mfma_f32_16x16x32_bf16 v[48:51], a[220:223], a[140:143], v[96:99]
  v_exp_f32 v14, v14
  v_mfma_f32_16x16x32_bf16 v[48:51], a[216:219], a[136:139], v[48:51]
  ds_read_b64_tr_b16 a[252:253], v223 offset:24576
  v_cvt_pk_bf16_f32 v76, v12, v13
  v_mfma_f32_16x16x32_bf16 v[48:51], a[212:215], a[132:135], v[48:51]
  s_waitcnt lgkmcnt(3)
  v_exp_f32 v15, v15
  v_mfma_f32_16x16x32_bf16 v[48:51], a[208:211], a[128:131], v[48:51]
  ds_read_b64_tr_b16 a[254:255], v223 offset:28672
  v_cvt_pk_bf16_f32 v77, v14, v15
  v_mfma_f32_16x16x32_bf16 a[12:15], a[224:227], v[204:207], a[12:15]
  v_exp_f32 v16, v16
  v_mfma_f32_16x16x32_bf16 a[12:15], a[228:231], v[252:255], a[12:15]
  ds_read_b128 a[192:195], v216 offset:16384
  v_add_f32 v112, v112, v16
  v_mfma_f32_16x16x32_bf16 a[8:11], a[228:231], v[248:251], a[8:11]
  v_exp_f32 v17, v17
  v_mfma_f32_16x16x32_bf16 a[8:11], a[224:227], v[200:203], a[8:11]
  ds_read_b128 a[196:199], v217 offset:16384
  v_add_f32 v112, v112, v17
  v_mfma_f32_16x16x32_bf16 a[4:7], a[224:227], v[196:199], a[4:7]
  s_add_u32 s72, s11, 8388608
  v_exp_f32 v18, v18
  v_mfma_f32_16x16x32_bf16 a[4:7], a[228:231], v[244:247], a[4:7]
  buffer_load_dwordx4 v[160:163], v213, s[52:55], s72 offen sc1
  v_mfma_f32_16x16x32_bf16 a[0:3], a[228:231], v[208:211], a[0:3]
  v_exp_f32 v19, v19
  v_mfma_f32_16x16x32_bf16 a[0:3], a[224:227], v[192:195], a[0:3]
  ds_read_b128 a[200:203], v218 offset:16384
  v_cvt_pk_bf16_f32 v66, v16, v17
  v_mfma_f32_16x16x32_bf16 a[16:19], a[232:235], v[192:195], a[16:19]
  v_exp_f32 v24, v24
  v_mfma_f32_16x16x32_bf16 a[16:19], a[236:239], v[208:211], a[16:19]
  ds_read_b128 a[204:207], v219 offset:16384
  v_add_f32 v112, v112, v18
  v_mfma_f32_16x16x32_bf16 a[20:23], a[236:239], v[244:247], a[20:23]
  v_exp_f32 v25, v25
  v_mfma_f32_16x16x32_bf16 a[20:23], a[232:235], v[196:199], a[20:23]
  ds_read_b128 a[208:211], v216 offset:20480
  v_add_f32 v112, v112, v19
  v_mfma_f32_16x16x32_bf16 a[24:27], a[232:235], v[200:203], a[24:27]
  s_add_u32 s72, s11, 8421376
  v_exp_f32 v26, v26
  v_mfma_f32_16x16x32_bf16 a[24:27], a[236:239], v[248:251], a[24:27]
  buffer_load_dwordx4 v[164:167], v213, s[52:55], s72 offen sc1
  v_mfma_f32_16x16x32_bf16 a[28:31], a[236:239], v[252:255], a[28:31]
  v_exp_f32 v27, v27
  v_mfma_f32_16x16x32_bf16 a[28:31], a[232:235], v[204:207], a[28:31]
  ds_read_b128 a[212:215], v217 offset:20480
  v_cvt_pk_bf16_f32 v67, v18, v19
  v_mfma_f32_16x16x32_bf16 a[44:47], a[240:243], v[204:207], a[44:47]
  v_exp_f32 v20, v20
  v_mfma_f32_16x16x32_bf16 a[44:47], a[244:247], v[252:255], a[44:47]
  ds_read_b128 a[216:219], v218 offset:20480
  v_cvt_pk_bf16_f32 v74, v24, v25
  v_mfma_f32_16x16x32_bf16 a[40:43], a[244:247], v[248:251], a[40:43]
  v_exp_f32 v21, v21
  v_mfma_f32_16x16x32_bf16 a[40:43], a[240:243], v[200:203], a[40:43]
  ds_read_b128 a[220:223], v219 offset:20480
  v_cvt_pk_bf16_f32 v75, v26, v27
  v_mfma_f32_16x16x32_bf16 a[36:39], a[240:243], v[196:199], a[36:39]
  s_add_u32 s72, s11, 8454144
  v_exp_f32 v22, v22
  v_mfma_f32_16x16x32_bf16 a[36:39], a[244:247], v[244:247], a[36:39]
  buffer_load_dwordx4 v[168:171], v213, s[52:55], s72 offen sc1
  v_mfma_f32_16x16x32_bf16 a[32:35], a[244:247], v[208:211], a[32:35]
  s_waitcnt lgkmcnt(8)
  v_exp_f32 v23, v23
  v_mfma_f32_16x16x32_bf16 a[32:35], a[240:243], v[192:195], a[32:35]
  v_add_f32 v113, v113, v20
  v_add_f32 v113, v113, v21
  v_mfma_f32_16x16x32_bf16 a[48:51], a[248:251], v[192:195], a[48:51]
  v_exp_f32 v28, v28
  v_mfma_f32_16x16x32_bf16 a[48:51], a[252:255], v[208:211], a[48:51]
  v_cvt_pk_bf16_f32 v70, v20, v21
  v_add_f32 v113, v113, v22
  v_mfma_f32_16x16x32_bf16 a[52:55], a[252:255], v[244:247], a[52:55]
  v_exp_f32 v29, v29
  v_mfma_f32_16x16x32_bf16 a[52:55], a[248:251], v[196:199], a[52:55]
  v_add_f32 v113, v113, v23
  v_cvt_pk_bf16_f32 v71, v22, v23
  v_mfma_f32_16x16x32_bf16 a[56:59], a[248:251], v[200:203], a[56:59]
  s_add_u32 s72, s11, 8486912
  v_exp_f32 v30, v30
  v_mfma_f32_16x16x32_bf16 a[56:59], a[252:255], v[248:251], a[56:59]
  buffer_load_dwordx4 v[172:175], v213, s[52:55], s72 offen sc1
  v_mfma_f32_16x16x32_bf16 a[60:63], a[252:255], v[252:255], a[60:63]
  v_exp_f32 v31, v31
  v_mfma_f32_16x16x32_bf16 a[60:63], a[248:251], v[204:207], a[60:63]
  v_cvt_pk_bf16_f32 v78, v28, v29
  v_cvt_pk_bf16_f32 v79, v30, v31
  v_mfma_f32_16x16x32_bf16 v[120:123], v[124:127], v[204:207], v[120:123]
  v_mfma_f32_16x16x32_bf16 v[120:123], v[124:127], v[252:255], v[120:123]
  s_waitcnt lgkmcnt(0)
  v_mfma_f32_16x16x32_bf16 v[0:3], a[192:195], a[128:131], v[96:99]
  v_exp_f32 v32, v32
  v_mfma_f32_16x16x32_bf16 v[0:3], a[196:199], a[132:135], v[0:3]
  ds_read_b64_tr_b16 a[224:225], v224 offset:16384
  v_add_f32 v112, v112, v32
  v_mfma_f32_16x16x32_bf16 v[0:3], a[200:203], a[136:139], v[0:3]
  v_exp_f32 v33, v33
  v_mfma_f32_16x16x32_bf16 v[0:3], a[204:207], a[140:143], v[0:3]
  ds_read_b64_tr_b16 a[226:227], v224 offset:20480
  v_add_f32 v112, v112, v33
  v_mfma_f32_16x16x32_bf16 v[4:7], a[204:207], a[156:159], v[100:103]
  v_exp_f32 v34, v34
  v_mfma_f32_16x16x32_bf16 v[4:7], a[200:203], a[152:155], v[4:7]
  ds_read_b64_tr_b16 a[228:229], v224 offset:24576
  v_cvt_pk_bf16_f32 v80, v32, v33
  v_mfma_f32_16x16x32_bf16 v[4:7], a[196:199], a[148:151], v[4:7]
  v_exp_f32 v35, v35
  v_mfma_f32_16x16x32_bf16 v[4:7], a[192:195], a[144:147], v[4:7]
  ds_read_b64_tr_b16 a[230:231], v224 offset:28672
  v_add_f32 v112, v112, v34
  v_mfma_f32_16x16x32_bf16 v[8:11], a[192:195], a[160:163], v[104:107]
  v_exp_f32 v40, v40
  v_mfma_f32_16x16x32_bf16 v[8:11], a[196:199], a[164:167], v[8:11]
  ds_read_b64_tr_b16 a[232:233], v225 offset:16384
  v_add_f32 v112, v112, v35
  v_mfma_f32_16x16x32_bf16 v[8:11], a[200:203], a[168:171], v[8:11]
  v_exp_f32 v41, v41
  v_mfma_f32_16x16x32_bf16 v[8:11], a[204:207], a[172:175], v[8:11]
  ds_read_b64_tr_b16 a[234:235], v225 offset:20480
  v_cvt_pk_bf16_f32 v81, v34, v35
  v_mfma_f32_16x16x32_bf16 v[12:15], a[204:207], a[188:191], v[108:111]
  v_exp_f32 v42, v42
  v_mfma_f32_16x16x32_bf16 v[12:15], a[200:203], a[184:187], v[12:15]
  ds_read_b64_tr_b16 a[236:237], v225 offset:24576
  v_cvt_pk_bf16_f32 v88, v40, v41
  v_mfma_f32_16x16x32_bf16 v[12:15], a[196:199], a[180:183], v[12:15]
  v_exp_f32 v43, v43
  v_mfma_f32_16x16x32_bf16 v[12:15], a[192:195], a[176:179], v[12:15]
  ds_read_b64_tr_b16 a[238:239], v225 offset:28672
  v_cvt_pk_bf16_f32 v89, v42, v43
  v_mfma_f32_16x16x32_bf16 v[28:31], a[208:211], a[176:179], v[108:111]
  v_exp_f32 v36, v36
  v_mfma_f32_16x16x32_bf16 v[28:31], a[212:215], a[180:183], v[28:31]
  ds_read_b64_tr_b16 a[240:241], v226 offset:16384
  v_add_f32 v113, v113, v36
  v_mfma_f32_16x16x32_bf16 v[28:31], a[216:219], a[184:187], v[28:31]
  v_exp_f32 v37, v37
  v_mfma_f32_16x16x32_bf16 v[28:31], a[220:223], a[188:191], v[28:31]
  ds_read_b64_tr_b16 a[242:243], v226 offset:20480
  v_add_f32 v113, v113, v37
  v_mfma_f32_16x16x32_bf16 v[24:27], a[220:223], a[172:175], v[104:107]
  v_exp_f32 v38, v38
  v_mfma_f32_16x16x32_bf16 v[24:27], a[216:219], a[168:171], v[24:27]
  ds_read_b64_tr_b16 a[244:245], v226 offset:24576
  v_cvt_pk_bf16_f32 v84, v36, v37
  v_mfma_f32_16x16x32_bf16 v[24:27], a[212:215], a[164:167], v[24:27]
  v_exp_f32 v39, v39
  v_mfma_f32_16x16x32_bf16 v[24:27], a[208:211], a[160:163], v[24:27]
  ds_read_b64_tr_b16 a[246:247], v226 offset:28672
  v_add_f32 v113, v113, v38
  v_mfma_f32_16x16x32_bf16 v[20:23], a[208:211], a[144:147], v[100:103]
  v_exp_f32 v44, v44
  v_mfma_f32_16x16x32_bf16 v[20:23], a[212:215], a[148:151], v[20:23]
  ds_read_b64_tr_b16 a[248:249], v227 offset:16384
  v_add_f32 v113, v113, v39
  v_mfma_f32_16x16x32_bf16 v[20:23], a[216:219], a[152:155], v[20:23]
  v_exp_f32 v45, v45
  v_mfma_f32_16x16x32_bf16 v[20:23], a[220:223], a[156:159], v[20:23]
  ds_read_b64_tr_b16 a[250:251], v227 offset:20480
  v_cvt_pk_bf16_f32 v85, v38, v39
  v_mfma_f32_16x16x32_bf16 v[16:19], a[220:223], a[140:143], v[96:99]
  v_exp_f32 v46, v46
  v_mfma_f32_16x16x32_bf16 v[16:19], a[216:219], a[136:139], v[16:19]
  ds_read_b64_tr_b16 a[252:253], v227 offset:24576
  v_cvt_pk_bf16_f32 v92, v44, v45
  v_mfma_f32_16x16x32_bf16 v[16:19], a[212:215], a[132:135], v[16:19]
  s_waitcnt lgkmcnt(3)
  v_exp_f32 v47, v47
  v_mfma_f32_16x16x32_bf16 v[16:19], a[208:211], a[128:131], v[16:19]
  ds_read_b64_tr_b16 a[254:255], v227 offset:28672
  v_cvt_pk_bf16_f32 v93, v46, v47
  v_mfma_f32_16x16x32_bf16 a[76:79], a[224:227], v[204:207], a[76:79]
  v_exp_f32 v48, v48
  v_mfma_f32_16x16x32_bf16 a[76:79], a[228:231], v[252:255], a[76:79]
  ds_read_b128 a[192:195], v216 offset:24576
  v_add_f32 v112, v112, v48
  v_mfma_f32_16x16x32_bf16 a[72:75], a[228:231], v[248:251], a[72:75]
  v_exp_f32 v49, v49
  v_mfma_f32_16x16x32_bf16 a[72:75], a[224:227], v[200:203], a[72:75]
  ds_read_b128 a[196:199], v217 offset:24576
  v_add_f32 v112, v112, v49
  v_mfma_f32_16x16x32_bf16 a[68:71], a[224:227], v[196:199], a[68:71]
  s_add_u32 s72, s11, 8519680
  v_exp_f32 v50, v50
  v_mfma_f32_16x16x32_bf16 a[68:71], a[228:231], v[244:247], a[68:71]
  buffer_load_dwordx4 v[176:179], v213, s[52:55], s72 offen sc1
  v_mfma_f32_16x16x32_bf16 a[64:67], a[228:231], v[208:211], a[64:67]
  v_exp_f32 v51, v51
  v_mfma_f32_16x16x32_bf16 a[64:67], a[224:227], v[192:195], a[64:67]
  ds_read_b128 a[200:203], v218 offset:24576
  v_cvt_pk_bf16_f32 v82, v48, v49
  v_mfma_f32_16x16x32_bf16 a[80:83], a[232:235], v[192:195], a[80:83]
  v_exp_f32 v56, v56
  v_mfma_f32_16x16x32_bf16 a[80:83], a[236:239], v[208:211], a[80:83]
  ds_read_b128 a[204:207], v219 offset:24576
  v_add_f32 v112, v112, v50
  v_mfma_f32_16x16x32_bf16 a[84:87], a[236:239], v[244:247], a[84:87]
  v_exp_f32 v57, v57
  v_mfma_f32_16x16x32_bf16 a[84:87], a[232:235], v[196:199], a[84:87]
  ds_read_b128 a[208:211], v216 offset:28672
  v_add_f32 v112, v112, v51
  v_mfma_f32_16x16x32_bf16 a[88:91], a[232:235], v[200:203], a[88:91]
  s_add_u32 s72, s11, 8552448
  v_exp_f32 v58, v58
  v_mfma_f32_16x16x32_bf16 a[88:91], a[236:239], v[248:251], a[88:91]
  buffer_load_dwordx4 v[180:183], v213, s[52:55], s72 offen sc1
  v_mfma_f32_16x16x32_bf16 a[92:95], a[236:239], v[252:255], a[92:95]
  v_exp_f32 v59, v59
  v_mfma_f32_16x16x32_bf16 a[92:95], a[232:235], v[204:207], a[92:95]
  ds_read_b128 a[212:215], v217 offset:28672
  v_cvt_pk_bf16_f32 v83, v50, v51
  v_mfma_f32_16x16x32_bf16 a[108:111], a[240:243], v[204:207], a[108:111]
  v_exp_f32 v52, v52
  v_mfma_f32_16x16x32_bf16 a[108:111], a[244:247], v[252:255], a[108:111]
  ds_read_b128 a[216:219], v218 offset:28672
  v_cvt_pk_bf16_f32 v90, v56, v57
  v_mfma_f32_16x16x32_bf16 a[104:107], a[244:247], v[248:251], a[104:107]
  v_exp_f32 v53, v53
  v_mfma_f32_16x16x32_bf16 a[104:107], a[240:243], v[200:203], a[104:107]
  ds_read_b128 a[220:223], v219 offset:28672
  v_cvt_pk_bf16_f32 v91, v58, v59
  v_mfma_f32_16x16x32_bf16 a[100:103], a[240:243], v[196:199], a[100:103]
  s_add_u32 s72, s11, 8585216
  v_exp_f32 v54, v54
  v_mfma_f32_16x16x32_bf16 a[100:103], a[244:247], v[244:247], a[100:103]
  buffer_load_dwordx4 v[184:187], v213, s[52:55], s72 offen sc1
  v_mfma_f32_16x16x32_bf16 a[96:99], a[244:247], v[208:211], a[96:99]
  s_waitcnt lgkmcnt(8)
  v_exp_f32 v55, v55
  v_mfma_f32_16x16x32_bf16 a[96:99], a[240:243], v[192:195], a[96:99]
  v_add_f32 v113, v113, v52
  v_add_f32 v113, v113, v53
  v_mfma_f32_16x16x32_bf16 a[112:115], a[248:251], v[192:195], a[112:115]
  v_exp_f32 v60, v60
  v_mfma_f32_16x16x32_bf16 a[112:115], a[252:255], v[208:211], a[112:115]
  v_cvt_pk_bf16_f32 v86, v52, v53
  v_add_f32 v113, v113, v54
  v_mfma_f32_16x16x32_bf16 a[116:119], a[252:255], v[244:247], a[116:119]
  v_exp_f32 v61, v61
  v_mfma_f32_16x16x32_bf16 a[116:119], a[248:251], v[196:199], a[116:119]
  v_add_f32 v113, v113, v55
  v_cvt_pk_bf16_f32 v87, v54, v55
  v_mfma_f32_16x16x32_bf16 a[120:123], a[248:251], v[200:203], a[120:123]
  s_add_u32 s72, s11, 8617984
  v_exp_f32 v62, v62
  v_mfma_f32_16x16x32_bf16 a[120:123], a[252:255], v[248:251], a[120:123]
  buffer_load_dwordx4 v[188:191], v213, s[52:55], s72 offen sc1
  v_mfma_f32_16x16x32_bf16 a[124:127], a[252:255], v[252:255], a[124:127]
  v_exp_f32 v63, v63
  v_mfma_f32_16x16x32_bf16 a[124:127], a[248:251], v[204:207], a[124:127]
  v_cvt_pk_bf16_f32 v94, v60, v61
  v_cvt_pk_bf16_f32 v95, v62, v63
  v_mfma_f32_16x16x32_bf16 v[116:119], v[124:127], v[200:203], v[116:119]
  v_mfma_f32_16x16x32_bf16 v[116:119], v[124:127], v[248:251], v[116:119]
  s_waitcnt vmcnt(8) lgkmcnt(0)
  s_barrier
  v_mfma_f32_16x16x32_bf16 v[32:35], a[192:195], a[128:131], v[96:99]
  v_exp_f32 v0, v0
  v_mfma_f32_16x16x32_bf16 v[32:35], a[196:199], a[132:135], v[32:35]
  ds_read_b64_tr_b16 a[224:225], v220 offset:32768
  v_add_f32 v112, v112, v0
  v_mfma_f32_16x16x32_bf16 v[32:35], a[200:203], a[136:139], v[32:35]
  v_exp_f32 v1, v1
  v_mfma_f32_16x16x32_bf16 v[32:35], a[204:207], a[140:143], v[32:35]
  ds_read_b64_tr_b16 a[226:227], v220 offset:36864
  v_add_f32 v112, v112, v1
  v_mfma_f32_16x16x32_bf16 v[36:39], a[204:207], a[156:159], v[100:103]
  v_exp_f32 v2, v2
  v_mfma_f32_16x16x32_bf16 v[36:39], a[200:203], a[152:155], v[36:39]
  ds_read_b64_tr_b16 a[228:229], v220 offset:40960
  v_cvt_pk_bf16_f32 v192, v0, v1
  v_mfma_f32_16x16x32_bf16 v[36:39], a[196:199], a[148:151], v[36:39]
  v_exp_f32 v3, v3
  v_mfma_f32_16x16x32_bf16 v[36:39], a[192:195], a[144:147], v[36:39]
  ds_read_b64_tr_b16 a[230:231], v220 offset:45056
  v_add_f32 v112, v112, v2
  v_mfma_f32_16x16x32_bf16 v[40:43], a[192:195], a[160:163], v[104:107]
  v_exp_f32 v8, v8
  v_mfma_f32_16x16x32_bf16 v[40:43], a[196:199], a[164:167], v[40:43]
  ds_read_b64_tr_b16 a[232:233], v221 offset:32768
  v_add_f32 v112, v112, v3
  v_mfma_f32_16x16x32_bf16 v[40:43], a[200:203], a[168:171], v[40:43]
  v_exp_f32 v9, v9
  v_mfma_f32_16x16x32_bf16 v[40:43], a[204:207], a[172:175], v[40:43]
  ds_read_b64_tr_b16 a[234:235], v221 offset:36864
  v_cvt_pk_bf16_f32 v193, v2, v3
  v_mfma_f32_16x16x32_bf16 v[44:47], a[204:207], a[188:191], v[108:111]
  v_exp_f32 v10, v10
  v_mfma_f32_16x16x32_bf16 v[44:47], a[200:203], a[184:187], v[44:47]
  ds_read_b64_tr_b16 a[236:237], v221 offset:40960
  v_cvt_pk_bf16_f32 v200, v8, v9
  v_mfma_f32_16x16x32_bf16 v[44:47], a[196:199], a[180:183], v[44:47]
  v_exp_f32 v11, v11
  v_mfma_f32_16x16x32_bf16 v[44:47], a[192:195], a[176:179], v[44:47]
  ds_read_b64_tr_b16 a[238:239], v221 offset:45056
  v_cvt_pk_bf16_f32 v201, v10, v11
  v_mfma_f32_16x16x32_bf16 v[60:63], a[208:211], a[176:179], v[108:111]
  v_exp_f32 v4, v4
  v_mfma_f32_16x16x32_bf16 v[60:63], a[212:215], a[180:183], v[60:63]
  ds_read_b64_tr_b16 a[240:241], v222 offset:32768
  v_add_f32 v113, v113, v4
  v_mfma_f32_16x16x32_bf16 v[60:63], a[216:219], a[184:187], v[60:63]
  v_exp_f32 v5, v5
  v_mfma_f32_16x16x32_bf16 v[60:63], a[220:223], a[188:191], v[60:63]
  ds_read_b64_tr_b16 a[242:243], v222 offset:36864
  v_add_f32 v113, v113, v5
  v_mfma_f32_16x16x32_bf16 v[56:59], a[220:223], a[172:175], v[104:107]
  v_exp_f32 v6, v6
  v_mfma_f32_16x16x32_bf16 v[56:59], a[216:219], a[168:171], v[56:59]
  ds_read_b64_tr_b16 a[244:245], v222 offset:40960
  v_cvt_pk_bf16_f32 v196, v4, v5
  v_mfma_f32_16x16x32_bf16 v[56:59], a[212:215], a[164:167], v[56:59]
  v_exp_f32 v7, v7
  v_mfma_f32_16x16x32_bf16 v[56:59], a[208:211], a[160:163], v[56:59]
  ds_read_b64_tr_b16 a[246:247], v222 offset:45056
  v_add_f32 v113, v113, v6
  v_mfma_f32_16x16x32_bf16 v[52:55], a[208:211], a[144:147], v[100:103]
  v_exp_f32 v12, v12
  v_mfma_f32_16x16x32_bf16 v[52:55], a[212:215], a[148:151], v[52:55]
  ds_read_b64_tr_b16 a[248:249], v223 offset:32768
  v_add_f32 v113, v113, v7
  v_mfma_f32_16x16x32_bf16 v[52:55], a[216:219], a[152:155], v[52:55]
L_pad5:
  s_cbranch_execz L_st0
  v_exp_f32 v13, v13
  v_mfma_f32_16x16x32_bf16 v[52:55], a[220:223], a[156:159], v[52:55]
  ds_read_b64_tr_b16 a[250:251], v223 offset:36864
  v_cvt_pk_bf16_f32 v197, v6, v7
  v_mfma_f32_16x16x32_bf16 v[48:51], a[220:223], a[140:143], v[96:99]
  v_exp_f32 v14, v14
  v_mfma_f32_16x16x32_bf16 v[48:51], a[216:219], a[136:139], v[48:51]
  ds_read_b64_tr_b16 a[252:253], v223 offset:40960
  v_cvt_pk_bf16_f32 v204, v12, v13
  v_mfma_f32_16x16x32_bf16 v[48:51], a[212:215], a[132:135], v[48:51]
  s_waitcnt lgkmcnt(3)
  v_exp_f32 v15, v15
  v_mfma_f32_16x16x32_bf16 v[48:51], a[208:211], a[128:131], v[48:51]
  ds_read_b64_tr_b16 a[254:255], v223 offset:45056
  v_cvt_pk_bf16_f32 v205, v14, v15
  v_mfma_f32_16x16x32_bf16 a[12:15], a[224:227], v[76:79], a[12:15]
  s_add_u32 m0, s64, 65536
  s_add_u32 s13, s13, s14
  s_cmp_eq_u32 s13, s27
  s_cselect_b32 s13, 0, s13
  v_exp_f32 v16, v16
  v_mfma_f32_16x16x32_bf16 a[12:15], a[228:231], v[92:95], a[12:15]
  ds_read_b64_tr_b16 a[192:193], v224 offset:32768
  v_add_f32 v112, v112, v16
  v_mfma_f32_16x16x32_bf16 a[8:11], a[228:231], v[88:91], a[8:11]
  buffer_load_dwordx4 v236, s[40:43], s13 offen offset:0 lds
  v_exp_f32 v17, v17
  v_mfma_f32_16x16x32_bf16 a[8:11], a[224:227], v[72:75], a[8:11]
  ds_read_b64_tr_b16 a[194:195], v224 offset:36864
  v_add_f32 v112, v112, v17
  v_mfma_f32_16x16x32_bf16 a[4:7], a[224:227], v[68:71], a[4:7]
  v_exp_f32 v18, v18
  v_mfma_f32_16x16x32_bf16 a[4:7], a[228:231], v[84:87], a[4:7]
  ds_read_b64_tr_b16 a[196:197], v224 offset:40960
  v_cvt_pk_bf16_f32 v194, v16, v17
  v_mfma_f32_16x16x32_bf16 a[0:3], a[228:231], v[80:83], a[0:3]
  buffer_load_dwordx4 v237, s[40:43], s13 offen offset:1024 lds
  v_exp_f32 v19, v19
  v_mfma_f32_16x16x32_bf16 a[0:3], a[224:227], v[64:67], a[0:3]
  ds_read_b64_tr_b16 a[198:199], v224 offset:45056
  v_add_f32 v112, v112, v18
  v_mfma_f32_16x16x32_bf16 a[16:19], a[232:235], v[64:67], a[16:19]
  v_exp_f32 v24, v24
  v_mfma_f32_16x16x32_bf16 a[16:19], a[236:239], v[80:83], a[16:19]
  ds_read_b64_tr_b16 a[200:201], v225 offset:32768
  v_add_f32 v112, v112, v19
  v_mfma_f32_16x16x32_bf16 a[20:23], a[236:239], v[84:87], a[20:23]
  buffer_load_dwordx4 v238, s[40:43], s13 offen offset:2048 lds
  v_exp_f32 v25, v25
  v_mfma_f32_16x16x32_bf16 a[20:23], a[232:235], v[68:71], a[20:23]
  ds_read_b64_tr_b16 a[202:203], v225 offset:36864
  v_cvt_pk_bf16_f32 v195, v18, v19
  v_mfma_f32_16x16x32_bf16 a[24:27], a[232:235], v[72:75], a[24:27]
  v_exp_f32 v26, v26
  v_mfma_f32_16x16x32_bf16 a[24:27], a[236:239], v[88:91], a[24:27]
  ds_read_b64_tr_b16 a[204:205], v225 offset:40960
  v_cvt_pk_bf16_f32 v202, v24, v25
  v_mfma_f32_16x16x32_bf16 a[28:31], a[236:239], v[92:95], a[28:31]
  buffer_load_dwordx4 v239, s[40:43], s13 offen offset:3072 lds
  v_exp_f32 v27, v27
  v_mfma_f32_16x16x32_bf16 a[28:31], a[232:235], v[76:79], a[28:31]
  ds_read_b64_tr_b16 a[206:207], v225 offset:45056
  v_cvt_pk_bf16_f32 v203, v26, v27
  v_mfma_f32_16x16x32_bf16 a[44:47], a[240:243], v[76:79], a[44:47]
  s_add_u32 m0, s64, 81920
  s_add_u32 s13, s13, s14
  s_cmp_eq_u32 s13, s27
  s_cselect_b32 s13, 0, s13
  v_exp_f32 v20, v20
  v_mfma_f32_16x16x32_bf16 a[44:47], a[244:247], v[92:95], a[44:47]
  ds_read_b64_tr_b16 a[208:209], v226 offset:32768
  v_add_f32 v113, v113, v20
  v_mfma_f32_16x16x32_bf16 a[40:43], a[244:247], v[88:91], a[40:43]
  buffer_load_dwordx4 v236, s[40:43], s13 offen offset:0 lds
  v_exp_f32 v21, v21
  v_mfma_f32_16x16x32_bf16 a[40:43], a[240:243], v[72:75], a[40:43]
  ds_read_b64_tr_b16 a[210:211], v226 offset:36864
  v_add_f32 v113, v113, v21
  v_mfma_f32_16x16x32_bf16 a[36:39], a[240:243], v[68:71], a[36:39]
  v_exp_f32 v22, v22
  v_mfma_f32_16x16x32_bf16 a[36:39], a[244:247], v[84:87], a[36:39]
  ds_read_b64_tr_b16 a[212:213], v226 offset:40960
  v_cvt_pk_bf16_f32 v198, v20, v21
  v_mfma_f32_16x16x32_bf16 a[32:35], a[244:247], v[80:83], a[32:35]
  buffer_load_dwordx4 v237, s[40:43], s13 offen offset:1024 lds
  s_waitcnt lgkmcnt(11)
  v_exp_f32 v23, v23
  v_mfma_f32_16x16x32_bf16 a[32:35], a[240:243], v[64:67], a[32:35]
  ds_read_b64_tr_b16 a[214:215], v226 offset:45056
  v_add_f32 v113, v113, v22
  v_mfma_f32_16x16x32_bf16 a[48:51], a[248:251], v[64:67], a[48:51]
  v_exp_f32 v28, v28
  v_mfma_f32_16x16x32_bf16 a[48:51], a[252:255], v[80:83], a[48:51]
  ds_read_b64_tr_b16 a[216:217], v227 offset:32768
  v_add_f32 v113, v113, v23
  v_mfma_f32_16x16x32_bf16 a[52:55], a[252:255], v[84:87], a[52:55]
  buffer_load_dwordx4 v238, s[40:43], s13 offen offset:2048 lds
  v_exp_f32 v29, v29
  v_mfma_f32_16x16x32_bf16 a[52:55], a[248:251], v[68:71], a[52:55]
  ds_read_b64_tr_b16 a[218:219], v227 offset:36864
  v_cvt_pk_bf16_f32 v199, v22, v23
  v_mfma_f32_16x16x32_bf16 a[56:59], a[248:251], v[72:75], a[56:59]
  v_exp_f32 v30, v30
  v_mfma_f32_16x16x32_bf16 a[56:59], a[252:255], v[88:91], a[56:59]
  ds_read_b64_tr_b16 a[220:221], v227 offset:40960
  v_cvt_pk_bf16_f32 v206, v28, v29
  v_mfma_f32_16x16x32_bf16 a[60:63], a[252:255], v[92:95], a[60:63]
  buffer_load_dwordx4 v239, s[40:43], s13 offen offset:3072 lds
  v_exp_f32 v31, v31
  v_mfma_f32_16x16x32_bf16 a[60:63], a[248:251], v[76:79], a[60:63]
  ds_read_b64_tr_b16 a[222:223], v227 offset:45056
  v_cvt_pk_bf16_f32 v207, v30, v31
  v_mfma_f32_16x16x32_bf16 v[120:123], v[124:127], v[76:79], v[120:123]
  v_mfma_f32_16x16x32_bf16 v[120:123], v[124:127], v[92:95], v[120:123]
  s_waitcnt lgkmcnt(0)
  v_mfma_f32_16x16x32_bf16 a[76:79], a[192:195], v[76:79], a[76:79]
  ds_read_b64_tr_b16 a[224:225], v220 offset:49152
  s_add_u32 m0, s64, 0
  v_mfma_f32_16x16x32_bf16 a[76:79], a[196:199], v[92:95], a[76:79]
  ds_read_b64_tr_b16 a[226:227], v220 offset:53248
  s_add_u32 s13, s13, s14
  v_mfma_f32_16x16x32_bf16 a[72:75], a[196:199], v[88:91], a[72:75]
  ds_read_b64_tr_b16 a[228:229], v220 offset:57344
  s_cmp_eq_u32 s13, s27
  v_mfma_f32_16x16x32_bf16 a[72:75], a[192:195], v[72:75], a[72:75]
  ds_read_b64_tr_b16 a[230:231], v220 offset:61440
  s_cselect_b32 s13, 0, s13
  v_mfma_f32_16x16x32_bf16 a[68:71], a[192:195], v[68:71], a[68:71]
  ds_read_b64_tr_b16 a[232:233], v221 offset:49152
  s_mov_b32 s94, 0x53800000
  v_mfma_f32_16x16x32_bf16 a[68:71], a[196:199], v[84:87], a[68:71]
  ds_read_b64_tr_b16 a[234:235], v221 offset:53248
  s_mov_b64 vcc, 0
  v_mfma_f32_16x16x32_bf16 a[64:67], a[196:199], v[80:83], a[64:67]
  ds_read_b64_tr_b16 a[236:237], v221 offset:57344
  v_mfma_f32_16x16x32_bf16 a[64:67], a[192:195], v[64:67], a[64:67]
  ds_read_b64_tr_b16 a[238:239], v221 offset:61440
  v_mfma_f32_16x16x32_bf16 a[80:83], a[200:203], v[64:67], a[80:83]
  ds_read_b64_tr_b16 a[240:241], v222 offset:49152
  v_mfma_f32_16x16x32_bf16 a[80:83], a[204:207], v[80:83], a[80:83]
  ds_read_b64_tr_b16 a[242:243], v222 offset:53248
  v_mfma_f32_16x16x32_bf16 a[84:87], a[204:207], v[84:87], a[84:87]
  ds_read_b64_tr_b16 a[244:245], v222 offset:57344
  v_and_b32 v215, 3, v212
  v_mfma_f32_16x16x32_bf16 a[84:87], a[200:203], v[68:71], a[84:87]
  ds_read_b64_tr_b16 a[246:247], v222 offset:61440
  v_lshlrev_b32 v215, 12, v215
  v_mfma_f32_16x16x32_bf16 a[88:91], a[200:203], v[72:75], a[88:91]
  ds_read_b64_tr_b16 a[248:249], v223 offset:49152
  v_mfma_f32_16x16x32_bf16 a[88:91], a[204:207], v[88:91], a[88:91]
  ds_read_b64_tr_b16 a[250:251], v223 offset:53248
  v_mfma_f32_16x16x32_bf16 a[92:95], a[204:207], v[92:95], a[92:95]
  ds_read_b64_tr_b16 a[252:253], v223 offset:57344
  v_mfma_f32_16x16x32_bf16 a[92:95], a[200:203], v[76:79], a[92:95]
  ds_read_b64_tr_b16 a[254:255], v223 offset:61440
  v_mfma_f32_16x16x32_bf16 a[108:111], a[208:211], v[76:79], a[108:111]
  buffer_load_dwordx4 v236, s[40:43], s13 offen offset:0 lds
  v_mfma_f32_16x16x32_bf16 a[108:111], a[212:215], v[92:95], a[108:111]
  ds_read_b64_tr_b16 a[192:193], v224 offset:49152
  v_mfma_f32_16x16x32_bf16 a[104:107], a[212:215], v[88:91], a[104:107]
  ds_read_b64_tr_b16 a[194:195], v224 offset:53248
  v_mfma_f32_16x16x32_bf16 a[104:107], a[208:211], v[72:75], a[104:107]
  ds_read_b64_tr_b16 a[196:197], v224 offset:57344
  v_mfma_f32_16x16x32_bf16 a[100:103], a[208:211], v[68:71], a[100:103]
  buffer_load_dwordx4 v237, s[40:43], s13 offen offset:1024 lds
  v_mfma_f32_16x16x32_bf16 a[100:103], a[212:215], v[84:87], a[100:103]
  ds_read_b64_tr_b16 a[198:199], v224 offset:61440
  v_mfma_f32_16x16x32_bf16 a[96:99], a[212:215], v[80:83], a[96:99]
  ds_read_b64_tr_b16 a[200:201], v225 offset:49152
  v_mfma_f32_16x16x32_bf16 a[96:99], a[208:211], v[64:67], a[96:99]
  ds_read_b64_tr_b16 a[202:203], v225 offset:53248
  v_mfma_f32_16x16x32_bf16 a[112:115], a[216:219], v[64:67], a[112:115]
  buffer_load_dwordx4 v238, s[40:43], s13 offen offset:2048 lds
  v_mfma_f32_16x16x32_bf16 a[112:115], a[220:223], v[80:83], a[112:115]
  ds_read_b64_tr_b16 a[204:205], v225 offset:57344
  v_mfma_f32_16x16x32_bf16 a[116:119], a[220:223], v[84:87], a[116:119]
  ds_read_b64_tr_b16 a[206:207], v225 offset:61440
  v_mfma_f32_16x16x32_bf16 a[116:119], a[216:219], v[68:71], a[116:119]
  ds_read_b64_tr_b16 a[208:209], v226 offset:49152
  v_mfma_f32_16x16x32_bf16 a[120:123], a[216:219], v[72:75], a[120:123]
  buffer_load_dwordx4 v239, s[40:43], s13 offen offset:3072 lds
  v_mfma_f32_16x16x32_bf16 a[120:123], a[220:223], v[88:91], a[120:123]
  ds_read_b64_tr_b16 a[210:211], v226 offset:53248
  s_add_u32 m0, s64, 16384
  v_mfma_f32_16x16x32_bf16 a[124:127], a[220:223], v[92:95], a[124:127]
  ds_read_b64_tr_b16 a[212:213], v226 offset:57344
  s_add_u32 s13, s13, s14
  v_mfma_f32_16x16x32_bf16 a[124:127], a[216:219], v[76:79], a[124:127]
  ds_read_b64_tr_b16 a[214:215], v226 offset:61440
  s_cmp_eq_u32 s13, s27
  v_mfma_f32_16x16x32_bf16 v[116:119], v[124:127], v[72:75], v[116:119]
  ds_read_b64_tr_b16 a[216:217], v227 offset:49152
  s_cselect_b32 s13, 0, s13
  v_mfma_f32_16x16x32_bf16 v[116:119], v[124:127], v[88:91], v[116:119]
  buffer_load_dwordx4 v236, s[40:43], s13 offen offset:0 lds
  v_mfma_f32_16x16x32_bf16 v[120:123], v[124:127], v[204:207], v[120:123]
  ds_read_b64_tr_b16 a[218:219], v227 offset:53248
  v_exp_f32 v44, v44
  v_exp_f32 v45, v45
  v_exp_f32 v46, v46
  v_cvt_pk_bf16_f32 v252, v44, v45
  v_exp_f32 v47, v47
  v_exp_f32 v60, v60
  buffer_load_dwordx4 v237, s[40:43], s13 offen offset:1024 lds
  v_cvt_pk_bf16_f32 v253, v46, v47
  v_exp_f32 v61, v61
  v_exp_f32 v62, v62
  v_cvt_pk_bf16_f32 v254, v60, v61
  v_exp_f32 v63, v63
  v_exp_f32 v40, v40
  v_cvt_pk_bf16_f32 v255, v62, v63
  v_exp_f32 v41, v41
  buffer_load_dwordx4 v238, s[40:43], s13 offen offset:2048 lds
  v_mfma_f32_16x16x32_bf16 v[120:123], v[124:127], v[252:255], v[120:123]
  ds_read_b64_tr_b16 a[220:221], v227 offset:57344
  v_cvt_pk_bf16_f32 v248, v40, v41
  v_mfma_f32_16x16x32_bf16 v[116:119], v[124:127], v[200:203], v[116:119]
  ds_read_b64_tr_b16 a[222:223], v227 offset:61440
  v_exp_f32 v42, v42
  v_exp_f32 v43, v43
  v_exp_f32 v56, v56
  buffer_load_dwordx4 v239, s[40:43], s13 offen offset:3072 lds
  v_cvt_pk_bf16_f32 v249, v42, v43
  v_exp_f32 v57, v57
  v_exp_f32 v58, v58
  v_cvt_pk_bf16_f32 v250, v56, v57
  v_exp_f32 v59, v59
  v_exp_f32 v36, v36
  v_cvt_pk_bf16_f32 v251, v58, v59
  v_add_f32 v113, v113, v36
  v_exp_f32 v37, v37
  v_mfma_f32_16x16x32_bf16 v[116:119], v[124:127], v[248:251], v[116:119]
  s_add_u32 m0, s64, 32768
  v_add_f32 v113, v113, v37
  v_cvt_pk_bf16_f32 v244, v36, v37
  s_waitcnt lgkmcnt(2)
  v_mfma_f32_16x16x32_bf16 a[12:15], a[224:227], v[204:207], a[12:15]
  s_add_u32 s13, s13, s14
  v_exp_f32 v38, v38
  v_mfma_f32_16x16x32_bf16 a[12:15], a[228:231], v[252:255], a[12:15]
  s_waitcnt lgkmcnt(0)
  s_barrier
  v_add_f32 v113, v113, v38
  s_cmp_eq_u32 s13, s27
  v_mfma_f32_16x16x32_bf16 a[8:11], a[228:231], v[248:251], a[8:11]
  s_cselect_b32 s13, 0, s13
  v_exp_f32 v39, v39
  v_mfma_f32_16x16x32_bf16 a[8:11], a[224:227], v[200:203], a[8:11]
  buffer_load_dwordx4 v236, s[40:43], s13 offen offset:0 lds
  v_mfma_f32_16x16x32_bf16 a[4:7], a[224:227], v[196:199], a[4:7]
  v_add_f32 v113, v113, v39
  v_cvt_pk_bf16_f32 v245, v38, v39
  v_exp_f32 v52, v52
  v_exp_f32 v53, v53
  v_add_f32 v113, v113, v52
  v_add_f32 v113, v113, v53
  v_cvt_pk_bf16_f32 v246, v52, v53
  v_exp_f32 v54, v54
  v_exp_f32 v55, v55
  v_add_f32 v113, v113, v54
  v_add_f32 v113, v113, v55
  v_cvt_pk_bf16_f32 v247, v54, v55
  v_exp_f32 v32, v32
  v_exp_f32 v33, v33
  v_mfma_f32_16x16x32_bf16 a[4:7], a[228:231], v[244:247], a[4:7]
  buffer_load_dwordx4 v237, s[40:43], s13 offen offset:1024 lds
  v_add_f32 v112, v112, v32
  v_add_f32 v112, v112, v33
  v_cvt_pk_bf16_f32 v208, v32, v33
  v_exp_f32 v34, v34
  v_exp_f32 v35, v35
  v_add_f32 v112, v112, v34
  v_add_f32 v112, v112, v35
  v_cvt_pk_bf16_f32 v209, v34, v35
  v_exp_f32 v48, v48
  v_exp_f32 v49, v49
  v_add_f32 v112, v112, v48
  v_add_f32 v112, v112, v49
  v_cvt_pk_bf16_f32 v210, v48, v49
  v_exp_f32 v50, v50
  v_exp_f32 v51, v51
  v_add_f32 v112, v112, v50
  v_add_f32 v112, v112, v51
  v_cvt_pk_bf16_f32 v211, v50, v51
  buffer_load_dwordx4 v238, s[40:43], s13 offen offset:2048 lds
  v_mov_b32 v115, v113
  v_mfma_f32_16x16x32_bf16 a[0:3], a[228:231], v[208:211], a[0:3]
  v_mov_b32 v114, v112
  v_permlane32_swap_b32 v113, v115
  v_mfma_f32_16x16x32_bf16 a[0:3], a[224:227], v[192:195], a[0:3]
  v_add_f32 v113, v113, v115
  v_mov_b32 v115, v113
  v_mfma_f32_16x16x32_bf16 a[16:19], a[232:235], v[192:195], a[16:19]
  v_permlane32_swap_b32 v112, v114
  v_permlane16_swap_b32 v113, v115
  v_mfma_f32_16x16x32_bf16 a[16:19], a[236:239], v[208:211], a[16:19]
  buffer_load_dwordx4 v239, s[40:43], s13 offen offset:3072 lds
  v_mfma_f32_16x16x32_bf16 a[20:23], a[236:239], v[244:247], a[20:23]
  s_waitcnt vmcnt(12)
  v_add_f32 v113, v113, v115
  v_cmp_ngt_f32 s[72:73], s94, v113
  v_mfma_f32_16x16x32_bf16 a[20:23], a[232:235], v[196:199], a[20:23]
  v_rcp_f32 v98, v113
  v_mfma_f32_16x16x32_bf16 a[24:27], a[232:235], v[200:203], a[24:27]
  s_or_b64 vcc, vcc, s[72:73]
  v_add_f32 v112, v112, v114
  v_mov_b32 v114, v112
  v_mfma_f32_16x16x32_bf16 a[24:27], a[236:239], v[248:251], a[24:27]
  v_rcp_f32 v102, v120
  v_mfma_f32_16x16x32_bf16 a[28:31], a[236:239], v[252:255], a[28:31]
  v_permlane16_swap_b32 v112, v114
  v_add_f32 v112, v112, v114
  v_mfma_f32_16x16x32_bf16 a[28:31], a[232:235], v[204:207], a[28:31]
  v_cmp_ngt_f32 s[72:73], s94, v112
  v_add_u32 v60, 49152, v240
  v_mfma_f32_16x16x32_bf16 a[44:47], a[240:243], v[204:207], a[44:47]
  ds_read_b64_tr_b16 v[64:65], v60 offset:16384
  s_or_b64 vcc, vcc, s[72:73]
  v_mfma_f32_16x16x32_bf16 a[44:47], a[244:247], v[252:255], a[44:47]
  ds_read_b64_tr_b16 v[66:67], v60 offset:18432
  v_cmp_ngt_f32 s[72:73], s94, v120
  v_mfma_f32_16x16x32_bf16 a[40:43], a[244:247], v[248:251], a[40:43]
  v_rcp_f32 v96, v112
  v_mfma_f32_16x16x32_bf16 a[40:43], a[240:243], v[200:203], a[40:43]
  s_or_b64 vcc, vcc, s[72:73]
  v_cmp_ngt_f32 s[72:73], s94, v116
  v_add_u32 v61, 49152, v241
  v_mfma_f32_16x16x32_bf16 a[36:39], a[240:243], v[196:199], a[36:39]
  ds_read_b64_tr_b16 v[68:69], v61 offset:16384
  s_or_b64 vcc, vcc, s[72:73]
  v_mfma_f32_16x16x32_bf16 a[36:39], a[244:247], v[244:247], a[36:39]
  ds_read_b64_tr_b16 v[70:71], v61 offset:18432
  s_lshl_b32 s71, s4, 2
  v_mfma_f32_16x16x32_bf16 a[32:35], a[244:247], v[208:211], a[32:35]
  s_add_u32 s71, s71, 114688
  v_rcp_f32 v100, v116
  v_mfma_f32_16x16x32_bf16 a[32:35], a[240:243], v[192:195], a[32:35]
  s_lshl_b32 s70, s4, 14
  v_add_u32 v215, s71, v215
  v_add_u32 v214, s70, v213
  v_mfma_f32_16x16x32_bf16 a[48:51], a[248:251], v[192:195], a[48:51]
  v_add_u32 v62, 49152, v242
  v_add_u32 v63, 49152, v243
  v_mfma_f32_16x16x32_bf16 a[48:51], a[252:255], v[208:211], a[48:51]
  ds_read_b64_tr_b16 v[72:73], v62 offset:16384
  v_accvgpr_read_b32 v0, a0
  v_mfma_f32_16x16x32_bf16 a[52:55], a[252:255], v[244:247], a[52:55]
  ds_read_b64_tr_b16 v[74:75], v62 offset:18432
  v_accvgpr_read_b32 v1, a1
  v_mfma_f32_16x16x32_bf16 a[52:55], a[248:251], v[196:199], a[52:55]
  ds_read_b64_tr_b16 v[76:77], v63 offset:16384
  v_accvgpr_read_b32 v2, a2
  v_mfma_f32_16x16x32_bf16 a[56:59], a[248:251], v[200:203], a[56:59]
  ds_read_b64_tr_b16 v[78:79], v63 offset:18432
  v_accvgpr_read_b32 v3, a3
  v_mfma_f32_16x16x32_bf16 a[56:59], a[252:255], v[248:251], a[56:59]
  ds_read_b64_tr_b16 v[80:81], v60 offset:32768
  v_accvgpr_read_b32 v4, a16
  v_mfma_f32_16x16x32_bf16 a[60:63], a[252:255], v[252:255], a[60:63]
  ds_read_b64_tr_b16 v[82:83], v60 offset:34816
  v_accvgpr_read_b32 v5, a17
  v_mfma_f32_16x16x32_bf16 a[60:63], a[248:251], v[204:207], a[60:63]
  ds_read_b64_tr_b16 v[84:85], v61 offset:32768
  v_accvgpr_read_b32 v6, a18
  v_mfma_f32_16x16x32_bf16 a[76:79], a[192:195], v[204:207], a[76:79]
  ds_read_b64_tr_b16 v[86:87], v61 offset:34816
  v_accvgpr_read_b32 v7, a19
  v_mfma_f32_16x16x32_bf16 a[76:79], a[196:199], v[252:255], a[76:79]
  ds_read_b64_tr_b16 v[88:89], v62 offset:32768
  v_mul_f32 v0, v0, v96
  v_mfma_f32_16x16x32_bf16 a[72:75], a[196:199], v[248:251], a[72:75]
  ds_read_b64_tr_b16 v[90:91], v62 offset:34816
  v_mul_f32 v1, v1, v96
  v_mfma_f32_16x16x32_bf16 a[72:75], a[192:195], v[200:203], a[72:75]
  ds_read_b64_tr_b16 v[92:93], v63 offset:32768
  v_mul_f32 v2, v2, v96
  v_mfma_f32_16x16x32_bf16 a[68:71], a[192:195], v[196:199], a[68:71]
  ds_read_b64_tr_b16 v[94:95], v63 offset:34816
  v_mul_f32 v3, v3, v96
  v_mfma_f32_16x16x32_bf16 a[68:71], a[196:199], v[244:247], a[68:71]
  v_mul_f32 v4, v4, v96
  v_mul_f32 v5, v5, v96
  v_mfma_f32_16x16x32_bf16 a[64:67], a[196:199], v[208:211], a[64:67]
  v_mul_f32 v6, v6, v96
  v_mul_f32 v7, v7, v96
  v_mfma_f32_16x16x32_bf16 a[64:67], a[192:195], v[192:195], a[64:67]
  v_cvt_pk_bf16_f32 v8, v0, v1
  v_accvgpr_read_b32 v12, a4
  v_mfma_f32_16x16x32_bf16 a[80:83], a[200:203], v[192:195], a[80:83]
  v_cvt_pk_bf16_f32 v9, v2, v3
  v_accvgpr_read_b32 v13, a5
  v_mfma_f32_16x16x32_bf16 a[80:83], a[204:207], v[208:211], a[80:83]
  v_cvt_pk_bf16_f32 v10, v4, v5
  v_accvgpr_read_b32 v14, a6
  v_mfma_f32_16x16x32_bf16 a[84:87], a[204:207], v[244:247], a[84:87]
  v_cvt_pk_bf16_f32 v11, v6, v7
  v_accvgpr_read_b32 v15, a7
  v_mfma_f32_16x16x32_bf16 a[84:87], a[200:203], v[196:199], a[84:87]
  ds_write_b128 v214, v[8:11] offset:0
  v_accvgpr_read_b32 v16, a20
  v_mfma_f32_16x16x32_bf16 a[88:91], a[200:203], v[200:203], a[88:91]
  v_accvgpr_read_b32 v17, a21
  v_accvgpr_read_b32 v18, a22
  v_mfma_f32_16x16x32_bf16 a[88:91], a[204:207], v[248:251], a[88:91]
  v_accvgpr_read_b32 v19, a23
  v_mul_f32 v12, v12, v98
  v_mfma_f32_16x16x32_bf16 a[92:95], a[204:207], v[252:255], a[92:95]
  v_mul_f32 v13, v13, v98
  v_mul_f32 v14, v14, v98
  v_mfma_f32_16x16x32_bf16 a[92:95], a[200:203], v[204:207], a[92:95]
  v_mul_f32 v15, v15, v98
  v_mul_f32 v16, v16, v98
  v_mfma_f32_16x16x32_bf16 a[108:111], a[208:211], v[204:207], a[108:111]
  v_mul_f32 v17, v17, v98
  v_mul_f32 v18, v18, v98
  v_mfma_f32_16x16x32_bf16 a[108:111], a[212:215], v[252:255], a[108:111]
  v_mul_f32 v19, v19, v98
  v_cvt_pk_bf16_f32 v20, v12, v13
  v_mfma_f32_16x16x32_bf16 a[104:107], a[212:215], v[248:251], a[104:107]
  v_cvt_pk_bf16_f32 v21, v14, v15
  v_accvgpr_read_b32 v24, a8
  v_mfma_f32_16x16x32_bf16 a[104:107], a[208:211], v[200:203], a[104:107]
  v_cvt_pk_bf16_f32 v22, v16, v17
  v_accvgpr_read_b32 v25, a9
  v_mfma_f32_16x16x32_bf16 a[100:103], a[208:211], v[196:199], a[100:103]
  v_cvt_pk_bf16_f32 v23, v18, v19
  v_accvgpr_read_b32 v26, a10
  v_mfma_f32_16x16x32_bf16 a[100:103], a[212:215], v[244:247], a[100:103]
  ds_write_b128 v214, v[20:23] offset:1024
  v_accvgpr_read_b32 v27, a11
  v_mfma_f32_16x16x32_bf16 a[96:99], a[212:215], v[208:211], a[96:99]
  v_accvgpr_read_b32 v28, a24
  v_accvgpr_read_b32 v29, a25
  v_mfma_f32_16x16x32_bf16 a[96:99], a[208:211], v[192:195], a[96:99]
  v_accvgpr_read_b32 v30, a26
  v_accvgpr_read_b32 v31, a27
  v_mfma_f32_16x16x32_bf16 a[112:115], a[216:219], v[192:195], a[112:115]
  v_mul_f32 v24, v24, v100
  v_mul_f32 v25, v25, v100
  v_mfma_f32_16x16x32_bf16 a[112:115], a[220:223], v[208:211], a[112:115]
  v_mul_f32 v26, v26, v100
  v_mul_f32 v27, v27, v100
  v_mfma_f32_16x16x32_bf16 a[116:119], a[220:223], v[244:247], a[116:119]
  v_mul_f32 v28, v28, v100
  v_mul_f32 v29, v29, v100
  v_mfma_f32_16x16x32_bf16 a[116:119], a[216:219], v[196:199], a[116:119]
  v_mul_f32 v30, v30, v100
  v_mul_f32 v31, v31, v100
  v_mfma_f32_16x16x32_bf16 a[120:123], a[216:219], v[200:203], a[120:123]
  v_cvt_pk_bf16_f32 v32, v24, v25
  v_accvgpr_read_b32 v36, a12
  v_mfma_f32_16x16x32_bf16 a[120:123], a[220:223], v[248:251], a[120:123]
  v_cvt_pk_bf16_f32 v33, v26, v27
  v_accvgpr_read_b32 v37, a13
  v_mfma_f32_16x16x32_bf16 a[124:127], a[220:223], v[252:255], a[124:127]
  v_cvt_pk_bf16_f32 v34, v28, v29
  v_accvgpr_read_b32 v38, a14
  v_mfma_f32_16x16x32_bf16 a[124:127], a[216:219], v[204:207], a[124:127]
  v_cvt_pk_bf16_f32 v35, v30, v31
  v_accvgpr_read_b32 v39, a15
  v_mfma_f32_16x16x32_bf16 v[52:55], v[124:127], v[8:11], 0
  ds_write_b128 v214, v[32:35] offset:2048
  v_accvgpr_read_b32 v40, a28
  v_mfma_f32_16x16x32_bf16 v[52:55], v[124:127], v[20:23], v[52:55]
  v_accvgpr_read_b32 v41, a29
  v_accvgpr_read_b32 v42, a30
  v_mfma_f32_16x16x32_bf16 v[52:55], v[124:127], v[32:35], v[52:55]
  v_accvgpr_read_b32 v43, a31
  v_mul_f32 v36, v36, v102
  v_mul_f32 v37, v37, v102
  v_mul_f32 v38, v38, v102
  v_mul_f32 v39, v39, v102
  v_mul_f32 v40, v40, v102
  v_mul_f32 v41, v41, v102
  v_mul_f32 v42, v42, v102
  v_mul_f32 v43, v43, v102
  v_cvt_pk_bf16_f32 v44, v36, v37
  v_cvt_pk_bf16_f32 v45, v38, v39
  v_cvt_pk_bf16_f32 v46, v40, v41
  v_cvt_pk_bf16_f32 v47, v42, v43
  ds_write_b128 v214, v[44:47] offset:3072
  s_nop 0
  v_mfma_f32_16x16x32_bf16 v[52:55], v[124:127], v[44:47], v[52:55]
  v_add_u32 v244, 49152, v240
  v_add_u32 v245, 49152, v241
  v_add_u32 v246, 49152, v242
  v_add_u32 v247, 49152, v243
.p2align 3
  v_accvgpr_read_b32 v0, a32
  v_accvgpr_read_b32 v1, a33
  v_accvgpr_read_b32 v2, a34
  v_accvgpr_read_b32 v3, a35
  v_accvgpr_read_b32 v4, a48
  v_accvgpr_read_b32 v5, a49
  v_accvgpr_read_b32 v6, a50
  v_accvgpr_read_b32 v7, a51
  v_pk_mul_f32 v[0:1], v[0:1], v[96:97] op_sel_hi:[1,0]
  v_pk_mul_f32 v[2:3], v[2:3], v[96:97] op_sel_hi:[1,0]
  v_pk_mul_f32 v[4:5], v[4:5], v[96:97] op_sel_hi:[1,0]
  v_pk_mul_f32 v[6:7], v[6:7], v[96:97] op_sel_hi:[1,0]
  v_cvt_pk_bf16_f32 v8, v0, v1
  v_cvt_pk_bf16_f32 v9, v2, v3
  v_cvt_pk_bf16_f32 v10, v4, v5
  v_cvt_pk_bf16_f32 v11, v6, v7
  ds_write_b128 v214, v[8:11] offset:4096
  v_accvgpr_read_b32 v12, a36
  v_mfma_f32_16x16x32_bf16 v[52:55], v[124:127], v[8:11], v[52:55]
  v_accvgpr_read_b32 v13, a37
  v_accvgpr_read_b32 v14, a38
  v_accvgpr_read_b32 v15, a39
  v_accvgpr_read_b32 v16, a52
  v_accvgpr_read_b32 v17, a53
  v_accvgpr_read_b32 v18, a54
  v_accvgpr_read_b32 v19, a55
  v_pk_mul_f32 v[12:13], v[12:13], v[98:99] op_sel_hi:[1,0]
  v_pk_mul_f32 v[14:15], v[14:15], v[98:99] op_sel_hi:[1,0]
  v_pk_mul_f32 v[16:17], v[16:17], v[98:99] op_sel_hi:[1,0]
  v_pk_mul_f32 v[18:19], v[18:19], v[98:99] op_sel_hi:[1,0]
  v_cvt_pk_bf16_f32 v20, v12, v13
  v_cvt_pk_bf16_f32 v21, v14, v15
  v_cvt_pk_bf16_f32 v22, v16, v17
  v_cvt_pk_bf16_f32 v23, v18, v19
  ds_write_b128 v214, v[20:23] offset:5120
  v_accvgpr_read_b32 v24, a40
  v_mfma_f32_16x16x32_bf16 v[52:55], v[124:127], v[20:23], v[52:55]
  v_accvgpr_read_b32 v25, a41
  v_accvgpr_read_b32 v26, a42
  v_accvgpr_read_b32 v27, a43
  v_accvgpr_read_b32 v28, a56
  v_accvgpr_read_b32 v29, a57
  v_accvgpr_read_b32 v30, a58
  v_accvgpr_read_b32 v31, a59
  v_pk_mul_f32 v[24:25], v[24:25], v[100:101] op_sel_hi:[1,0]
  v_pk_mul_f32 v[26:27], v[26:27], v[100:101] op_sel_hi:[1,0]
  v_pk_mul_f32 v[28:29], v[28:29], v[100:101] op_sel_hi:[1,0]
  v_pk_mul_f32 v[30:31], v[30:31], v[100:101] op_sel_hi:[1,0]
  v_cvt_pk_bf16_f32 v32, v24, v25
  v_cvt_pk_bf16_f32 v33, v26, v27
  v_cvt_pk_bf16_f32 v34, v28, v29
  v_cvt_pk_bf16_f32 v35, v30, v31
  ds_write_b128 v214, v[32:35] offset:6144
  v_accvgpr_read_b32 v36, a44
  v_mfma_f32_16x16x32_bf16 v[52:55], v[124:127], v[32:35], v[52:55]
  v_accvgpr_read_b32 v37, a45
  v_accvgpr_read_b32 v38, a46
  v_accvgpr_read_b32 v39, a47
  v_accvgpr_read_b32 v40, a60
  v_accvgpr_read_b32 v41, a61
  v_accvgpr_read_b32 v42, a62
  v_accvgpr_read_b32 v43, a63
  v_pk_mul_f32 v[36:37], v[36:37], v[102:103] op_sel_hi:[1,0]
  v_pk_mul_f32 v[38:39], v[38:39], v[102:103] op_sel_hi:[1,0]
  v_pk_mul_f32 v[40:41], v[40:41], v[102:103] op_sel_hi:[1,0]
  v_pk_mul_f32 v[42:43], v[42:43], v[102:103] op_sel_hi:[1,0]
  v_cvt_pk_bf16_f32 v44, v36, v37
  v_cvt_pk_bf16_f32 v45, v38, v39
  v_cvt_pk_bf16_f32 v46, v40, v41
  v_cvt_pk_bf16_f32 v47, v42, v43
  ds_write_b128 v214, v[44:47] offset:7168
  v_accvgpr_read_b32 v0, a64
  v_mfma_f32_16x16x32_bf16 v[52:55], v[124:127], v[44:47], v[52:55]
  v_accvgpr_read_b32 v1, a65
  v_accvgpr_read_b32 v2, a66
  v_accvgpr_read_b32 v3, a67
  v_accvgpr_read_b32 v4, a80
  v_accvgpr_read_b32 v5, a81
  v_accvgpr_read_b32 v6, a82
  v_accvgpr_read_b32 v7, a83
  v_pk_mul_f32 v[0:1], v[0:1], v[96:97] op_sel_hi:[1,0]
  v_pk_mul_f32 v[2:3], v[2:3], v[96:97] op_sel_hi:[1,0]
  v_pk_mul_f32 v[4:5], v[4:5], v[96:97] op_sel_hi:[1,0]
  v_pk_mul_f32 v[6:7], v[6:7], v[96:97] op_sel_hi:[1,0]
  v_cvt_pk_bf16_f32 v8, v0, v1
  v_cvt_pk_bf16_f32 v9, v2, v3
  v_cvt_pk_bf16_f32 v10, v4, v5
  v_cvt_pk_bf16_f32 v11, v6, v7
  ds_write_b128 v214, v[8:11] offset:8192
  v_accvgpr_read_b32 v12, a68
  v_mfma_f32_16x16x32_bf16 v[52:55], v[124:127], v[8:11], v[52:55]
  v_accvgpr_read_b32 v13, a69
  v_accvgpr_read_b32 v14, a70
  v_accvgpr_read_b32 v15, a71
  v_accvgpr_read_b32 v16, a84
  v_accvgpr_read_b32 v17, a85
  v_accvgpr_read_b32 v18, a86
  v_accvgpr_read_b32 v19, a87
  v_pk_mul_f32 v[12:13], v[12:13], v[98:99] op_sel_hi:[1,0]
  v_pk_mul_f32 v[14:15], v[14:15], v[98:99] op_sel_hi:[1,0]
  v_pk_mul_f32 v[16:17], v[16:17], v[98:99] op_sel_hi:[1,0]
  v_pk_mul_f32 v[18:19], v[18:19], v[98:99] op_sel_hi:[1,0]
  v_cvt_pk_bf16_f32 v20, v12, v13
  v_cvt_pk_bf16_f32 v21, v14, v15
  v_cvt_pk_bf16_f32 v22, v16, v17
  v_cvt_pk_bf16_f32 v23, v18, v19
  ds_write_b128 v214, v[20:23] offset:9216
  v_accvgpr_read_b32 v24, a72
L_pad6:
  s_cbranch_execz L_st1
  s_nop 0
  v_mfma_f32_16x16x32_bf16 v[52:55], v[124:127], v[20:23], v[52:55]
  v_accvgpr_read_b32 v25, a73
  v_accvgpr_read_b32 v26, a74
  v_accvgpr_read_b32 v27, a75
  v_accvgpr_read_b32 v28, a88
  v_accvgpr_read_b32 v29, a89
  v_accvgpr_read_b32 v30, a90
  v_accvgpr_read_b32 v31, a91
  v_pk_mul_f32 v[24:25], v[24:25], v[100:101] op_sel_hi:[1,0]
  v_pk_mul_f32 v[26:27], v[26:27], v[100:101] op_sel_hi:[1,0]
  v_pk_mul_f32 v[28:29], v[28:29], v[100:101] op_sel_hi:[1,0]
  v_pk_mul_f32 v[30:31], v[30:31], v[100:101] op_sel_hi:[1,0]
  v_cvt_pk_bf16_f32 v32, v24, v25
  v_cvt_pk_bf16_f32 v33, v26, v27
  v_cvt_pk_bf16_f32 v34, v28, v29
  v_cvt_pk_bf16_f32 v35, v30, v31
  ds_write_b128 v214, v[32:35] offset:10240
  v_accvgpr_read_b32 v36, a76
  v_mfma_f32_16x16x32_bf16 v[52:55], v[124:127], v[32:35], v[52:55]
  v_accvgpr_read_b32 v37, a77
  v_accvgpr_read_b32 v38, a78
  v_accvgpr_read_b32 v39, a79
  v_accvgpr_read_b32 v40, a92
  v_accvgpr_read_b32 v41, a93
  v_accvgpr_read_b32 v42, a94
  v_accvgpr_read_b32 v43, a95
  v_pk_mul_f32 v[36:37], v[36:37], v[102:103] op_sel_hi:[1,0]
  v_pk_mul_f32 v[38:39], v[38:39], v[102:103] op_sel_hi:[1,0]
  v_pk_mul_f32 v[40:41], v[40:41], v[102:103] op_sel_hi:[1,0]
  v_pk_mul_f32 v[42:43], v[42:43], v[102:103] op_sel_hi:[1,0]
  v_cvt_pk_bf16_f32 v44, v36, v37
  v_cvt_pk_bf16_f32 v45, v38, v39
  v_cvt_pk_bf16_f32 v46, v40, v41
  v_cvt_pk_bf16_f32 v47, v42, v43
  ds_write_b128 v214, v[44:47] offset:11264
  v_accvgpr_read_b32 v0, a96
  v_mfma_f32_16x16x32_bf16 v[52:55], v[124:127], v[44:47], v[52:55]
  v_accvgpr_read_b32 v1, a97
  v_accvgpr_read_b32 v2, a98
  v_accvgpr_read_b32 v3, a99
  v_accvgpr_read_b32 v4, a112
  v_accvgpr_read_b32 v5, a113
  v_accvgpr_read_b32 v6, a114
  v_accvgpr_read_b32 v7, a115
  v_pk_mul_f32 v[0:1], v[0:1], v[96:97] op_sel_hi:[1,0]
  v_pk_mul_f32 v[2:3], v[2:3], v[96:97] op_sel_hi:[1,0]
  v_pk_mul_f32 v[4:5], v[4:5], v[96:97] op_sel_hi:[1,0]
  v_pk_mul_f32 v[6:7], v[6:7], v[96:97] op_sel_hi:[1,0]
  v_cvt_pk_bf16_f32 v8, v0, v1
  v_cvt_pk_bf16_f32 v9, v2, v3
  v_cvt_pk_bf16_f32 v10, v4, v5
  v_cvt_pk_bf16_f32 v11, v6, v7
  ds_write_b128 v214, v[8:11] offset:12288
  v_accvgpr_read_b32 v12, a100
  v_mfma_f32_16x16x32_bf16 v[52:55], v[124:127], v[8:11], v[52:55]
  v_accvgpr_read_b32 v13, a101
  v_accvgpr_read_b32 v14, a102
  v_accvgpr_read_b32 v15, a103
  v_accvgpr_read_b32 v16, a116
  v_accvgpr_read_b32 v17, a117
  v_accvgpr_read_b32 v18, a118
  v_accvgpr_read_b32 v19, a119
  v_pk_mul_f32 v[12:13], v[12:13], v[98:99] op_sel_hi:[1,0]
  v_pk_mul_f32 v[14:15], v[14:15], v[98:99] op_sel_hi:[1,0]
  v_pk_mul_f32 v[16:17], v[16:17], v[98:99] op_sel_hi:[1,0]
  v_pk_mul_f32 v[18:19], v[18:19], v[98:99] op_sel_hi:[1,0]
  v_cvt_pk_bf16_f32 v20, v12, v13
  v_cvt_pk_bf16_f32 v21, v14, v15
  v_cvt_pk_bf16_f32 v22, v16, v17
  v_cvt_pk_bf16_f32 v23, v18, v19
  ds_write_b128 v214, v[20:23] offset:13312
  v_accvgpr_read_b32 v24, a104
  v_mfma_f32_16x16x32_bf16 v[52:55], v[124:127], v[20:23], v[52:55]
  v_accvgpr_read_b32 v25, a105
  v_accvgpr_read_b32 v26, a106
  v_accvgpr_read_b32 v27, a107
  v_accvgpr_read_b32 v28, a120
  v_accvgpr_read_b32 v29, a121
  v_accvgpr_read_b32 v30, a122
  v_accvgpr_read_b32 v31, a123
  v_pk_mul_f32 v[24:25], v[24:25], v[100:101] op_sel_hi:[1,0]
  v_pk_mul_f32 v[26:27], v[26:27], v[100:101] op_sel_hi:[1,0]
  v_pk_mul_f32 v[28:29], v[28:29], v[100:101] op_sel_hi:[1,0]
  v_pk_mul_f32 v[30:31], v[30:31], v[100:101] op_sel_hi:[1,0]
  v_cvt_pk_bf16_f32 v32, v24, v25
  v_cvt_pk_bf16_f32 v33, v26, v27
  v_cvt_pk_bf16_f32 v34, v28, v29
  v_cvt_pk_bf16_f32 v35, v30, v31
  ds_write_b128 v214, v[32:35] offset:14336
  v_accvgpr_read_b32 v36, a108
  v_mfma_f32_16x16x32_bf16 v[52:55], v[124:127], v[32:35], v[52:55]
  v_accvgpr_read_b32 v37, a109
  v_accvgpr_read_b32 v38, a110
  v_accvgpr_read_b32 v39, a111
  v_accvgpr_read_b32 v40, a124
  v_accvgpr_read_b32 v41, a125
  v_accvgpr_read_b32 v42, a126
  v_accvgpr_read_b32 v43, a127
  v_pk_mul_f32 v[36:37], v[36:37], v[102:103] op_sel_hi:[1,0]
  v_pk_mul_f32 v[38:39], v[38:39], v[102:103] op_sel_hi:[1,0]
  v_pk_mul_f32 v[40:41], v[40:41], v[102:103] op_sel_hi:[1,0]
  v_pk_mul_f32 v[42:43], v[42:43], v[102:103] op_sel_hi:[1,0]
  v_cvt_pk_bf16_f32 v44, v36, v37
  v_cvt_pk_bf16_f32 v45, v38, v39
  v_cvt_pk_bf16_f32 v46, v40, v41
  v_cvt_pk_bf16_f32 v47, v42, v43
  ds_write_b128 v214, v[44:47] offset:15360
  s_nop 0
  v_mfma_f32_16x16x32_bf16 v[52:55], v[124:127], v[44:47], v[52:55]
  s_nop 7
  v_cmp_u_f32 s[72:73], v53, v53
  s_nop 2
  s_or_b64 vcc, vcc, s[72:73]
  s_cmp_lg_u64 vcc, 0
  s_cselect_b32 s70, 1, 0
  v_mov_b32 v56, s70
  ds_write_b32 v215, v56
  s_waitcnt lgkmcnt(0)
  s_barrier
  s_add_u32 s70, s64, 49152
  v_mov_b32 v214, s70
  ds_read_b128 v[0:3], v214
  s_lshl_b32 s3, s100, 12
  s_mov_b32 s7, 65536
  v_add_u32 v210, s3, v213
  ds_read_b128 v[96:99], v210 offset:0
  ds_read_b128 v[100:103], v210 offset:1024
  ds_read_b128 v[104:107], v210 offset:2048
  ds_read_b128 v[108:111], v210 offset:3072
  s_add_u32 s3, s3, 4096
  s_cmp_eq_u32 s3, s7
  s_cselect_b32 s3, 0, s3
  v_add_u32 v210, s3, v213
  ds_read_b128 v[112:115], v210 offset:0
  ds_read_b128 v[116:119], v210 offset:1024
  ds_read_b128 v[120:123], v210 offset:2048
  ds_read_b128 v[124:127], v210 offset:3072
  s_add_u32 s3, s3, 4096
  s_cmp_eq_u32 s3, s7
  s_cselect_b32 s3, 0, s3
  v_add_u32 v210, s3, v213
  s_waitcnt lgkmcnt(8)
  v_or_b32 v0, v0, v1
  v_or3_b32 v0, v0, v2, v3
  s_nop 0
  v_readfirstlane_b32 s70, v0
  s_andn2_b32 s70, s70, s66
  s_cbranch_scc1 L_redo
  s_add_u32 m0, s64, 49152
  s_add_u32 s13, s13, s14
  s_cmp_eq_u32 s13, s27
  s_cselect_b32 s13, 0, s13
  buffer_load_dwordx4 v236, s[40:43], s13 offen offset:0 lds
  buffer_load_dwordx4 v237, s[40:43], s13 offen offset:1024 lds
  buffer_load_dwordx4 v238, s[40:43], s13 offen offset:2048 lds
  buffer_load_dwordx4 v239, s[40:43], s13 offen offset:3072 lds
  s_add_u32 m0, s64, 65536
  s_add_u32 s13, s13, s14
  s_cmp_eq_u32 s13, s27
  s_cselect_b32 s13, 0, s13
  buffer_load_dwordx4 v236, s[40:43], s13 offen offset:0 lds
  buffer_load_dwordx4 v237, s[40:43], s13 offen offset:1024 lds
  buffer_load_dwordx4 v238, s[40:43], s13 offen offset:2048 lds
  buffer_load_dwordx4 v239, s[40:43], s13 offen offset:3072 lds
  s_lshl_b32 s70, s4, 1
  s_sub_u32 s68, s5, s70
  s_waitcnt vmcnt(16) lgkmcnt(0)
  v_mfma_f32_16x16x32_bf16 v[0:3], v[64:67], v[96:99], 0
  ds_read_b128 a[224:227], v210 offset:0
  s_add_u32 s3, s3, 4096
  v_mfma_f32_16x16x32_bf16 v[0:3], v[80:83], v[112:115], v[0:3]
  ds_read_b128 a[228:231], v210 offset:1024
  s_cmp_eq_u32 s3, s7
  v_mfma_f32_16x16x32_bf16 v[4:7], v[80:83], v[116:119], 0
  ds_read_b128 a[232:235], v210 offset:2048
  s_cselect_b32 s3, 0, s3
  v_mfma_f32_16x16x32_bf16 v[4:7], v[64:67], v[100:103], v[4:7]
  ds_read_b128 a[236:239], v210 offset:3072
  v_add_u32 v210, s3, v213
  v_mfma_f32_16x16x32_bf16 v[8:11], v[64:67], v[104:107], 0
  ds_read_b64_tr_b16 a[192:193], v240 offset:0
  s_add_u32 s13, s13, s14
  v_mfma_f32_16x16x32_bf16 v[8:11], v[80:83], v[120:123], v[8:11]
  ds_read_b64_tr_b16 a[194:195], v240 offset:2048
  s_cmp_eq_u32 s13, s27
  v_mfma_f32_16x16x32_bf16 v[12:15], v[80:83], v[124:127], 0
  ds_read_b64_tr_b16 a[196:197], v241 offset:0
  s_cselect_b32 s13, 0, s13
  v_mfma_f32_16x16x32_bf16 v[12:15], v[64:67], v[108:111], v[12:15]
  ds_read_b64_tr_b16 a[198:199], v241 offset:2048
  s_add_u32 m0, s64, 81920
  v_mfma_f32_16x16x32_bf16 v[28:31], v[68:71], v[108:111], 0
  ds_read_b64_tr_b16 a[200:201], v242 offset:0
  v_mfma_f32_16x16x32_bf16 v[28:31], v[84:87], v[124:127], v[28:31]
  ds_read_b64_tr_b16 a[202:203], v242 offset:2048
  v_mfma_f32_16x16x32_bf16 v[24:27], v[84:87], v[120:123], 0
  ds_read_b64_tr_b16 a[204:205], v243 offset:0
  v_mfma_f32_16x16x32_bf16 v[24:27], v[68:71], v[104:107], v[24:27]
  ds_read_b64_tr_b16 a[206:207], v243 offset:2048
  v_mfma_f32_16x16x32_bf16 v[20:23], v[68:71], v[100:103], 0
  buffer_load_dwordx4 v236, s[40:43], s13 offen offset:0 lds
  v_mfma_f32_16x16x32_bf16 v[20:23], v[84:87], v[116:119], v[20:23]
  buffer_load_dwordx4 v237, s[40:43], s13 offen offset:1024 lds
  v_mfma_f32_16x16x32_bf16 v[16:19], v[84:87], v[112:115], 0
  buffer_load_dwordx4 v238, s[40:43], s13 offen offset:2048 lds
  v_mfma_f32_16x16x32_bf16 v[16:19], v[68:71], v[96:99], v[16:19]
  buffer_load_dwordx4 v239, s[40:43], s13 offen offset:3072 lds
  s_waitcnt vmcnt(16) lgkmcnt(0)
  v_mfma_f32_16x16x32_bf16 v[32:35], v[72:75], v[96:99], 0
  ds_read_b128 a[240:243], v210 offset:0
  s_add_u32 s3, s3, 4096
  v_mfma_f32_16x16x32_bf16 v[32:35], v[88:91], v[112:115], v[32:35]
  ds_read_b128 a[244:247], v210 offset:1024
  s_cmp_eq_u32 s3, s7
  v_mfma_f32_16x16x32_bf16 v[36:39], v[88:91], v[116:119], 0
  ds_read_b128 a[248:251], v210 offset:2048
  s_cselect_b32 s3, 0, s3
  v_mfma_f32_16x16x32_bf16 v[36:39], v[72:75], v[100:103], v[36:39]
  ds_read_b128 a[252:255], v210 offset:3072
  v_add_u32 v210, s3, v213
  v_mfma_f32_16x16x32_bf16 v[40:43], v[72:75], v[104:107], 0
  ds_read_b64_tr_b16 a[208:209], v240 offset:16384
  s_add_u32 s13, s13, s14
  v_mfma_f32_16x16x32_bf16 v[40:43], v[88:91], v[120:123], v[40:43]
  ds_read_b64_tr_b16 a[210:211], v240 offset:18432
  s_cmp_eq_u32 s13, s27
  v_mfma_f32_16x16x32_bf16 v[44:47], v[88:91], v[124:127], 0
  ds_read_b64_tr_b16 a[212:213], v241 offset:16384
  s_cselect_b32 s13, 0, s13
  v_mfma_f32_16x16x32_bf16 v[44:47], v[72:75], v[108:111], v[44:47]
  ds_read_b64_tr_b16 a[214:215], v241 offset:18432
  s_add_u32 m0, s64, 0
  v_mfma_f32_16x16x32_bf16 v[60:63], v[76:79], v[108:111], 0
  ds_read_b64_tr_b16 a[216:217], v242 offset:16384
  v_mfma_f32_16x16x32_bf16 v[60:63], v[92:95], v[124:127], v[60:63]
  ds_read_b64_tr_b16 a[218:219], v242 offset:18432
  v_mfma_f32_16x16x32_bf16 v[56:59], v[92:95], v[120:123], 0
  ds_read_b64_tr_b16 a[220:221], v243 offset:16384
  v_mfma_f32_16x16x32_bf16 v[56:59], v[76:79], v[104:107], v[56:59]
  ds_read_b64_tr_b16 a[222:223], v243 offset:18432
  v_mfma_f32_16x16x32_bf16 v[52:55], v[76:79], v[100:103], 0
  buffer_load_dwordx4 v236, s[40:43], s13 offen offset:0 lds
  v_mfma_f32_16x16x32_bf16 v[52:55], v[92:95], v[116:119], v[52:55]
  buffer_load_dwordx4 v237, s[40:43], s13 offen offset:1024 lds
  v_mfma_f32_16x16x32_bf16 v[48:51], v[92:95], v[112:115], 0
  buffer_load_dwordx4 v238, s[40:43], s13 offen offset:2048 lds
  v_mfma_f32_16x16x32_bf16 v[48:51], v[76:79], v[96:99], v[48:51]
  buffer_load_dwordx4 v239, s[40:43], s13 offen offset:3072 lds
  s_mov_b32 s10, 4
  s_call_b64 s[8:9], L_gemm10
  v_xor_b32 v236, 128, v236
  v_xor_b32 v237, 128, v237
  v_xor_b32 v238, 128, v238
  v_xor_b32 v239, 128, v239
  s_mov_b32 s10, 3
  s_call_b64 s[8:9], L_gemm5
  v_mov_b32 v248, 0
  v_mov_b32 v249, 0
  v_mov_b32 v250, 0
  v_mov_b32 v251, 0
  s_nop 1
  v_mfma_f32_32x32x16_bf16 a[0:15], v[248:251], v[248:251], 0
  v_mfma_f32_32x32x16_bf16 a[16:31], v[248:251], v[248:251], 0
  v_mfma_f32_32x32x16_bf16 a[32:47], v[248:251], v[248:251], 0
  v_mfma_f32_32x32x16_bf16 a[48:63], v[248:251], v[248:251], 0
  s_nop 5
  s_add_u32 s94, s65, 16777216
  s_add_u32 s95, s94, 4096
  s_cmp_eq_u32 s68, 0
  s_cselect_b32 s94, 0x40000000, s94
  s_cmp_eq_u32 s68, 1
  s_cselect_b32 s95, 0x40000000, s95
.p2align 3
  v_cvt_pk_bf16_f32 v192, v0, v1
  v_cvt_pk_bf16_f32 v193, v2, v3
  v_cvt_pk_bf16_f32 v194, v16, v17
  v_cvt_pk_bf16_f32 v195, v18, v19
  v_cvt_pk_bf16_f32 v196, v4, v5
  v_cvt_pk_bf16_f32 v197, v6, v7
  v_cvt_pk_bf16_f32 v198, v20, v21
  v_cvt_pk_bf16_f32 v199, v22, v23
  v_cvt_pk_bf16_f32 v200, v8, v9
  v_cvt_pk_bf16_f32 v201, v10, v11
  v_cvt_pk_bf16_f32 v202, v24, v25
  v_cvt_pk_bf16_f32 v203, v26, v27
  v_cvt_pk_bf16_f32 v204, v12, v13
  v_cvt_pk_bf16_f32 v205, v14, v15
  v_cvt_pk_bf16_f32 v206, v28, v29
  v_cvt_pk_bf16_f32 v207, v30, v31
  v_cvt_pk_bf16_f32 v216, v32, v33
  v_cvt_pk_bf16_f32 v217, v34, v35
  v_cvt_pk_bf16_f32 v218, v48, v49
  v_cvt_pk_bf16_f32 v219, v50, v51
  v_cvt_pk_bf16_f32 v220, v36, v37
  v_cvt_pk_bf16_f32 v221, v38, v39
  v_cvt_pk_bf16_f32 v222, v52, v53
  v_cvt_pk_bf16_f32 v223, v54, v55
  v_cvt_pk_bf16_f32 v224, v40, v41
  v_cvt_pk_bf16_f32 v225, v42, v43
  v_cvt_pk_bf16_f32 v226, v56, v57
  v_cvt_pk_bf16_f32 v227, v58, v59
  v_cvt_pk_bf16_f32 v228, v44, v45
  v_cvt_pk_bf16_f32 v229, v46, v47
  v_cvt_pk_bf16_f32 v230, v60, v61
  v_cvt_pk_bf16_f32 v231, v62, v63
  s_mov_b32 s56, s16
  s_mov_b32 s57, s17
  s_mov_b32 s58, 2097152
  s_lshr_b32 s60, s65, 15
  s_lshl_b32 s60, s60, 7
  s_add_u32 s60, s60, 41943040
  s_add_u32 s12, s12, s67
  s_xor_b32 s67, s12, 128
  v_mov_b32 v209, 0
  v_and_b32 v214, 15, v212
  v_lshlrev_b32 v214, 10, v214
  v_and_b32 v215, 16, v212
  v_lshl_add_u32 v214, v215, 1, v214
  v_bfe_u32 v215, v212, 5, 1
  v_lshl_add_u32 v211, v215, 4, v214
  s_mov_b32 s96, s36
  s_mov_b32 s97, s37
  s_lshl_b32 s69, s6, 10
  s_add_u32 s69, s69, 41943040
  s_add_u32 s70, s69, 1024
  s_cmp_eq_u32 s4, 0
  s_cselect_b32 s98, s70, 0
  s_lshl_b32 s62, 1, s5
  v_mov_b32 v214, s62
  v_lshlrev_b32 v215, 7, v212
  s_waitcnt vmcnt(16) lgkmcnt(0)
  v_mfma_f32_16x16x32_bf16 v[0:3], v[64:67], v[96:99], 0
  ds_read_b128 a[224:227], v210 offset:0
  s_add_u32 s3, s3, 4096
  v_mfma_f32_16x16x32_bf16 v[0:3], v[80:83], v[112:115], v[0:3]
  ds_read_b128 a[228:231], v210 offset:1024
  s_cmp_eq_u32 s3, s7
  v_mfma_f32_16x16x32_bf16 v[4:7], v[80:83], v[116:119], 0
  ds_read_b128 a[232:235], v210 offset:2048
  s_cselect_b32 s3, 0, s3
  v_mfma_f32_16x16x32_bf16 v[4:7], v[64:67], v[100:103], v[4:7]
  ds_read_b128 a[236:239], v210 offset:3072
  v_add_u32 v210, s3, v213
  v_mfma_f32_16x16x32_bf16 v[8:11], v[64:67], v[104:107], 0
  ds_read_b64_tr_b16 a[192:193], v244 offset:16384
  s_add_u32 s13, s13, s14
  v_mfma_f32_16x16x32_bf16 v[8:11], v[80:83], v[120:123], v[8:11]
  ds_read_b64_tr_b16 a[194:195], v244 offset:18432
  s_cmp_eq_u32 s13, s27
  v_mfma_f32_16x16x32_bf16 v[12:15], v[80:83], v[124:127], 0
  ds_read_b64_tr_b16 a[196:197], v245 offset:16384
  s_cselect_b32 s13, 0, s13
  v_mfma_f32_16x16x32_bf16 v[12:15], v[64:67], v[108:111], v[12:15]
  ds_read_b64_tr_b16 a[198:199], v245 offset:18432
  s_add_u32 m0, s64, 49152
  v_mfma_f32_16x16x32_bf16 v[28:31], v[68:71], v[108:111], 0
  ds_read_b64_tr_b16 a[200:201], v246 offset:16384
  v_mfma_f32_16x16x32_bf16 v[28:31], v[84:87], v[124:127], v[28:31]
  ds_read_b64_tr_b16 a[202:203], v246 offset:18432
  v_mfma_f32_16x16x32_bf16 v[24:27], v[84:87], v[120:123], 0
  ds_read_b64_tr_b16 a[204:205], v247 offset:16384
  v_mfma_f32_16x16x32_bf16 v[24:27], v[68:71], v[104:107], v[24:27]
  ds_read_b64_tr_b16 a[206:207], v247 offset:18432
  v_mfma_f32_16x16x32_bf16 v[20:23], v[68:71], v[100:103], 0
  buffer_load_dwordx4 v236, s[40:43], s13 offen offset:0 lds
  v_mfma_f32_16x16x32_bf16 v[20:23], v[84:87], v[116:119], v[20:23]
  buffer_load_dwordx4 v237, s[40:43], s13 offen offset:1024 lds
  v_mfma_f32_16x16x32_bf16 v[16:19], v[84:87], v[112:115], 0
  buffer_load_dwordx4 v238, s[40:43], s13 offen offset:2048 lds
  v_mfma_f32_16x16x32_bf16 v[16:19], v[68:71], v[96:99], v[16:19]
  buffer_load_dwordx4 v239, s[40:43], s13 offen offset:3072 lds
  s_waitcnt vmcnt(16) lgkmcnt(0)
  v_mfma_f32_16x16x32_bf16 v[32:35], v[72:75], v[96:99], 0
  ds_read_b128 a[240:243], v210 offset:0
  s_add_u32 s3, s3, 4096
  v_mfma_f32_16x16x32_bf16 v[32:35], v[88:91], v[112:115], v[32:35]
  ds_read_b128 a[244:247], v210 offset:1024
  s_cmp_eq_u32 s3, s7
  v_mfma_f32_16x16x32_bf16 v[36:39], v[88:91], v[116:119], 0
  ds_read_b128 a[248:251], v210 offset:2048
  s_cselect_b32 s3, 0, s3
  v_mfma_f32_16x16x32_bf16 v[36:39], v[72:75], v[100:103], v[36:39]
  ds_read_b128 a[252:255], v210 offset:3072
  v_add_u32 v210, s3, v213
  v_mfma_f32_16x16x32_bf16 v[40:43], v[72:75], v[104:107], 0
  ds_read_b64_tr_b16 a[208:209], v244 offset:32768
  s_add_u32 s13, s13, s14
  v_mfma_f32_16x16x32_bf16 v[40:43], v[88:91], v[120:123], v[40:43]
  ds_read_b64_tr_b16 a[210:211], v244 offset:34816
  s_cmp_eq_u32 s13, s27
  v_mfma_f32_16x16x32_bf16 v[44:47], v[88:91], v[124:127], 0
  ds_read_b64_tr_b16 a[212:213], v245 offset:32768
  s_cselect_b32 s13, 0, s13
  v_mfma_f32_16x16x32_bf16 v[44:47], v[72:75], v[108:111], v[44:47]
  ds_read_b64_tr_b16 a[214:215], v245 offset:34816
  s_add_u32 m0, s64, 65536
  v_mfma_f32_16x16x32_bf16 v[60:63], v[76:79], v[108:111], 0
  ds_read_b64_tr_b16 a[216:217], v246 offset:32768
  v_mfma_f32_16x16x32_bf16 v[60:63], v[92:95], v[124:127], v[60:63]
  ds_read_b64_tr_b16 a[218:219], v246 offset:34816
  v_mfma_f32_16x16x32_bf16 v[56:59], v[92:95], v[120:123], 0
  ds_read_b64_tr_b16 a[220:221], v247 offset:32768
  v_mfma_f32_16x16x32_bf16 v[56:59], v[76:79], v[104:107], v[56:59]
  ds_read_b64_tr_b16 a[222:223], v247 offset:34816
  v_mfma_f32_16x16x32_bf16 v[52:55], v[76:79], v[100:103], 0
  buffer_load_dwordx4 v236, s[40:43], s13 offen offset:0 lds
  v_mfma_f32_16x16x32_bf16 v[52:55], v[92:95], v[116:119], v[52:55]
  buffer_load_dwordx4 v237, s[40:43], s13 offen offset:1024 lds
  v_mfma_f32_16x16x32_bf16 v[48:51], v[92:95], v[112:115], 0
  buffer_load_dwordx4 v238, s[40:43], s13 offen offset:2048 lds
  v_mfma_f32_16x16x32_bf16 v[48:51], v[76:79], v[96:99], v[48:51]
  buffer_load_dwordx4 v239, s[40:43], s13 offen offset:3072 lds
  s_mov_b32 s10, 3
  s_call_b64 s[8:9], L_gemm2
  s_mov_b32 s61, 0
  s_waitcnt vmcnt(16) lgkmcnt(0)
  v_mfma_f32_16x16x32_bf16 v[32:35], v[72:75], v[96:99], v[32:35]
  ds_read_b128 a[240:243], v210 offset:0
  s_add_u32 s3, s3, 4096
  v_mfma_f32_16x16x32_bf16 v[32:35], v[88:91], v[112:115], v[32:35]
  ds_read_b128 a[244:247], v210 offset:1024
  s_cmp_eq_u32 s3, s7
  v_mfma_f32_16x16x32_bf16 v[36:39], v[88:91], v[116:119], v[36:39]
  ds_read_b128 a[248:251], v210 offset:2048
  s_cselect_b32 s3, 0, s3
  v_mfma_f32_16x16x32_bf16 v[36:39], v[72:75], v[100:103], v[36:39]
  ds_read_b128 a[252:255], v210 offset:3072
  v_add_u32 v210, s3, v213
  v_mfma_f32_16x16x32_bf16 v[40:43], v[72:75], v[104:107], v[40:43]
  ds_read_b64_tr_b16 a[208:209], v240 offset:16384
  v_mfma_f32_16x16x32_bf16 v[40:43], v[88:91], v[120:123], v[40:43]
  ds_read_b64_tr_b16 a[210:211], v240 offset:18432
  v_mfma_f32_16x16x32_bf16 v[44:47], v[88:91], v[124:127], v[44:47]
  ds_read_b64_tr_b16 a[212:213], v241 offset:16384
  v_mfma_f32_16x16x32_bf16 v[44:47], v[72:75], v[108:111], v[44:47]
  ds_read_b64_tr_b16 a[214:215], v241 offset:18432
  v_mfma_f32_16x16x32_bf16 v[60:63], v[76:79], v[108:111], v[60:63]
  ds_read_b64_tr_b16 a[216:217], v242 offset:16384
  v_mfma_f32_16x16x32_bf16 v[60:63], v[92:95], v[124:127], v[60:63]
  ds_read_b64_tr_b16 a[218:219], v242 offset:18432
  v_mfma_f32_16x16x32_bf16 v[56:59], v[92:95], v[120:123], v[56:59]
  ds_read_b64_tr_b16 a[220:221], v243 offset:16384
  v_mfma_f32_16x16x32_bf16 v[56:59], v[76:79], v[104:107], v[56:59]
  ds_read_b64_tr_b16 a[222:223], v243 offset:18432
  v_mfma_f32_16x16x32_bf16 v[52:55], v[76:79], v[100:103], v[52:55]
  buffer_store_dwordx4 v[192:195], v213, s[52:55], s94 offen offset:0 sc1
  v_mfma_f32_16x16x32_bf16 v[52:55], v[92:95], v[116:119], v[52:55]
  buffer_store_dwordx4 v[196:199], v213, s[52:55], s94 offen offset:1024 sc1
  v_mfma_f32_16x16x32_bf16 v[48:51], v[92:95], v[112:115], v[48:51]
  buffer_store_dwordx4 v[200:203], v213, s[52:55], s94 offen offset:2048 sc1
  v_mfma_f32_16x16x32_bf16 v[48:51], v[76:79], v[96:99], v[48:51]
  buffer_store_dwordx4 v[204:207], v213, s[52:55], s94 offen offset:3072 sc1
  s_waitcnt vmcnt(16) lgkmcnt(0)
  v_mfma_f32_16x16x32_bf16 v[0:3], a[192:195], a[224:227], v[0:3]
  ds_read_b128 v[96:99], v210 offset:0
  s_add_u32 s3, s3, 4096
  v_mfma_f32_16x16x32_bf16 v[0:3], a[208:211], a[240:243], v[0:3]
  ds_read_b128 v[100:103], v210 offset:1024
  s_cmp_eq_u32 s3, s7
  v_mfma_f32_16x16x32_bf16 v[4:7], a[208:211], a[244:247], v[4:7]
  ds_read_b128 v[104:107], v210 offset:2048
  s_cselect_b32 s3, 0, s3
  v_mfma_f32_16x16x32_bf16 v[4:7], a[192:195], a[228:231], v[4:7]
  ds_read_b128 v[108:111], v210 offset:3072
  v_add_u32 v210, s3, v213
  v_mfma_f32_16x16x32_bf16 v[8:11], a[192:195], a[232:235], v[8:11]
  ds_read_b64_tr_b16 v[64:65], v240 offset:32768
  v_mfma_f32_16x16x32_bf16 v[8:11], a[208:211], a[248:251], v[8:11]
  ds_read_b64_tr_b16 v[66:67], v240 offset:34816
  v_mfma_f32_16x16x32_bf16 v[12:15], a[208:211], a[252:255], v[12:15]
  ds_read_b64_tr_b16 v[68:69], v241 offset:32768
  v_mfma_f32_16x16x32_bf16 v[12:15], a[192:195], a[236:239], v[12:15]
  ds_read_b64_tr_b16 v[70:71], v241 offset:34816
  v_mfma_f32_16x16x32_bf16 v[28:31], a[196:199], a[236:239], v[28:31]
  ds_read_b64_tr_b16 v[72:73], v242 offset:32768
  v_mfma_f32_16x16x32_bf16 v[28:31], a[212:215], a[252:255], v[28:31]
  ds_read_b64_tr_b16 v[74:75], v242 offset:34816
  v_mfma_f32_16x16x32_bf16 v[24:27], a[212:215], a[248:251], v[24:27]
  ds_read_b64_tr_b16 v[76:77], v243 offset:32768
  v_mfma_f32_16x16x32_bf16 v[24:27], a[196:199], a[232:235], v[24:27]
  ds_read_b64_tr_b16 v[78:79], v243 offset:34816
  v_mfma_f32_16x16x32_bf16 v[20:23], a[196:199], a[228:231], v[20:23]
  buffer_store_dwordx4 v[216:219], v213, s[52:55], s95 offen offset:0 sc1
  v_mfma_f32_16x16x32_bf16 v[20:23], a[212:215], a[244:247], v[20:23]
  buffer_store_dwordx4 v[220:223], v213, s[52:55], s95 offen offset:1024 sc1
  v_mfma_f32_16x16x32_bf16 v[16:19], a[212:215], a[240:243], v[16:19]
  buffer_store_dwordx4 v[224:227], v213, s[52:55], s95 offen offset:2048 sc1
  v_mfma_f32_16x16x32_bf16 v[16:19], a[196:199], a[224:227], v[16:19]
  buffer_store_dwordx4 v[228:231], v213, s[52:55], s95 offen offset:3072 sc1
  s_waitcnt vmcnt(16) lgkmcnt(0)
  v_mfma_f32_16x16x32_bf16 v[32:35], a[200:203], a[224:227], v[32:35]
  ds_read_b128 v[112:115], v210 offset:0
  s_add_u32 s3, s3, 4096
  v_mfma_f32_16x16x32_bf16 v[32:35], a[216:219], a[240:243], v[32:35]
  ds_read_b128 v[116:119], v210 offset:1024
  s_cmp_eq_u32 s3, s7
  v_mfma_f32_16x16x32_bf16 v[36:39], a[216:219], a[244:247], v[36:39]
  ds_read_b128 v[120:123], v210 offset:2048
  s_cselect_b32 s3, 0, s3
  v_mfma_f32_16x16x32_bf16 v[36:39], a[200:203], a[228:231], v[36:39]
  ds_read_b128 v[124:127], v210 offset:3072
  v_add_u32 v210, s3, v213
  v_mfma_f32_16x16x32_bf16 v[40:43], a[200:203], a[232:235], v[40:43]
  ds_read_b64_tr_b16 v[80:81], v244 offset:0
  v_mfma_f32_16x16x32_bf16 v[40:43], a[216:219], a[248:251], v[40:43]
  ds_read_b64_tr_b16 v[82:83], v244 offset:2048
  v_mfma_f32_16x16x32_bf16 v[44:47], a[216:219], a[252:255], v[44:47]
  ds_read_b64_tr_b16 v[84:85], v245 offset:0
  v_mfma_f32_16x16x32_bf16 v[44:47], a[200:203], a[236:239], v[44:47]
  ds_read_b64_tr_b16 v[86:87], v245 offset:2048
  v_mfma_f32_16x16x32_bf16 v[60:63], a[204:207], a[236:239], v[60:63]
  ds_read_b64_tr_b16 v[88:89], v246 offset:0
  v_mfma_f32_16x16x32_bf16 v[60:63], a[220:223], a[252:255], v[60:63]
  ds_read_b64_tr_b16 v[90:91], v246 offset:2048
  v_mfma_f32_16x16x32_bf16 v[56:59], a[220:223], a[248:251], v[56:59]
  ds_read_b64_tr_b16 v[92:93], v247 offset:0
  v_mfma_f32_16x16x32_bf16 v[56:59], a[204:207], a[232:235], v[56:59]
  ds_read_b64_tr_b16 v[94:95], v247 offset:2048
  v_mfma_f32_16x16x32_bf16 v[52:55], a[204:207], a[228:231], v[52:55]
  buffer_load_dwordx4 v[248:251], v211, s[56:59], s12 offen
  v_mfma_f32_16x16x32_bf16 v[52:55], a[220:223], a[244:247], v[52:55]
  buffer_load_dwordx4 v[252:255], v211, s[56:59], s67 offen
  v_mfma_f32_16x16x32_bf16 v[48:51], a[220:223], a[240:243], v[48:51]

  v_mfma_f32_16x16x32_bf16 v[48:51], a[204:207], a[224:227], v[48:51]

  s_waitcnt vmcnt(14) lgkmcnt(0)
  v_mfma_f32_16x16x32_bf16 v[0:3], v[64:67], v[96:99], v[0:3]
  ds_read_b128 a[224:227], v210 offset:0
  s_add_u32 s3, s3, 4096
  v_mfma_f32_16x16x32_bf16 v[0:3], v[80:83], v[112:115], v[0:3]
  ds_read_b128 a[228:231], v210 offset:1024
  s_cmp_eq_u32 s3, s7
  v_mfma_f32_16x16x32_bf16 v[4:7], v[80:83], v[116:119], v[4:7]
  ds_read_b128 a[232:235], v210 offset:2048
  s_cselect_b32 s3, 0, s3
  v_mfma_f32_16x16x32_bf16 v[4:7], v[64:67], v[100:103], v[4:7]
  ds_read_b128 a[236:239], v210 offset:3072
  v_add_u32 v210, s3, v213
  v_mfma_f32_16x16x32_bf16 v[8:11], v[64:67], v[104:107], v[8:11]
  ds_read_b64_tr_b16 a[192:193], v244 offset:16384
  v_mfma_f32_16x16x32_bf16 v[8:11], v[80:83], v[120:123], v[8:11]
  ds_read_b64_tr_b16 a[194:195], v244 offset:18432
  v_mfma_f32_16x16x32_bf16 v[12:15], v[80:83], v[124:127], v[12:15]
  ds_read_b64_tr_b16 a[196:197], v245 offset:16384
  v_mfma_f32_16x16x32_bf16 v[12:15], v[64:67], v[108:111], v[12:15]
  ds_read_b64_tr_b16 a[198:199], v245 offset:18432
  v_mfma_f32_16x16x32_bf16 v[28:31], v[68:71], v[108:111], v[28:31]
  ds_read_b64_tr_b16 a[200:201], v246 offset:16384
  v_mfma_f32_16x16x32_bf16 v[28:31], v[84:87], v[124:127], v[28:31]
  ds_read_b64_tr_b16 a[202:203], v246 offset:18432
  v_mfma_f32_16x16x32_bf16 v[24:27], v[84:87], v[120:123], v[24:27]
  ds_read_b64_tr_b16 a[204:205], v247 offset:16384
  v_mfma_f32_16x16x32_bf16 v[24:27], v[68:71], v[104:107], v[24:27]
  ds_read_b64_tr_b16 a[206:207], v247 offset:18432
  v_mfma_f32_16x16x32_bf16 v[20:23], v[68:71], v[100:103], v[20:23]

  v_mfma_f32_16x16x32_bf16 v[20:23], v[84:87], v[116:119], v[20:23]

  v_mfma_f32_16x16x32_bf16 v[16:19], v[84:87], v[112:115], v[16:19]

  v_mfma_f32_16x16x32_bf16 v[16:19], v[68:71], v[96:99], v[16:19]

  s_waitcnt vmcnt(10) lgkmcnt(0)
  v_mfma_f32_16x16x32_bf16 v[32:35], v[72:75], v[96:99], v[32:35]
  ds_read_b128 a[240:243], v210 offset:0
  s_add_u32 s3, s3, 4096
  v_mfma_f32_16x16x32_bf16 v[32:35], v[88:91], v[112:115], v[32:35]
  ds_read_b128 a[244:247], v210 offset:1024
  s_cmp_eq_u32 s3, s7
  v_mfma_f32_16x16x32_bf16 v[36:39], v[88:91], v[116:119], v[36:39]
L_pad7:
  s_cbranch_execz L_padB
  ds_read_b128 a[248:251], v210 offset:2048
  s_cselect_b32 s3, 0, s3
  v_mfma_f32_16x16x32_bf16 v[36:39], v[72:75], v[100:103], v[36:39]
  ds_read_b128 a[252:255], v210 offset:3072
  v_add_u32 v210, s3, v213
  v_mfma_f32_16x16x32_bf16 v[40:43], v[72:75], v[104:107], v[40:43]
  ds_read_b64_tr_b16 a[208:209], v244 offset:32768
  v_mfma_f32_16x16x32_bf16 v[40:43], v[88:91], v[120:123], v[40:43]
  ds_read_b64_tr_b16 a[210:211], v244 offset:34816
  v_mfma_f32_16x16x32_bf16 v[44:47], v[88:91], v[124:127], v[44:47]
  ds_read_b64_tr_b16 a[212:213], v245 offset:32768
  v_mfma_f32_16x16x32_bf16 v[44:47], v[72:75], v[108:111], v[44:47]
  ds_read_b64_tr_b16 a[214:215], v245 offset:34816
  v_mfma_f32_16x16x32_bf16 v[60:63], v[76:79], v[108:111], v[60:63]
  ds_read_b64_tr_b16 a[216:217], v246 offset:32768
  v_mfma_f32_16x16x32_bf16 v[60:63], v[92:95], v[124:127], v[60:63]
  ds_read_b64_tr_b16 a[218:219], v246 offset:34816
  v_mfma_f32_16x16x32_bf16 v[56:59], v[92:95], v[120:123], v[56:59]
  ds_read_b64_tr_b16 a[220:221], v247 offset:32768
  v_mfma_f32_16x16x32_bf16 v[56:59], v[76:79], v[104:107], v[56:59]
  ds_read_b64_tr_b16 a[222:223], v247 offset:34816
  v_mfma_f32_16x16x32_bf16 v[52:55], v[76:79], v[100:103], v[52:55]

  v_mfma_f32_16x16x32_bf16 v[52:55], v[92:95], v[116:119], v[52:55]

  v_mfma_f32_16x16x32_bf16 v[48:51], v[92:95], v[112:115], v[48:51]

  v_mfma_f32_16x16x32_bf16 v[48:51], v[76:79], v[96:99], v[48:51]

  s_waitcnt vmcnt(63) lgkmcnt(0)
  v_mfma_f32_16x16x32_bf16 v[0:3], a[192:195], a[224:227], v[0:3]

  v_lshrrev_b32 v232, 4, v212
  v_mfma_f32_16x16x32_bf16 v[0:3], a[208:211], a[240:243], v[0:3]

  v_bfe_u32 v233, v212, 2, 2
  v_mfma_f32_16x16x32_bf16 v[4:7], a[208:211], a[244:247], v[4:7]

  v_cmp_eq_u32 vcc, v232, v233
  v_mfma_f32_16x16x32_bf16 v[4:7], a[192:195], a[228:231], v[4:7]

  v_and_b32 v232, 1, v212
  v_mfma_f32_16x16x32_bf16 v[8:11], a[192:195], a[232:235], v[8:11]

  v_lshlrev_b32 v232, 4, v232
  v_mfma_f32_16x16x32_bf16 v[8:11], a[208:211], a[248:251], v[8:11]

  v_mov_b32 v233, 0x3f80
  v_mfma_f32_16x16x32_bf16 v[12:15], a[208:211], a[252:255], v[12:15]

  v_lshlrev_b32 v233, v232, v233
  v_mfma_f32_16x16x32_bf16 v[12:15], a[192:195], a[236:239], v[12:15]

  v_cndmask_b32 v233, 0, v233, vcc
  v_mfma_f32_16x16x32_bf16 v[28:31], a[196:199], a[236:239], v[28:31]

  v_and_b32 v232, 2, v212
  v_mfma_f32_16x16x32_bf16 v[28:31], a[212:215], a[252:255], v[28:31]

  v_cmp_eq_u32 vcc, 0, v232
  v_mfma_f32_16x16x32_bf16 v[24:27], a[212:215], a[248:251], v[24:27]

  v_mov_b32 v236, 0
  v_mfma_f32_16x16x32_bf16 v[24:27], a[196:199], a[232:235], v[24:27]

  v_mov_b32 v237, 0
  v_mfma_f32_16x16x32_bf16 v[20:23], a[196:199], a[228:231], v[20:23]

  v_cndmask_b32 v238, 0, v233, vcc
  v_mfma_f32_16x16x32_bf16 v[20:23], a[212:215], a[244:247], v[20:23]

  v_cndmask_b32 v239, v233, v236, vcc
  v_mfma_f32_16x16x32_bf16 v[16:19], a[212:215], a[240:243], v[16:19]

  v_mov_b32 v240, 0
  v_mfma_f32_16x16x32_bf16 v[16:19], a[196:199], a[224:227], v[16:19]
  buffer_load_dword v234, v209, s[52:55], s60 offen sc1
  v_mov_b32 v241, 0
  s_waitcnt vmcnt(63) lgkmcnt(0)
  v_mfma_f32_16x16x32_bf16 v[32:35], a[200:203], a[224:227], v[32:35]

  v_mfma_f32_16x16x32_bf16 v[32:35], a[216:219], a[240:243], v[32:35]

  v_mfma_f32_16x16x32_bf16 v[36:39], a[216:219], a[244:247], v[36:39]

  v_mfma_f32_16x16x32_bf16 v[36:39], a[200:203], a[228:231], v[36:39]

  v_mfma_f32_16x16x32_bf16 v[40:43], a[200:203], a[232:235], v[40:43]

  v_mfma_f32_16x16x32_bf16 v[40:43], a[216:219], a[248:251], v[40:43]

  v_mfma_f32_16x16x32_bf16 v[44:47], a[216:219], a[252:255], v[44:47]

  v_mfma_f32_16x16x32_bf16 v[44:47], a[200:203], a[236:239], v[44:47]

  v_mfma_f32_16x16x32_bf16 v[60:63], a[204:207], a[236:239], v[60:63]

  v_mfma_f32_16x16x32_bf16 v[60:63], a[220:223], a[252:255], v[60:63]

  v_mfma_f32_16x16x32_bf16 v[56:59], a[220:223], a[248:251], v[56:59]

  v_mfma_f32_16x16x32_bf16 v[56:59], a[204:207], a[232:235], v[56:59]

  v_mfma_f32_16x16x32_bf16 v[52:55], a[204:207], a[228:231], v[52:55]

  v_mfma_f32_16x16x32_bf16 v[52:55], a[220:223], a[244:247], v[52:55]

  v_mfma_f32_16x16x32_bf16 v[48:51], a[220:223], a[240:243], v[48:51]

  v_mfma_f32_16x16x32_bf16 v[48:51], a[204:207], a[224:227], v[48:51]

  s_nop 5
  s_add_u32 s70, s65, 25165824
  s_add_u32 s71, s70, 4096
  s_cmp_eq_u32 s68, 0
  s_cselect_b32 s70, 0x40000000, s70
  s_cmp_eq_u32 s68, 1
  s_cselect_b32 s71, 0x40000000, s71
.p2align 3
  v_cvt_pk_bf16_f32 v0, v0, v1
  v_cvt_pk_bf16_f32 v1, v2, v3
  v_cvt_pk_bf16_f32 v2, v16, v17
  v_cvt_pk_bf16_f32 v3, v18, v19
  buffer_store_dwordx4 v[0:3], v213, s[52:55], s70 offen offset:0 sc1
  v_cvt_pk_bf16_f32 v4, v4, v5
  v_cvt_pk_bf16_f32 v5, v6, v7
  v_cvt_pk_bf16_f32 v6, v20, v21
  v_cvt_pk_bf16_f32 v7, v22, v23
  buffer_store_dwordx4 v[4:7], v213, s[52:55], s70 offen offset:1024 sc1
  v_cvt_pk_bf16_f32 v8, v8, v9
  v_cvt_pk_bf16_f32 v9, v10, v11
  v_cvt_pk_bf16_f32 v10, v24, v25
  v_cvt_pk_bf16_f32 v11, v26, v27
  buffer_store_dwordx4 v[8:11], v213, s[52:55], s70 offen offset:2048 sc1
  v_cvt_pk_bf16_f32 v12, v12, v13
  v_cvt_pk_bf16_f32 v13, v14, v15
  v_cvt_pk_bf16_f32 v14, v28, v29
  v_cvt_pk_bf16_f32 v15, v30, v31
  buffer_store_dwordx4 v[12:15], v213, s[52:55], s70 offen offset:3072 sc1
  v_cvt_pk_bf16_f32 v32, v32, v33
  v_cvt_pk_bf16_f32 v33, v34, v35
  v_cvt_pk_bf16_f32 v34, v48, v49
  v_cvt_pk_bf16_f32 v35, v50, v51
  buffer_store_dwordx4 v[32:35], v213, s[52:55], s71 offen offset:0 sc1
  v_cvt_pk_bf16_f32 v36, v36, v37
  v_cvt_pk_bf16_f32 v37, v38, v39
  v_cvt_pk_bf16_f32 v38, v52, v53
  v_cvt_pk_bf16_f32 v39, v54, v55
  buffer_store_dwordx4 v[36:39], v213, s[52:55], s71 offen offset:1024 sc1
  v_cvt_pk_bf16_f32 v40, v40, v41
  v_cvt_pk_bf16_f32 v41, v42, v43
  v_cvt_pk_bf16_f32 v42, v56, v57
  v_cvt_pk_bf16_f32 v43, v58, v59
  buffer_store_dwordx4 v[40:43], v213, s[52:55], s71 offen offset:2048 sc1
  v_cvt_pk_bf16_f32 v44, v44, v45
  v_cvt_pk_bf16_f32 v45, v46, v47
  v_cvt_pk_bf16_f32 v46, v60, v61
  v_cvt_pk_bf16_f32 v47, v62, v63
  buffer_store_dwordx4 v[44:47], v213, s[52:55], s71 offen offset:3072 sc1
  s_nop 1
  s_cmp_gt_u32 s68, 1
  s_cbranch_scc1 L_own_done
  v_add_u32 v210, s64, v213
  s_cmp_eq_u32 s68, 1
  s_cbranch_scc1 L_own1
  ds_write_b128 v210, v[192:195] offset:0
  ds_write_b128 v210, v[0:3] offset:16384
  ds_write_b128 v210, v[196:199] offset:1024
  ds_write_b128 v210, v[4:7] offset:17408
  ds_write_b128 v210, v[200:203] offset:2048
  ds_write_b128 v210, v[8:11] offset:18432
  ds_write_b128 v210, v[204:207] offset:3072
  ds_write_b128 v210, v[12:15] offset:19456
  s_branch L_own_w
L_own1:
  ds_write_b128 v210, v[216:219] offset:0
  ds_write_b128 v210, v[32:35] offset:16384
  ds_write_b128 v210, v[220:223] offset:1024
  ds_write_b128 v210, v[36:39] offset:17408
  ds_write_b128 v210, v[224:227] offset:2048
  ds_write_b128 v210, v[40:43] offset:18432
  ds_write_b128 v210, v[228:231] offset:3072
  ds_write_b128 v210, v[44:47] offset:19456
L_own_w:
L_own_done:
  s_lshr_b32 s70, s5, 1
  s_lshl_b32 s70, s70, 2
  s_add_u32 s70, s70, s4
  s_lshl_b32 s70, s70, 10
  s_add_u32 s70, s70, 65536
  s_waitcnt lgkmcnt(0)
  v_add_u32 v210, s70, v213
  s_waitcnt vmcnt(8)
  s_barrier
  buffer_atomic_add v214, v215, s[96:99], s69 offen sc1
  ds_read_b128 v[64:67], v210
  ds_read_b128 v[68:71], v210 offset:16384
  v_readfirstlane_b32 s63, v234
  v_lshlrev_b32 v214, 8, v214
  s_nop 2
  s_mul_i32 s62, s62, 0x101
  s_or_b32 s61, s61, s62
  s_mov_b32 s62, s63
  s_and_b32 s63, s63, 0x7f
  s_or_b32 s61, s61, s63
  v_mfma_f32_16x16x32_bf16 v[16:19], v[238:241], v[128:131], 0
  s_bitcmp1_b32 s63, 0
  s_cselect_b32 s71, s11, 0x40000000
  v_mfma_f32_16x16x32_bf16 v[20:23], v[236:239], v[128:131], 0
  s_add_u32 s72, s71, 16777216
  buffer_load_dwordx4 a[0:3], v213, s[52:55], s72 offen sc1
  v_mfma_f32_16x16x32_bf16 v[16:19], v[238:241], v[132:135], v[16:19]
  s_bitcmp1_b32 s63, 1
  s_cselect_b32 s71, s11, 0x40000000
  v_mfma_f32_16x16x32_bf16 v[20:23], v[236:239], v[132:135], v[20:23]
  s_add_u32 s72, s71, 16809984
  buffer_load_dwordx4 a[4:7], v213, s[52:55], s72 offen sc1
  v_mfma_f32_16x16x32_bf16 v[16:19], v[238:241], v[136:139], v[16:19]
  s_bitcmp1_b32 s63, 2
  s_cselect_b32 s71, s11, 0x40000000
  v_mfma_f32_16x16x32_bf16 v[20:23], v[236:239], v[136:139], v[20:23]
  s_add_u32 s72, s71, 16842752
  buffer_load_dwordx4 a[8:11], v213, s[52:55], s72 offen sc1
  v_mfma_f32_16x16x32_bf16 v[16:19], v[238:241], v[140:143], v[16:19]
  s_bitcmp1_b32 s63, 3
  s_cselect_b32 s71, s11, 0x40000000
  v_mfma_f32_16x16x32_bf16 v[20:23], v[236:239], v[140:143], v[20:23]
  s_add_u32 s72, s71, 16875520
  buffer_load_dwordx4 a[12:15], v213, s[52:55], s72 offen sc1
  v_mfma_f32_16x16x32_bf16 v[16:19], v[238:241], v[144:147], v[16:19]
  s_bitcmp1_b32 s63, 4
  s_cselect_b32 s71, s11, 0x40000000
  v_mfma_f32_16x16x32_bf16 v[20:23], v[236:239], v[144:147], v[20:23]
  s_add_u32 s72, s71, 16908288
  buffer_load_dwordx4 a[16:19], v213, s[52:55], s72 offen sc1
  v_mfma_f32_16x16x32_bf16 v[16:19], v[238:241], v[148:151], v[16:19]
  s_bitcmp1_b32 s63, 5
  s_cselect_b32 s71, s11, 0x40000000
  v_mfma_f32_16x16x32_bf16 v[20:23], v[236:239], v[148:151], v[20:23]
  s_add_u32 s72, s71, 16941056
  buffer_load_dwordx4 a[20:23], v213, s[52:55], s72 offen sc1
  v_mfma_f32_16x16x32_bf16 v[16:19], v[238:241], v[152:155], v[16:19]
  s_bitcmp1_b32 s63, 6
  s_cselect_b32 s71, s11, 0x40000000
  v_mfma_f32_16x16x32_bf16 v[20:23], v[236:239], v[152:155], v[20:23]
  s_add_u32 s72, s71, 16973824
  buffer_load_dwordx4 a[24:27], v213, s[52:55], s72 offen sc1
  v_mfma_f32_16x16x32_bf16 v[16:19], v[238:241], v[156:159], v[16:19]
  v_mfma_f32_16x16x32_bf16 v[20:23], v[236:239], v[156:159], v[20:23]
  v_mfma_f32_16x16x32_bf16 v[24:27], v[238:241], v[160:163], 0
  v_mfma_f32_16x16x32_bf16 v[28:31], v[236:239], v[160:163], 0
  v_mfma_f32_16x16x32_bf16 v[24:27], v[238:241], v[164:167], v[24:27]
  v_mfma_f32_16x16x32_bf16 v[28:31], v[236:239], v[164:167], v[28:31]
  v_mfma_f32_16x16x32_bf16 v[24:27], v[238:241], v[168:171], v[24:27]
  v_mfma_f32_16x16x32_bf16 v[28:31], v[236:239], v[168:171], v[28:31]
  v_mfma_f32_16x16x32_bf16 v[24:27], v[238:241], v[172:175], v[24:27]
  v_mfma_f32_16x16x32_bf16 v[28:31], v[236:239], v[172:175], v[28:31]
  v_mul_f32 v16, v16, v235
  v_mul_f32 v17, v17, v235
  v_mfma_f32_16x16x32_bf16 v[24:27], v[238:241], v[176:179], v[24:27]
  v_mul_f32 v18, v18, v235
  v_mul_f32 v19, v19, v235
  v_mfma_f32_16x16x32_bf16 v[28:31], v[236:239], v[176:179], v[28:31]
  v_mul_f32 v20, v20, v235
  v_mul_f32 v21, v21, v235
  v_mfma_f32_16x16x32_bf16 v[24:27], v[238:241], v[180:183], v[24:27]
  v_mul_f32 v22, v22, v235
  v_mul_f32 v23, v23, v235
  v_mfma_f32_16x16x32_bf16 v[28:31], v[236:239], v[180:183], v[28:31]
  v_cvt_pk_bf16_f32 v48, v16, v17
  v_lshlrev_b32 v16, 16, v48
  v_mfma_f32_16x16x32_bf16 v[24:27], v[238:241], v[184:187], v[24:27]
  v_and_b32 v17, 0xffff0000, v48
  v_cvt_pk_bf16_f32 v49, v18, v19
  v_mfma_f32_16x16x32_bf16 v[28:31], v[236:239], v[184:187], v[28:31]
  v_lshlrev_b32 v18, 16, v49
  v_and_b32 v19, 0xffff0000, v49
  v_mfma_f32_16x16x32_bf16 v[24:27], v[238:241], v[188:191], v[24:27]
  v_cvt_pk_bf16_f32 v48, v20, v21
  v_lshlrev_b32 v20, 16, v48
  v_mfma_f32_16x16x32_bf16 v[28:31], v[236:239], v[188:191], v[28:31]
  v_and_b32 v21, 0xffff0000, v48
  v_cvt_pk_bf16_f32 v49, v22, v23
  s_waitcnt vmcnt(8)
  s_barrier
  buffer_atomic_add v214, v215, s[96:99], s69 offen sc1
  s_call_b64 s[8:9], L_round
  s_waitcnt lgkmcnt(0)
  v_mfma_f32_16x16x32_bf16 v[0:3], v[238:241], v[64:67], 0
  v_lshlrev_b32 v22, 16, v49
  v_and_b32 v23, 0xffff0000, v49
  v_mfma_f32_16x16x32_bf16 v[4:7], v[236:239], v[64:67], 0
  v_mul_f32 v52, 0xbfb8aa3b, v16
  v_mul_f32 v53, 0xbfb8aa3b, v17
  v_mfma_f32_16x16x32_bf16 v[8:11], v[238:241], v[68:71], 0
  v_mul_f32 v54, 0xbfb8aa3b, v18
  v_mul_f32 v55, 0xbfb8aa3b, v19
  v_mfma_f32_16x16x32_bf16 v[12:15], v[236:239], v[68:71], 0
  v_mul_f32 v56, 0xbfb8aa3b, v20
  v_mul_f32 v57, 0xbfb8aa3b, v21
  v_mul_f32 v58, 0xbfb8aa3b, v22
  v_mul_f32 v59, 0xbfb8aa3b, v23
  v_exp_f32 v52, v52
  v_exp_f32 v53, v53
  v_exp_f32 v54, v54
  v_exp_f32 v55, v55
  v_exp_f32 v56, v56
  v_exp_f32 v57, v57
  v_exp_f32 v58, v58
  v_exp_f32 v59, v59
  v_add_f32 v52, 1.0, v52
  v_add_f32 v53, 1.0, v53
  v_add_f32 v54, 1.0, v54
  v_add_f32 v55, 1.0, v55
  v_add_f32 v56, 1.0, v56
  v_add_f32 v57, 1.0, v57
  v_add_f32 v58, 1.0, v58
  v_add_f32 v59, 1.0, v59
  v_rcp_f32 v52, v52
  v_rcp_f32 v53, v53
  v_rcp_f32 v54, v54
  v_rcp_f32 v55, v55
  v_rcp_f32 v56, v56
  v_rcp_f32 v57, v57
  v_rcp_f32 v58, v58
  v_rcp_f32 v59, v59
  v_mul_f32 v16, v16, v52
  v_mul_f32 v17, v17, v53
  v_mul_f32 v18, v18, v54
  v_mul_f32 v19, v19, v55
  v_mul_f32 v20, v20, v56
  v_mul_f32 v21, v21, v57
  v_mul_f32 v22, v22, v58
  v_mul_f32 v23, v23, v59
  v_cvt_pk_bf16_f32 v48, v16, v17
  v_lshlrev_b32 v16, 16, v48
  v_and_b32 v17, 0xffff0000, v48
  v_cvt_pk_bf16_f32 v49, v18, v19
  v_lshlrev_b32 v18, 16, v49
  v_and_b32 v19, 0xffff0000, v49
  v_cvt_pk_bf16_f32 v48, v20, v21
  v_lshlrev_b32 v20, 16, v48
  v_and_b32 v21, 0xffff0000, v48
  v_cvt_pk_bf16_f32 v49, v22, v23
  v_lshlrev_b32 v22, 16, v49
  v_and_b32 v23, 0xffff0000, v49
  v_mul_f32 v24, v24, v235
  v_mul_f32 v25, v25, v235
  v_mul_f32 v26, v26, v235
  v_mul_f32 v27, v27, v235
  v_mul_f32 v28, v28, v235
  v_mul_f32 v29, v29, v235
  v_mul_f32 v30, v30, v235
  v_mul_f32 v31, v31, v235
  v_cvt_pk_bf16_f32 v48, v24, v25
  v_lshlrev_b32 v24, 16, v48
  v_and_b32 v25, 0xffff0000, v48
  v_cvt_pk_bf16_f32 v49, v26, v27
  v_lshlrev_b32 v26, 16, v49
  v_and_b32 v27, 0xffff0000, v49
  v_cvt_pk_bf16_f32 v48, v28, v29
  v_lshlrev_b32 v28, 16, v48
  v_and_b32 v29, 0xffff0000, v48
  v_cvt_pk_bf16_f32 v49, v30, v31
  v_lshlrev_b32 v30, 16, v49
  v_and_b32 v31, 0xffff0000, v49
  v_mul_f32 v52, 0xbfb8aa3b, v24
  v_mul_f32 v53, 0xbfb8aa3b, v25
  v_mul_f32 v54, 0xbfb8aa3b, v26
  v_mul_f32 v55, 0xbfb8aa3b, v27
  v_mul_f32 v56, 0xbfb8aa3b, v28
  v_mul_f32 v57, 0xbfb8aa3b, v29
  v_mul_f32 v58, 0xbfb8aa3b, v30
  v_mul_f32 v59, 0xbfb8aa3b, v31
  v_exp_f32 v52, v52
  v_exp_f32 v53, v53
  v_exp_f32 v54, v54
  v_exp_f32 v55, v55
  v_exp_f32 v56, v56
  v_exp_f32 v57, v57
  v_exp_f32 v58, v58
  v_exp_f32 v59, v59
  v_add_f32 v52, 1.0, v52
  v_add_f32 v53, 1.0, v53
  v_add_f32 v54, 1.0, v54
  v_add_f32 v55, 1.0, v55
  v_add_f32 v56, 1.0, v56
  v_add_f32 v57, 1.0, v57
  v_add_f32 v58, 1.0, v58
  v_add_f32 v59, 1.0, v59
  v_rcp_f32 v52, v52
  v_rcp_f32 v53, v53
  v_rcp_f32 v54, v54
  v_rcp_f32 v55, v55
  v_rcp_f32 v56, v56
  v_rcp_f32 v57, v57
  v_rcp_f32 v58, v58
  v_rcp_f32 v59, v59
  v_mul_f32 v24, v24, v52
  v_mul_f32 v25, v25, v53
  v_mul_f32 v26, v26, v54
  v_mul_f32 v27, v27, v55
  v_mul_f32 v28, v28, v56
  v_mul_f32 v29, v29, v57
  v_mul_f32 v30, v30, v58
  v_mul_f32 v31, v31, v59
  v_cvt_pk_bf16_f32 v48, v24, v25
  v_lshlrev_b32 v24, 16, v48
  v_and_b32 v25, 0xffff0000, v48
  v_cvt_pk_bf16_f32 v49, v26, v27
  v_lshlrev_b32 v26, 16, v49
  v_and_b32 v27, 0xffff0000, v49
  v_cvt_pk_bf16_f32 v48, v28, v29
  v_lshlrev_b32 v28, 16, v48
  v_and_b32 v29, 0xffff0000, v48
  v_cvt_pk_bf16_f32 v49, v30, v31
  v_lshlrev_b32 v30, 16, v49
  v_and_b32 v31, 0xffff0000, v49
  v_permlane16_swap_b32 v248, v250
  v_permlane16_swap_b32 v249, v251
  v_lshlrev_b32 v72, 16, v248
  v_and_b32 v73, 0xffff0000, v248
  v_lshlrev_b32 v74, 16, v249
  v_and_b32 v75, 0xffff0000, v249
  v_lshlrev_b32 v76, 16, v250
  v_and_b32 v77, 0xffff0000, v250
  v_lshlrev_b32 v78, 16, v251
  v_and_b32 v79, 0xffff0000, v251
  v_permlane16_swap_b32 v252, v254
  v_permlane16_swap_b32 v253, v255
  v_lshlrev_b32 v80, 16, v252
  v_and_b32 v81, 0xffff0000, v252
  v_lshlrev_b32 v82, 16, v253
  v_and_b32 v83, 0xffff0000, v253
  v_lshlrev_b32 v84, 16, v254
  v_and_b32 v85, 0xffff0000, v254
  v_lshlrev_b32 v86, 16, v255
  v_and_b32 v87, 0xffff0000, v255
  s_mov_b32 s96, s32
  s_mov_b32 s97, s33
  s_mov_b32 s98, 2097152
  s_mov_b32 s10, 200000
L_sp0:
  s_cmp_eq_u32 s61, 0xffff
  s_cbranch_scc1 L_both
  s_bfe_u32 s73, s61, 524288
  buffer_load_dword v234, v209, s[52:55], s60 offen sc1
  s_waitcnt vmcnt(0)
  v_readfirstlane_b32 s62, v234
  s_nop 3
  s_call_b64 s[8:9], L_round
  s_cmp_eq_u32 s73, 0xff
  s_cbranch_scc1 L_sp0_done
  s_sub_u32 s10, s10, 1
  s_cbranch_scc0 L_sp0
  s_mov_b32 s10, 0
  s_branch L_sp0_done
L_st0:
  s_branch L_disp
L_sp0_done:
  v_mfma_f32_16x16x32_bf16 v[0:3], v[238:241], a[0:3], v[0:3]
  v_mfma_f32_16x16x32_bf16 v[0:3], v[238:241], a[4:7], v[0:3]
  v_mfma_f32_16x16x32_bf16 v[0:3], v[238:241], a[8:11], v[0:3]
  v_mfma_f32_16x16x32_bf16 v[0:3], v[238:241], a[12:15], v[0:3]
  v_mfma_f32_16x16x32_bf16 v[0:3], v[238:241], a[16:19], v[0:3]
  v_mfma_f32_16x16x32_bf16 v[0:3], v[238:241], a[20:23], v[0:3]
  v_mfma_f32_16x16x32_bf16 v[0:3], v[238:241], a[24:27], v[0:3]
  v_mfma_f32_16x16x32_bf16 v[0:3], v[238:241], a[28:31], v[0:3]
  s_nop 2
  v_mfma_f32_16x16x32_bf16 v[4:7], v[236:239], a[0:3], v[4:7]
  s_nop 2
  v_mfma_f32_16x16x32_bf16 v[4:7], v[236:239], a[4:7], v[4:7]
  v_fma_f32 v0, v0, v16, v72
  v_fma_f32 v1, v1, v17, v73
  v_mfma_f32_16x16x32_bf16 v[4:7], v[236:239], a[8:11], v[4:7]
  v_fma_f32 v2, v2, v18, v74
  v_fma_f32 v3, v3, v19, v75
  v_mfma_f32_16x16x32_bf16 v[4:7], v[236:239], a[12:15], v[4:7]
  v_cvt_pk_bf16_f32 v248, v0, v1
  v_mfma_f32_16x16x32_bf16 v[4:7], v[236:239], a[16:19], v[4:7]
  v_cvt_pk_bf16_f32 v249, v2, v3
  v_mfma_f32_16x16x32_bf16 v[4:7], v[236:239], a[20:23], v[4:7]
  v_mfma_f32_16x16x32_bf16 v[4:7], v[236:239], a[24:27], v[4:7]
  v_mfma_f32_16x16x32_bf16 v[4:7], v[236:239], a[28:31], v[4:7]
  s_nop 7
  v_fma_f32 v4, v4, v20, v76
  v_fma_f32 v5, v5, v21, v77
  v_fma_f32 v6, v6, v22, v78
  v_fma_f32 v7, v7, v23, v79
  v_cvt_pk_bf16_f32 v250, v4, v5
  v_cvt_pk_bf16_f32 v251, v6, v7
  s_nop 0
  v_permlane16_swap_b32 v248, v250
  v_permlane16_swap_b32 v249, v251
L_sp1:
  s_cmp_eq_u32 s61, 0xffff
  s_cbranch_scc1 L_sp1_done
  s_bfe_u32 s73, s61, 524296
  buffer_load_dword v234, v209, s[52:55], s60 offen sc1
  s_waitcnt vmcnt(0)
  v_readfirstlane_b32 s62, v234
  s_nop 3
  s_call_b64 s[8:9], L_round
  s_sub_u32 s10, s10, 1
  s_cbranch_scc0 L_sp1
  s_mov_b32 s10, 0
  s_branch L_sp1_done
L_st1:
  s_branch L_disp
L_sp1_done:
  s_waitcnt vmcnt(0)
  v_mfma_f32_16x16x32_bf16 v[8:11], v[238:241], a[32:35], v[8:11]
  buffer_store_dwordx4 v[248:251], v211, s[96:99], s12 offen
  v_mfma_f32_16x16x32_bf16 v[8:11], v[238:241], a[36:39], v[8:11]
  v_mfma_f32_16x16x32_bf16 v[8:11], v[238:241], a[40:43], v[8:11]
  v_mfma_f32_16x16x32_bf16 v[8:11], v[238:241], a[44:47], v[8:11]
  v_mfma_f32_16x16x32_bf16 v[8:11], v[238:241], a[48:51], v[8:11]
  v_mfma_f32_16x16x32_bf16 v[8:11], v[238:241], a[52:55], v[8:11]
  v_mfma_f32_16x16x32_bf16 v[8:11], v[238:241], a[56:59], v[8:11]
  v_mfma_f32_16x16x32_bf16 v[8:11], v[238:241], a[60:63], v[8:11]
  s_nop 2
  v_mfma_f32_16x16x32_bf16 v[12:15], v[236:239], a[32:35], v[12:15]
  s_nop 2
  v_mfma_f32_16x16x32_bf16 v[12:15], v[236:239], a[36:39], v[12:15]
  v_fma_f32 v8, v8, v24, v80
  v_fma_f32 v9, v9, v25, v81
  v_mfma_f32_16x16x32_bf16 v[12:15], v[236:239], a[40:43], v[12:15]
  v_fma_f32 v10, v10, v26, v82
  v_fma_f32 v11, v11, v27, v83
  v_mfma_f32_16x16x32_bf16 v[12:15], v[236:239], a[44:47], v[12:15]
  v_cvt_pk_bf16_f32 v252, v8, v9
  v_mfma_f32_16x16x32_bf16 v[12:15], v[236:239], a[48:51], v[12:15]
  v_cvt_pk_bf16_f32 v253, v10, v11
  v_mfma_f32_16x16x32_bf16 v[12:15], v[236:239], a[52:55], v[12:15]
  v_mfma_f32_16x16x32_bf16 v[12:15], v[236:239], a[56:59], v[12:15]
  v_mfma_f32_16x16x32_bf16 v[12:15], v[236:239], a[60:63], v[12:15]
  s_nop 7
  v_fma_f32 v12, v12, v28, v84
  v_fma_f32 v13, v13, v29, v85
  v_fma_f32 v14, v14, v30, v86
  v_fma_f32 v15, v15, v31, v87
  v_cvt_pk_bf16_f32 v254, v12, v13
  v_cvt_pk_bf16_f32 v255, v14, v15
  s_nop 0
  v_permlane16_swap_b32 v252, v254
  v_permlane16_swap_b32 v253, v255
  buffer_store_dwordx4 v[252:255], v211, s[96:99], s67 offen
  s_branch L_fin
L_padB:
  s_branch L_disp
L_both:
  s_waitcnt vmcnt(0)
  v_mfma_f32_16x16x32_bf16 v[0:3], v[238:241], a[0:3], v[0:3]
  v_mfma_f32_16x16x32_bf16 v[0:3], v[238:241], a[4:7], v[0:3]
  v_mfma_f32_16x16x32_bf16 v[0:3], v[238:241], a[8:11], v[0:3]
  v_mfma_f32_16x16x32_bf16 v[0:3], v[238:241], a[12:15], v[0:3]
  v_mfma_f32_16x16x32_bf16 v[0:3], v[238:241], a[16:19], v[0:3]
  v_mfma_f32_16x16x32_bf16 v[0:3], v[238:241], a[20:23], v[0:3]
  v_mfma_f32_16x16x32_bf16 v[0:3], v[238:241], a[24:27], v[0:3]
  v_mfma_f32_16x16x32_bf16 v[0:3], v[238:241], a[28:31], v[0:3]
  s_nop 2
  v_mfma_f32_16x16x32_bf16 v[4:7], v[236:239], a[0:3], v[4:7]
  s_nop 2
  v_mfma_f32_16x16x32_bf16 v[4:7], v[236:239], a[4:7], v[4:7]
  v_fma_f32 v0, v0, v16, v72
  v_fma_f32 v1, v1, v17, v73
  v_mfma_f32_16x16x32_bf16 v[4:7], v[236:239], a[8:11], v[4:7]
  v_fma_f32 v2, v2, v18, v74
  v_fma_f32 v3, v3, v19, v75
  v_mfma_f32_16x16x32_bf16 v[4:7], v[236:239], a[12:15], v[4:7]
  v_cvt_pk_bf16_f32 v248, v0, v1
  v_mfma_f32_16x16x32_bf16 v[4:7], v[236:239], a[16:19], v[4:7]
  v_cvt_pk_bf16_f32 v249, v2, v3
  v_mfma_f32_16x16x32_bf16 v[4:7], v[236:239], a[20:23], v[4:7]
  v_mfma_f32_16x16x32_bf16 v[4:7], v[236:239], a[24:27], v[4:7]
  v_mfma_f32_16x16x32_bf16 v[4:7], v[236:239], a[28:31], v[4:7]
  s_nop 2
  v_mfma_f32_16x16x32_bf16 v[8:11], v[238:241], a[32:35], v[8:11]
  s_nop 2
  v_mfma_f32_16x16x32_bf16 v[8:11], v[238:241], a[36:39], v[8:11]
  v_fma_f32 v4, v4, v20, v76
  v_fma_f32 v5, v5, v21, v77
  v_mfma_f32_16x16x32_bf16 v[8:11], v[238:241], a[40:43], v[8:11]
  v_fma_f32 v6, v6, v22, v78
  v_fma_f32 v7, v7, v23, v79
  v_mfma_f32_16x16x32_bf16 v[8:11], v[238:241], a[44:47], v[8:11]
  v_cvt_pk_bf16_f32 v250, v4, v5
  v_mfma_f32_16x16x32_bf16 v[8:11], v[238:241], a[48:51], v[8:11]
  v_cvt_pk_bf16_f32 v251, v6, v7
  v_permlane16_swap_b32 v248, v250
  v_mfma_f32_16x16x32_bf16 v[8:11], v[238:241], a[52:55], v[8:11]
  v_permlane16_swap_b32 v249, v251
  v_mfma_f32_16x16x32_bf16 v[8:11], v[238:241], a[56:59], v[8:11]
  buffer_store_dwordx4 v[248:251], v211, s[96:99], s12 offen
  v_mfma_f32_16x16x32_bf16 v[8:11], v[238:241], a[60:63], v[8:11]
  s_nop 2
  v_mfma_f32_16x16x32_bf16 v[12:15], v[236:239], a[32:35], v[12:15]
  s_nop 2
  v_mfma_f32_16x16x32_bf16 v[12:15], v[236:239], a[36:39], v[12:15]
  v_fma_f32 v8, v8, v24, v80
  v_fma_f32 v9, v9, v25, v81
  v_mfma_f32_16x16x32_bf16 v[12:15], v[236:239], a[40:43], v[12:15]
  v_fma_f32 v10, v10, v26, v82
  v_fma_f32 v11, v11, v27, v83
  v_mfma_f32_16x16x32_bf16 v[12:15], v[236:239], a[44:47], v[12:15]
  v_cvt_pk_bf16_f32 v252, v8, v9
  v_mfma_f32_16x16x32_bf16 v[12:15], v[236:239], a[48:51], v[12:15]
  v_cvt_pk_bf16_f32 v253, v10, v11
  v_mfma_f32_16x16x32_bf16 v[12:15], v[236:239], a[52:55], v[12:15]
  v_mfma_f32_16x16x32_bf16 v[12:15], v[236:239], a[56:59], v[12:15]
  v_mfma_f32_16x16x32_bf16 v[12:15], v[236:239], a[60:63], v[12:15]
  s_nop 7
  v_fma_f32 v12, v12, v28, v84
  v_fma_f32 v13, v13, v29, v85
  v_fma_f32 v14, v14, v30, v86
  v_fma_f32 v15, v15, v31, v87
  v_cvt_pk_bf16_f32 v254, v12, v13
  v_cvt_pk_bf16_f32 v255, v14, v15
  s_nop 0
  v_permlane16_swap_b32 v252, v254
  v_permlane16_swap_b32 v253, v255
  buffer_store_dwordx4 v[252:255], v211, s[96:99], s67 offen
L_fin:
L_end:
  s_endpgm
L_padR:
  s_branch L_disp
L_round:
  s_andn2_b32 s63, s62, s61
  s_or_b32 s61, s61, s62
  s_and_b32 s70, s63, 15
  s_cbranch_scc0 L_rs0
  s_add_u32 s72, s11, 16777216
  s_bitcmp1_b32 s63, 0
  s_cselect_b64 exec, -1, 0
  buffer_load_dwordx4 a[0:3], v213, s[52:55], s72 offen sc1
  s_add_u32 s72, s11, 16809984
  s_bitcmp1_b32 s63, 1
  s_cselect_b64 exec, -1, 0
  buffer_load_dwordx4 a[4:7], v213, s[52:55], s72 offen sc1
  s_add_u32 s72, s11, 16842752
  s_bitcmp1_b32 s63, 2
  s_cselect_b64 exec, -1, 0
  buffer_load_dwordx4 a[8:11], v213, s[52:55], s72 offen sc1
  s_add_u32 s72, s11, 16875520
  s_bitcmp1_b32 s63, 3
  s_cselect_b64 exec, -1, 0
  buffer_load_dwordx4 a[12:15], v213, s[52:55], s72 offen sc1
  s_mov_b64 exec, -1
L_rs0:
  s_and_b32 s70, s63, 240
  s_cbranch_scc0 L_rs1
  s_add_u32 s72, s11, 16908288
  s_bitcmp1_b32 s63, 4
  s_cselect_b64 exec, -1, 0
  buffer_load_dwordx4 a[16:19], v213, s[52:55], s72 offen sc1
  s_add_u32 s72, s11, 16941056
  s_bitcmp1_b32 s63, 5
  s_cselect_b64 exec, -1, 0
  buffer_load_dwordx4 a[20:23], v213, s[52:55], s72 offen sc1
  s_add_u32 s72, s11, 16973824
  s_bitcmp1_b32 s63, 6
  s_cselect_b64 exec, -1, 0
  buffer_load_dwordx4 a[24:27], v213, s[52:55], s72 offen sc1
  s_add_u32 s72, s11, 17006592
  s_bitcmp1_b32 s63, 7
  s_cselect_b64 exec, -1, 0
  buffer_load_dwordx4 a[28:31], v213, s[52:55], s72 offen sc1
  s_mov_b64 exec, -1
L_rs1:
  s_and_b32 s70, s63, 3840
  s_cbranch_scc0 L_rs2
  s_add_u32 s72, s11, 25165824
  s_bitcmp1_b32 s63, 8
  s_cselect_b64 exec, -1, 0
  buffer_load_dwordx4 a[32:35], v213, s[52:55], s72 offen sc1
  s_add_u32 s72, s11, 25198592
  s_bitcmp1_b32 s63, 9
  s_cselect_b64 exec, -1, 0
  buffer_load_dwordx4 a[36:39], v213, s[52:55], s72 offen sc1
  s_add_u32 s72, s11, 25231360
  s_bitcmp1_b32 s63, 10
  s_cselect_b64 exec, -1, 0
  buffer_load_dwordx4 a[40:43], v213, s[52:55], s72 offen sc1
  s_add_u32 s72, s11, 25264128
  s_bitcmp1_b32 s63, 11
  s_cselect_b64 exec, -1, 0
  buffer_load_dwordx4 a[44:47], v213, s[52:55], s72 offen sc1
  s_mov_b64 exec, -1
L_rs2:
  s_and_b32 s70, s63, 61440
  s_cbranch_scc0 L_rs3
  s_add_u32 s72, s11, 25296896
  s_bitcmp1_b32 s63, 12
  s_cselect_b64 exec, -1, 0
  buffer_load_dwordx4 a[48:51], v213, s[52:55], s72 offen sc1
  s_add_u32 s72, s11, 25329664
  s_bitcmp1_b32 s63, 13
  s_cselect_b64 exec, -1, 0
  buffer_load_dwordx4 a[52:55], v213, s[52:55], s72 offen sc1
  s_add_u32 s72, s11, 25362432
  s_bitcmp1_b32 s63, 14
  s_cselect_b64 exec, -1, 0
  buffer_load_dwordx4 a[56:59], v213, s[52:55], s72 offen sc1
  s_add_u32 s72, s11, 25395200
  s_bitcmp1_b32 s63, 15
  s_cselect_b64 exec, -1, 0
  buffer_load_dwordx4 a[60:63], v213, s[52:55], s72 offen sc1
  s_mov_b64 exec, -1
L_rs3:
  s_setpc_b64 s[8:9]
L_w3:
  s_mov_b32 s40, s22
  s_mov_b32 s41, s23
  s_mov_b32 s42, 4194304
  s_mov_b32 s70, 8192
  v_mad_u32_u24 v236, v208, s70, v209
  s_lshl_b32 s70, s5, 10
  s_lshl_b32 s71, s4, 8
  s_add_u32 s70, s70, s71
  s_add_u32 s70, s70, s67
  v_add_u32 v236, s70, v236
  v_add_u32 v237, 64512, v236
  v_add_u32 v238, 129024, v236
  v_add_u32 v239, 193536, v236
  s_mov_b32 s14, 262144
  s_mov_b32 s27, 4194304
  s_mul_i32 s13, s100, 262144
  s_sub_u32 s13, s13, s14
  s_waitcnt vmcnt(0) lgkmcnt(0)
  s_add_u32 m0, s64, 0
  s_add_u32 s13, s13, s14
  s_cmp_eq_u32 s13, s27
  s_cselect_b32 s13, 0, s13
  buffer_load_dwordx4 v236, s[40:43], s13 offen offset:0 lds
  buffer_load_dwordx4 v237, s[40:43], s13 offen offset:1024 lds
  buffer_load_dwordx4 v238, s[40:43], s13 offen offset:2048 lds
  buffer_load_dwordx4 v239, s[40:43], s13 offen offset:3072 lds
  s_add_u32 m0, s64, 16384
  s_add_u32 s13, s13, s14
  s_cmp_eq_u32 s13, s27
  s_cselect_b32 s13, 0, s13
  buffer_load_dwordx4 v236, s[40:43], s13 offen offset:0 lds
  buffer_load_dwordx4 v237, s[40:43], s13 offen offset:1024 lds
  buffer_load_dwordx4 v238, s[40:43], s13 offen offset:2048 lds
  buffer_load_dwordx4 v239, s[40:43], s13 offen offset:3072 lds
  s_add_u32 m0, s64, 32768
  s_add_u32 s13, s13, s14
  s_cmp_eq_u32 s13, s27
  s_cselect_b32 s13, 0, s13
  buffer_load_dwordx4 v236, s[40:43], s13 offen offset:0 lds
  buffer_load_dwordx4 v237, s[40:43], s13 offen offset:1024 lds
  buffer_load_dwordx4 v238, s[40:43], s13 offen offset:2048 lds
  buffer_load_dwordx4 v239, s[40:43], s13 offen offset:3072 lds
  s_add_u32 m0, s64, 49152
  s_add_u32 s13, s13, s14
  s_cmp_eq_u32 s13, s27
  s_cselect_b32 s13, 0, s13
  buffer_load_dwordx4 v236, s[40:43], s13 offen offset:0 lds
  buffer_load_dwordx4 v237, s[40:43], s13 offen offset:1024 lds
  buffer_load_dwordx4 v238, s[40:43], s13 offen offset:2048 lds
  buffer_load_dwordx4 v239, s[40:43], s13 offen offset:3072 lds
  s_add_u32 m0, s64, 65536
  s_add_u32 s13, s13, s14
  s_cmp_eq_u32 s13, s27
  s_cselect_b32 s13, 0, s13
  buffer_load_dwordx4 v236, s[40:43], s13 offen offset:0 lds
  buffer_load_dwordx4 v237, s[40:43], s13 offen offset:1024 lds
  buffer_load_dwordx4 v238, s[40:43], s13 offen offset:2048 lds
  buffer_load_dwordx4 v239, s[40:43], s13 offen offset:3072 lds
  s_add_u32 m0, s64, 81920
  s_add_u32 s13, s13, s14
  s_cmp_eq_u32 s13, s27
  s_cselect_b32 s13, 0, s13
  buffer_load_dwordx4 v236, s[40:43], s13 offen offset:0 lds
  buffer_load_dwordx4 v237, s[40:43], s13 offen offset:1024 lds
  buffer_load_dwordx4 v238, s[40:43], s13 offen offset:2048 lds
  buffer_load_dwordx4 v239, s[40:43], s13 offen offset:3072 lds
  s_waitcnt vmcnt(16)
  ds_read_b64_tr_b16 v[64:65], v240 offset:0
  ds_read_b64_tr_b16 v[66:67], v240 offset:2048
  ds_read_b64_tr_b16 v[68:69], v241 offset:0
  ds_read_b64_tr_b16 v[70:71], v241 offset:2048
  ds_read_b64_tr_b16 v[72:73], v242 offset:0
  ds_read_b64_tr_b16 v[74:75], v242 offset:2048
  ds_read_b64_tr_b16 v[76:77], v243 offset:0
  ds_read_b64_tr_b16 v[78:79], v243 offset:2048
  ds_read_b64_tr_b16 v[80:81], v240 offset:16384
  ds_read_b64_tr_b16 v[82:83], v240 offset:18432
  ds_read_b64_tr_b16 v[84:85], v241 offset:16384
  ds_read_b64_tr_b16 v[86:87], v241 offset:18432
  ds_read_b64_tr_b16 v[88:89], v242 offset:16384
  ds_read_b64_tr_b16 v[90:91], v242 offset:18432
  ds_read_b64_tr_b16 v[92:93], v243 offset:16384
  ds_read_b64_tr_b16 v[94:95], v243 offset:18432
  s_waitcnt lgkmcnt(0)
  s_add_u32 m0, s64, 0
  s_add_u32 s13, s13, s14
  s_cmp_eq_u32 s13, s27
  s_cselect_b32 s13, 0, s13
  buffer_load_dwordx4 v236, s[40:43], s13 offen offset:0 lds
  buffer_load_dwordx4 v237, s[40:43], s13 offen offset:1024 lds
  buffer_load_dwordx4 v238, s[40:43], s13 offen offset:2048 lds
  buffer_load_dwordx4 v239, s[40:43], s13 offen offset:3072 lds
  s_branch L_qstart
L_walk:
  s_mov_b32 s10, 0
L_walk1:
  s_mov_b64 exec, 0
  s_cmp_eq_u32 s10, 0
  s_cbranch_scc1 L_pad0
  s_cmp_eq_u32 s10, 1
  s_cbranch_scc1 L_pad1
  s_cmp_eq_u32 s10, 2
  s_cbranch_scc1 L_pad2
  s_branch L_pad3
L_disp:
  s_mov_b64 exec, -1
  s_add_u32 s10, s10, 1
  s_cmp_lt_u32 s10, 4
  s_cbranch_scc1 L_walk1
  s_branch L_walk_ret
L_ffn2_even:
  s_waitcnt vmcnt(16) lgkmcnt(0)
  v_mfma_f32_16x16x32_bf16 v[0:3], v[64:67], v[96:99], 0
  ds_read_b128 a[224:227], v210 offset:0
  s_add_u32 s3, s3, 4096
  v_mfma_f32_16x16x32_bf16 v[0:3], v[80:83], v[112:115], v[0:3]
  ds_read_b128 a[228:231], v210 offset:1024
  s_cmp_eq_u32 s3, s7
  v_mfma_f32_16x16x32_bf16 v[4:7], v[80:83], v[116:119], 0
  ds_read_b128 a[232:235], v210 offset:2048
  s_cselect_b32 s3, 0, s3
  v_mfma_f32_16x16x32_bf16 v[4:7], v[64:67], v[100:103], v[4:7]
  ds_read_b128 a[236:239], v210 offset:3072
  v_add_u32 v210, s3, v213
  v_mfma_f32_16x16x32_bf16 v[8:11], v[64:67], v[104:107], 0
  ds_read_b64_tr_b16 a[192:193], v244 offset:16384
  s_add_u32 s13, s13, s14
  v_mfma_f32_16x16x32_bf16 v[8:11], v[80:83], v[120:123], v[8:11]
  ds_read_b64_tr_b16 a[194:195], v244 offset:18432
  s_cmp_eq_u32 s13, s27
  v_mfma_f32_16x16x32_bf16 v[12:15], v[80:83], v[124:127], 0
  ds_read_b64_tr_b16 a[196:197], v245 offset:16384
  s_cselect_b32 s13, 0, s13
  v_mfma_f32_16x16x32_bf16 v[12:15], v[64:67], v[108:111], v[12:15]
  ds_read_b64_tr_b16 a[198:199], v245 offset:18432
  s_add_u32 m0, s64, 49152
  v_mfma_f32_16x16x32_bf16 v[28:31], v[68:71], v[108:111], 0
  ds_read_b64_tr_b16 a[200:201], v246 offset:16384
  v_mfma_f32_16x16x32_bf16 v[28:31], v[84:87], v[124:127], v[28:31]
  ds_read_b64_tr_b16 a[202:203], v246 offset:18432
  v_mfma_f32_16x16x32_bf16 v[24:27], v[84:87], v[120:123], 0
  ds_read_b64_tr_b16 a[204:205], v247 offset:16384
  v_mfma_f32_16x16x32_bf16 v[24:27], v[68:71], v[104:107], v[24:27]
  ds_read_b64_tr_b16 a[206:207], v247 offset:18432
  v_mfma_f32_16x16x32_bf16 v[20:23], v[68:71], v[100:103], 0
  buffer_load_dwordx4 v236, s[40:43], s13 offen offset:0 lds
  v_mfma_f32_16x16x32_bf16 v[20:23], v[84:87], v[116:119], v[20:23]
  buffer_load_dwordx4 v237, s[40:43], s13 offen offset:1024 lds
  v_mfma_f32_16x16x32_bf16 v[16:19], v[84:87], v[112:115], 0
  buffer_load_dwordx4 v238, s[40:43], s13 offen offset:2048 lds
  v_mfma_f32_16x16x32_bf16 v[16:19], v[68:71], v[96:99], v[16:19]
  buffer_load_dwordx4 v239, s[40:43], s13 offen offset:3072 lds
  v_xor_b32 v236, 128, v236
  v_xor_b32 v237, 128, v237
  v_xor_b32 v238, 128, v238
  v_xor_b32 v239, 128, v239
  s_waitcnt vmcnt(16) lgkmcnt(0)
  v_mfma_f32_16x16x32_bf16 v[32:35], v[72:75], v[96:99], 0
  ds_read_b128 a[240:243], v210 offset:0
  s_add_u32 s3, s3, 4096
  v_mfma_f32_16x16x32_bf16 v[32:35], v[88:91], v[112:115], v[32:35]
  ds_read_b128 a[244:247], v210 offset:1024
  s_cmp_eq_u32 s3, s7
  v_mfma_f32_16x16x32_bf16 v[36:39], v[88:91], v[116:119], 0
  ds_read_b128 a[248:251], v210 offset:2048
  s_cselect_b32 s3, 0, s3
  v_mfma_f32_16x16x32_bf16 v[36:39], v[72:75], v[100:103], v[36:39]
  ds_read_b128 a[252:255], v210 offset:3072
  v_add_u32 v210, s3, v213
  v_mfma_f32_16x16x32_bf16 v[40:43], v[72:75], v[104:107], 0
  ds_read_b64_tr_b16 a[208:209], v244 offset:32768
  s_add_u32 s13, s13, s14
  v_mfma_f32_16x16x32_bf16 v[40:43], v[88:91], v[120:123], v[40:43]
  ds_read_b64_tr_b16 a[210:211], v244 offset:34816
  s_cmp_eq_u32 s13, s27
  v_mfma_f32_16x16x32_bf16 v[44:47], v[88:91], v[124:127], 0
  ds_read_b64_tr_b16 a[212:213], v245 offset:32768
  s_cselect_b32 s13, 0, s13
  v_mfma_f32_16x16x32_bf16 v[44:47], v[72:75], v[108:111], v[44:47]
  ds_read_b64_tr_b16 a[214:215], v245 offset:34816
  s_add_u32 m0, s64, 65536
  v_mfma_f32_16x16x32_bf16 v[60:63], v[76:79], v[108:111], 0
  ds_read_b64_tr_b16 a[216:217], v246 offset:32768
  v_mfma_f32_16x16x32_bf16 v[60:63], v[92:95], v[124:127], v[60:63]
  ds_read_b64_tr_b16 a[218:219], v246 offset:34816
  v_mfma_f32_16x16x32_bf16 v[56:59], v[92:95], v[120:123], 0
  ds_read_b64_tr_b16 a[220:221], v247 offset:32768
  v_mfma_f32_16x16x32_bf16 v[56:59], v[76:79], v[104:107], v[56:59]
  ds_read_b64_tr_b16 a[222:223], v247 offset:34816
  v_mfma_f32_16x16x32_bf16 v[52:55], v[76:79], v[100:103], 0
  buffer_load_dwordx4 v236, s[40:43], s13 offen offset:0 lds
  v_mfma_f32_16x16x32_bf16 v[52:55], v[92:95], v[116:119], v[52:55]
  buffer_load_dwordx4 v237, s[40:43], s13 offen offset:1024 lds
  v_mfma_f32_16x16x32_bf16 v[48:51], v[92:95], v[112:115], 0
  buffer_load_dwordx4 v238, s[40:43], s13 offen offset:2048 lds
  v_mfma_f32_16x16x32_bf16 v[48:51], v[76:79], v[96:99], v[48:51]
  buffer_load_dwordx4 v239, s[40:43], s13 offen offset:3072 lds
  s_mov_b32 s10, 2
  s_call_b64 s[8:9], L_gemm2
  s_nop 5
  s_add_u32 s94, s65, 0
  s_add_u32 s95, s94, 4096
.p2align 3
  v_cvt_pk_bf16_f32 v128, v0, v1
  v_cvt_pk_bf16_f32 v129, v2, v3
  v_cvt_pk_bf16_f32 v130, v16, v17
  v_cvt_pk_bf16_f32 v131, v18, v19
  v_cvt_pk_bf16_f32 v132, v4, v5
  v_cvt_pk_bf16_f32 v133, v6, v7
  v_cvt_pk_bf16_f32 v134, v20, v21
  v_cvt_pk_bf16_f32 v135, v22, v23
  v_cvt_pk_bf16_f32 v136, v8, v9
  v_cvt_pk_bf16_f32 v137, v10, v11
  v_cvt_pk_bf16_f32 v138, v24, v25
  v_cvt_pk_bf16_f32 v139, v26, v27
  v_cvt_pk_bf16_f32 v140, v12, v13
  v_cvt_pk_bf16_f32 v141, v14, v15
  v_cvt_pk_bf16_f32 v142, v28, v29
  v_cvt_pk_bf16_f32 v143, v30, v31
  v_cvt_pk_bf16_f32 v144, v32, v33
  v_cvt_pk_bf16_f32 v145, v34, v35
  v_cvt_pk_bf16_f32 v146, v48, v49
  v_cvt_pk_bf16_f32 v147, v50, v51
  v_cvt_pk_bf16_f32 v148, v36, v37
  v_cvt_pk_bf16_f32 v149, v38, v39
  v_cvt_pk_bf16_f32 v150, v52, v53
  v_cvt_pk_bf16_f32 v151, v54, v55
  v_cvt_pk_bf16_f32 v152, v40, v41
  v_cvt_pk_bf16_f32 v153, v42, v43
  v_cvt_pk_bf16_f32 v154, v56, v57
  v_cvt_pk_bf16_f32 v155, v58, v59
  v_cvt_pk_bf16_f32 v156, v44, v45
  v_cvt_pk_bf16_f32 v157, v46, v47
  v_cvt_pk_bf16_f32 v158, v60, v61
  v_cvt_pk_bf16_f32 v159, v62, v63
  s_waitcnt vmcnt(16) lgkmcnt(0)
  v_mfma_f32_16x16x32_bf16 v[0:3], v[64:67], v[96:99], 0
  ds_read_b128 a[224:227], v210 offset:0
  s_add_u32 s3, s3, 4096
  v_mfma_f32_16x16x32_bf16 v[0:3], v[80:83], v[112:115], v[0:3]
  ds_read_b128 a[228:231], v210 offset:1024
  s_cmp_eq_u32 s3, s7
  v_mfma_f32_16x16x32_bf16 v[4:7], v[80:83], v[116:119], 0
  ds_read_b128 a[232:235], v210 offset:2048
  s_cselect_b32 s3, 0, s3
  v_mfma_f32_16x16x32_bf16 v[4:7], v[64:67], v[100:103], v[4:7]
  ds_read_b128 a[236:239], v210 offset:3072
  v_add_u32 v210, s3, v213
  v_mfma_f32_16x16x32_bf16 v[8:11], v[64:67], v[104:107], 0
  ds_read_b64_tr_b16 a[192:193], v240 offset:0
  s_add_u32 s13, s13, s14
  v_mfma_f32_16x16x32_bf16 v[8:11], v[80:83], v[120:123], v[8:11]
  ds_read_b64_tr_b16 a[194:195], v240 offset:2048
  s_cmp_eq_u32 s13, s27
  v_mfma_f32_16x16x32_bf16 v[12:15], v[80:83], v[124:127], 0
  ds_read_b64_tr_b16 a[196:197], v241 offset:0
  s_cselect_b32 s13, 0, s13
  v_mfma_f32_16x16x32_bf16 v[12:15], v[64:67], v[108:111], v[12:15]
  ds_read_b64_tr_b16 a[198:199], v241 offset:2048
  s_add_u32 m0, s64, 81920
  v_mfma_f32_16x16x32_bf16 v[28:31], v[68:71], v[108:111], 0
  ds_read_b64_tr_b16 a[200:201], v242 offset:0
  v_mfma_f32_16x16x32_bf16 v[28:31], v[84:87], v[124:127], v[28:31]
  ds_read_b64_tr_b16 a[202:203], v242 offset:2048
  v_mfma_f32_16x16x32_bf16 v[24:27], v[84:87], v[120:123], 0
  ds_read_b64_tr_b16 a[204:205], v243 offset:0
  v_mfma_f32_16x16x32_bf16 v[24:27], v[68:71], v[104:107], v[24:27]
  ds_read_b64_tr_b16 a[206:207], v243 offset:2048
  v_mfma_f32_16x16x32_bf16 v[20:23], v[68:71], v[100:103], 0
  buffer_load_dwordx4 v236, s[40:43], s13 offen offset:0 lds
  v_mfma_f32_16x16x32_bf16 v[20:23], v[84:87], v[116:119], v[20:23]
  buffer_load_dwordx4 v237, s[40:43], s13 offen offset:1024 lds
  v_mfma_f32_16x16x32_bf16 v[16:19], v[84:87], v[112:115], 0
  buffer_load_dwordx4 v238, s[40:43], s13 offen offset:2048 lds
  v_mfma_f32_16x16x32_bf16 v[16:19], v[68:71], v[96:99], v[16:19]
  buffer_load_dwordx4 v239, s[40:43], s13 offen offset:3072 lds
  s_waitcnt vmcnt(16) lgkmcnt(0)
  v_mfma_f32_16x16x32_bf16 v[32:35], v[72:75], v[96:99], 0
  ds_read_b128 a[240:243], v210 offset:0
  s_add_u32 s3, s3, 4096
  v_mfma_f32_16x16x32_bf16 v[32:35], v[88:91], v[112:115], v[32:35]
  ds_read_b128 a[244:247], v210 offset:1024
  s_cmp_eq_u32 s3, s7
  v_mfma_f32_16x16x32_bf16 v[36:39], v[88:91], v[116:119], 0
  ds_read_b128 a[248:251], v210 offset:2048
  s_cselect_b32 s3, 0, s3
  v_mfma_f32_16x16x32_bf16 v[36:39], v[72:75], v[100:103], v[36:39]
  ds_read_b128 a[252:255], v210 offset:3072
  v_add_u32 v210, s3, v213
  v_mfma_f32_16x16x32_bf16 v[40:43], v[72:75], v[104:107], 0
  ds_read_b64_tr_b16 a[208:209], v240 offset:16384
  v_mfma_f32_16x16x32_bf16 v[40:43], v[88:91], v[120:123], v[40:43]
  ds_read_b64_tr_b16 a[210:211], v240 offset:18432
  v_mfma_f32_16x16x32_bf16 v[44:47], v[88:91], v[124:127], 0
  ds_read_b64_tr_b16 a[212:213], v241 offset:16384
  v_mfma_f32_16x16x32_bf16 v[44:47], v[72:75], v[108:111], v[44:47]
  ds_read_b64_tr_b16 a[214:215], v241 offset:18432
  v_mfma_f32_16x16x32_bf16 v[60:63], v[76:79], v[108:111], 0
  ds_read_b64_tr_b16 a[216:217], v242 offset:16384
  v_mfma_f32_16x16x32_bf16 v[60:63], v[92:95], v[124:127], v[60:63]
  ds_read_b64_tr_b16 a[218:219], v242 offset:18432
  v_mfma_f32_16x16x32_bf16 v[56:59], v[92:95], v[120:123], 0
  ds_read_b64_tr_b16 a[220:221], v243 offset:16384
  s_add_u32 m0, s63, 32768
  v_mfma_f32_16x16x32_bf16 v[56:59], v[76:79], v[104:107], v[56:59]
  ds_read_b64_tr_b16 a[222:223], v243 offset:18432
  v_mfma_f32_16x16x32_bf16 v[52:55], v[76:79], v[100:103], 0
  buffer_load_dwordx4 v228, s[44:47], s60 offen offset:0 lds
  v_mfma_f32_16x16x32_bf16 v[52:55], v[92:95], v[116:119], v[52:55]
  buffer_load_dwordx4 v229, s[44:47], s60 offen offset:1024 lds
  v_mfma_f32_16x16x32_bf16 v[48:51], v[92:95], v[112:115], 0
  buffer_load_dwordx4 v230, s[44:47], s60 offen offset:2048 lds
  v_mfma_f32_16x16x32_bf16 v[48:51], v[76:79], v[96:99], v[48:51]
  buffer_load_dwordx4 v231, s[44:47], s60 offen offset:3072 lds
  s_add_u32 s60, s60, 16384
  s_waitcnt vmcnt(16) lgkmcnt(0)
  v_mfma_f32_16x16x32_bf16 v[0:3], a[192:195], a[224:227], v[0:3]
  ds_read_b128 v[96:99], v210 offset:0
  s_add_u32 s3, s3, 4096
  v_mfma_f32_16x16x32_bf16 v[0:3], a[208:211], a[240:243], v[0:3]
  ds_read_b128 v[100:103], v210 offset:1024
  s_cmp_eq_u32 s3, s7
  v_mfma_f32_16x16x32_bf16 v[4:7], a[208:211], a[244:247], v[4:7]
  ds_read_b128 v[104:107], v210 offset:2048
  s_cselect_b32 s3, 0, s3
  v_mfma_f32_16x16x32_bf16 v[4:7], a[192:195], a[228:231], v[4:7]
  ds_read_b128 v[108:111], v210 offset:3072
  v_add_u32 v210, s3, v213
  v_mfma_f32_16x16x32_bf16 v[8:11], a[192:195], a[232:235], v[8:11]
  ds_read_b64_tr_b16 v[64:65], v240 offset:32768
  v_mfma_f32_16x16x32_bf16 v[8:11], a[208:211], a[248:251], v[8:11]
  ds_read_b64_tr_b16 v[66:67], v240 offset:34816
  v_mfma_f32_16x16x32_bf16 v[12:15], a[208:211], a[252:255], v[12:15]
  ds_read_b64_tr_b16 v[68:69], v241 offset:32768
  v_mfma_f32_16x16x32_bf16 v[12:15], a[192:195], a[236:239], v[12:15]
  ds_read_b64_tr_b16 v[70:71], v241 offset:34816
  v_mfma_f32_16x16x32_bf16 v[28:31], a[196:199], a[236:239], v[28:31]
  ds_read_b64_tr_b16 v[72:73], v242 offset:32768
  v_mfma_f32_16x16x32_bf16 v[28:31], a[212:215], a[252:255], v[28:31]
  ds_read_b64_tr_b16 v[74:75], v242 offset:34816
  v_mfma_f32_16x16x32_bf16 v[24:27], a[212:215], a[248:251], v[24:27]
  ds_read_b64_tr_b16 v[76:77], v243 offset:32768
  s_add_u32 m0, s63, 49152
  v_mfma_f32_16x16x32_bf16 v[24:27], a[196:199], a[232:235], v[24:27]
  ds_read_b64_tr_b16 v[78:79], v243 offset:34816
  v_mfma_f32_16x16x32_bf16 v[20:23], a[196:199], a[228:231], v[20:23]
  buffer_load_dwordx4 v228, s[44:47], s60 offen offset:0 lds
  v_mfma_f32_16x16x32_bf16 v[20:23], a[212:215], a[244:247], v[20:23]
  buffer_load_dwordx4 v229, s[44:47], s60 offen offset:1024 lds
  v_mfma_f32_16x16x32_bf16 v[16:19], a[212:215], a[240:243], v[16:19]
  buffer_load_dwordx4 v230, s[44:47], s60 offen offset:2048 lds
  v_mfma_f32_16x16x32_bf16 v[16:19], a[196:199], a[224:227], v[16:19]
  buffer_load_dwordx4 v231, s[44:47], s60 offen offset:3072 lds
  s_add_u32 s60, s60, 16384
  s_waitcnt vmcnt(16) lgkmcnt(0)
  v_mfma_f32_16x16x32_bf16 v[32:35], a[200:203], a[224:227], v[32:35]
  ds_read_b128 v[112:115], v210 offset:0
  s_add_u32 s3, s3, 4096
  v_mfma_f32_16x16x32_bf16 v[32:35], a[216:219], a[240:243], v[32:35]
  ds_read_b128 v[116:119], v210 offset:1024
  s_cmp_eq_u32 s3, s7
  v_mfma_f32_16x16x32_bf16 v[36:39], a[216:219], a[244:247], v[36:39]
  ds_read_b128 v[120:123], v210 offset:2048
  s_cselect_b32 s3, 0, s3
  v_mfma_f32_16x16x32_bf16 v[36:39], a[200:203], a[228:231], v[36:39]
  ds_read_b128 v[124:127], v210 offset:3072
  v_add_u32 v210, s3, v213
  v_mfma_f32_16x16x32_bf16 v[40:43], a[200:203], a[232:235], v[40:43]
  ds_read_b64_tr_b16 v[80:81], v244 offset:0
  v_mfma_f32_16x16x32_bf16 v[40:43], a[216:219], a[248:251], v[40:43]
  ds_read_b64_tr_b16 v[82:83], v244 offset:2048
  v_mfma_f32_16x16x32_bf16 v[44:47], a[216:219], a[252:255], v[44:47]
  ds_read_b64_tr_b16 v[84:85], v245 offset:0
  v_mfma_f32_16x16x32_bf16 v[44:47], a[200:203], a[236:239], v[44:47]
  ds_read_b64_tr_b16 v[86:87], v245 offset:2048
  v_mfma_f32_16x16x32_bf16 v[60:63], a[204:207], a[236:239], v[60:63]
  ds_read_b64_tr_b16 v[88:89], v246 offset:0
  v_mfma_f32_16x16x32_bf16 v[60:63], a[220:223], a[252:255], v[60:63]
  ds_read_b64_tr_b16 v[90:91], v246 offset:2048
  v_mfma_f32_16x16x32_bf16 v[56:59], a[220:223], a[248:251], v[56:59]
  ds_read_b64_tr_b16 v[92:93], v247 offset:0
  s_add_u32 m0, s64, 0
  v_mfma_f32_16x16x32_bf16 v[56:59], a[204:207], a[232:235], v[56:59]
  ds_read_b64_tr_b16 v[94:95], v247 offset:2048
  v_mfma_f32_16x16x32_bf16 v[52:55], a[204:207], a[228:231], v[52:55]
  buffer_load_dwordx4 v232, s[48:51], s61 offen offset:0 lds
  v_mfma_f32_16x16x32_bf16 v[52:55], a[220:223], a[244:247], v[52:55]
  buffer_load_dwordx4 v233, s[48:51], s61 offen offset:1024 lds
  v_mfma_f32_16x16x32_bf16 v[48:51], a[220:223], a[240:243], v[48:51]
  buffer_load_dwordx4 v232, s[48:51], s61 offen offset:2048 lds
  v_mfma_f32_16x16x32_bf16 v[48:51], a[204:207], a[224:227], v[48:51]
  buffer_load_dwordx4 v233, s[48:51], s61 offen offset:3072 lds
  s_waitcnt vmcnt(16) lgkmcnt(0)
  v_mfma_f32_16x16x32_bf16 v[0:3], v[64:67], v[96:99], v[0:3]
  ds_read_b128 a[224:227], v210 offset:0
  s_add_u32 s3, s3, 4096
  v_mfma_f32_16x16x32_bf16 v[0:3], v[80:83], v[112:115], v[0:3]
  ds_read_b128 a[228:231], v210 offset:1024
  s_cmp_eq_u32 s3, s7
  v_mfma_f32_16x16x32_bf16 v[4:7], v[80:83], v[116:119], v[4:7]
  ds_read_b128 a[232:235], v210 offset:2048
  s_cselect_b32 s3, 0, s3
  v_mfma_f32_16x16x32_bf16 v[4:7], v[64:67], v[100:103], v[4:7]
  ds_read_b128 a[236:239], v210 offset:3072
  v_add_u32 v210, s3, v213
  v_mfma_f32_16x16x32_bf16 v[8:11], v[64:67], v[104:107], v[8:11]
  ds_read_b64_tr_b16 a[192:193], v244 offset:16384
  v_mfma_f32_16x16x32_bf16 v[8:11], v[80:83], v[120:123], v[8:11]
  ds_read_b64_tr_b16 a[194:195], v244 offset:18432
  s_add_u32 s61, s61, 16384
  v_mfma_f32_16x16x32_bf16 v[12:15], v[80:83], v[124:127], v[12:15]
  ds_read_b64_tr_b16 a[196:197], v245 offset:16384
  v_mfma_f32_16x16x32_bf16 v[12:15], v[64:67], v[108:111], v[12:15]
  ds_read_b64_tr_b16 a[198:199], v245 offset:18432
  v_mfma_f32_16x16x32_bf16 v[28:31], v[68:71], v[108:111], v[28:31]
  ds_read_b64_tr_b16 a[200:201], v246 offset:16384
  v_mfma_f32_16x16x32_bf16 v[28:31], v[84:87], v[124:127], v[28:31]
  ds_read_b64_tr_b16 a[202:203], v246 offset:18432
  v_mfma_f32_16x16x32_bf16 v[24:27], v[84:87], v[120:123], v[24:27]
  ds_read_b64_tr_b16 a[204:205], v247 offset:16384
  s_add_u32 m0, s64, 16384
  v_mfma_f32_16x16x32_bf16 v[24:27], v[68:71], v[104:107], v[24:27]
  ds_read_b64_tr_b16 a[206:207], v247 offset:18432
  v_mfma_f32_16x16x32_bf16 v[20:23], v[68:71], v[100:103], v[20:23]
  buffer_load_dwordx4 v232, s[48:51], s61 offen offset:0 lds
  v_mfma_f32_16x16x32_bf16 v[20:23], v[84:87], v[116:119], v[20:23]
  buffer_load_dwordx4 v233, s[48:51], s61 offen offset:1024 lds
  v_mfma_f32_16x16x32_bf16 v[16:19], v[84:87], v[112:115], v[16:19]
  buffer_load_dwordx4 v232, s[48:51], s61 offen offset:2048 lds
  v_mfma_f32_16x16x32_bf16 v[16:19], v[68:71], v[96:99], v[16:19]
  buffer_load_dwordx4 v233, s[48:51], s61 offen offset:3072 lds
  s_waitcnt vmcnt(16) lgkmcnt(0)
  v_mfma_f32_16x16x32_bf16 v[32:35], v[72:75], v[96:99], v[32:35]
  ds_read_b128 a[240:243], v210 offset:0
  s_add_u32 s3, s3, 4096
  v_mfma_f32_16x16x32_bf16 v[32:35], v[88:91], v[112:115], v[32:35]
  ds_read_b128 a[244:247], v210 offset:1024
  s_cmp_eq_u32 s3, s7
  v_mfma_f32_16x16x32_bf16 v[36:39], v[88:91], v[116:119], v[36:39]
  ds_read_b128 a[248:251], v210 offset:2048
  s_cselect_b32 s3, 0, s3
  v_mfma_f32_16x16x32_bf16 v[36:39], v[72:75], v[100:103], v[36:39]
  ds_read_b128 a[252:255], v210 offset:3072
  v_add_u32 v210, s3, v213
  v_mfma_f32_16x16x32_bf16 v[40:43], v[72:75], v[104:107], v[40:43]
  ds_read_b64_tr_b16 a[208:209], v244 offset:32768
  v_mfma_f32_16x16x32_bf16 v[40:43], v[88:91], v[120:123], v[40:43]
  ds_read_b64_tr_b16 a[210:211], v244 offset:34816
  v_mfma_f32_16x16x32_bf16 v[44:47], v[88:91], v[124:127], v[44:47]
  ds_read_b64_tr_b16 a[212:213], v245 offset:32768
  v_mfma_f32_16x16x32_bf16 v[44:47], v[72:75], v[108:111], v[44:47]
  ds_read_b64_tr_b16 a[214:215], v245 offset:34816
  v_mfma_f32_16x16x32_bf16 v[60:63], v[76:79], v[108:111], v[60:63]
  ds_read_b64_tr_b16 a[216:217], v246 offset:32768
  v_mfma_f32_16x16x32_bf16 v[60:63], v[92:95], v[124:127], v[60:63]
  ds_read_b64_tr_b16 a[218:219], v246 offset:34816
  v_mfma_f32_16x16x32_bf16 v[56:59], v[92:95], v[120:123], v[56:59]
  ds_read_b64_tr_b16 a[220:221], v247 offset:32768
  v_mfma_f32_16x16x32_bf16 v[56:59], v[76:79], v[104:107], v[56:59]
  ds_read_b64_tr_b16 a[222:223], v247 offset:34816
  v_mfma_f32_16x16x32_bf16 v[52:55], v[76:79], v[100:103], v[52:55]

  v_mfma_f32_16x16x32_bf16 v[52:55], v[92:95], v[116:119], v[52:55]

  v_mfma_f32_16x16x32_bf16 v[48:51], v[92:95], v[112:115], v[48:51]

  v_mfma_f32_16x16x32_bf16 v[48:51], v[76:79], v[96:99], v[48:51]

  s_waitcnt vmcnt(63) lgkmcnt(0)
  v_mfma_f32_16x16x32_bf16 v[0:3], a[192:195], a[224:227], v[0:3]
  s_add_u32 s61, s69, 32768
  v_mov_b32 v112, 0
  v_mov_b32 v113, 0
  v_mfma_f32_16x16x32_bf16 v[0:3], a[208:211], a[240:243], v[0:3]
  s_mov_b32 s40, s24
  v_mov_b32 v114, 0
  v_mov_b32 v115, 0
  v_mfma_f32_16x16x32_bf16 v[4:7], a[208:211], a[244:247], v[4:7]
  s_mov_b32 s41, s25
  v_mov_b32 v116, 0
  v_mov_b32 v117, 0
  v_mfma_f32_16x16x32_bf16 v[4:7], a[192:195], a[228:231], v[4:7]
  s_mov_b32 s42, 4194304
  v_mov_b32 v118, 0
  v_mov_b32 v119, 0
  v_mfma_f32_16x16x32_bf16 v[8:11], a[192:195], a[232:235], v[8:11]
  s_mov_b32 s70, 1024
  v_mov_b32 v120, 0
  v_mov_b32 v121, 0
  v_mfma_f32_16x16x32_bf16 v[8:11], a[208:211], a[248:251], v[8:11]
  s_mov_b32 s14, 32768
  v_mov_b32 v122, 0
  v_mov_b32 v123, 0
  v_mfma_f32_16x16x32_bf16 v[12:15], a[208:211], a[252:255], v[12:15]
  s_mov_b32 s27, 524288
  v_and_b32 v214, 3, v212
  v_cmp_eq_u32 vcc, 0, v214
  v_mfma_f32_16x16x32_bf16 v[12:15], a[192:195], a[236:239], v[12:15]
  s_mul_i32 s13, s100, 32768
  v_mov_b32 v214, 0x3f803f80
  v_cndmask_b32 v124, 0, v214, vcc
  v_mfma_f32_16x16x32_bf16 v[28:31], a[196:199], a[236:239], v[28:31]
  v_mov_b32 v125, v124
  v_mov_b32 v126, v124
  v_mfma_f32_16x16x32_bf16 v[28:31], a[212:215], a[252:255], v[28:31]
  v_mov_b32 v127, v124
  v_mad_u32_u24 v236, v208, s70, v209
  v_mfma_f32_16x16x32_bf16 v[24:27], a[212:215], a[248:251], v[24:27]
  s_lshl_b32 s70, s5, 19
  s_lshl_b32 s71, s4, 8
  s_add_u32 s70, s70, s71
  v_mfma_f32_16x16x32_bf16 v[24:27], a[196:199], a[232:235], v[24:27]
  s_add_u32 s70, s70, s67
  v_add_u32 v236, s70, v236
  v_add_u32 v237, 7168, v236
  v_mfma_f32_16x16x32_bf16 v[20:23], a[196:199], a[228:231], v[20:23]
  s_sub_u32 s13, s13, s14
  v_add_u32 v238, 14336, v236
  v_add_u32 v239, 21504, v236
  v_mfma_f32_16x16x32_bf16 v[20:23], a[212:215], a[244:247], v[20:23]
  s_mov_b32 s68, s13
  v_cvt_pk_bf16_f32 v160, v0, v1
  v_mfma_f32_16x16x32_bf16 v[16:19], a[212:215], a[240:243], v[16:19]
  v_cvt_pk_bf16_f32 v161, v2, v3
  v_mfma_f32_16x16x32_bf16 v[16:19], a[196:199], a[224:227], v[16:19]
  v_cvt_pk_bf16_f32 v164, v4, v5
  v_mfma_f32_16x16x32_bf16 v[32:35], a[200:203], a[224:227], v[32:35]
  v_cvt_pk_bf16_f32 v165, v6, v7
  v_mfma_f32_16x16x32_bf16 v[32:35], a[216:219], a[240:243], v[32:35]
  v_cvt_pk_bf16_f32 v166, v20, v21
  v_mfma_f32_16x16x32_bf16 v[36:39], a[216:219], a[244:247], v[36:39]
  v_cvt_pk_bf16_f32 v167, v22, v23
  v_mfma_f32_16x16x32_bf16 v[36:39], a[200:203], a[228:231], v[36:39]
  v_cvt_pk_bf16_f32 v162, v16, v17
  v_mfma_f32_16x16x32_bf16 v[40:43], a[200:203], a[232:235], v[40:43]
  v_cvt_pk_bf16_f32 v163, v18, v19
  v_mfma_f32_16x16x32_bf16 v[40:43], a[216:219], a[248:251], v[40:43]
  v_cvt_pk_bf16_f32 v168, v8, v9
  v_mfma_f32_16x16x32_bf16 v[44:47], a[216:219], a[252:255], v[44:47]
  v_cvt_pk_bf16_f32 v169, v10, v11
  v_mfma_f32_16x16x32_bf16 v[44:47], a[200:203], a[236:239], v[44:47]
  v_cvt_pk_bf16_f32 v170, v24, v25
  v_mfma_f32_16x16x32_bf16 v[60:63], a[204:207], a[236:239], v[60:63]
  v_cvt_pk_bf16_f32 v171, v26, v27
  v_mfma_f32_16x16x32_bf16 v[60:63], a[220:223], a[252:255], v[60:63]
  v_cvt_pk_bf16_f32 v172, v12, v13
  v_mfma_f32_16x16x32_bf16 v[56:59], a[220:223], a[248:251], v[56:59]
  v_cvt_pk_bf16_f32 v173, v14, v15
  v_mfma_f32_16x16x32_bf16 v[56:59], a[204:207], a[232:235], v[56:59]
  v_cvt_pk_bf16_f32 v174, v28, v29
  v_mfma_f32_16x16x32_bf16 v[52:55], a[204:207], a[228:231], v[52:55]
  v_cvt_pk_bf16_f32 v175, v30, v31
  v_mfma_f32_16x16x32_bf16 v[52:55], a[220:223], a[244:247], v[52:55]
  v_mfma_f32_16x16x32_bf16 v[48:51], a[220:223], a[240:243], v[48:51]
  v_mfma_f32_16x16x32_bf16 v[48:51], a[204:207], a[224:227], v[48:51]
  s_branch L_ffn2_done
L_redo:
  s_waitcnt lgkmcnt(0)
  s_mov_b32 s66, 1
  s_mov_b32 s60, s69
  s_mov_b32 s62, 32
  v_mov_b32 v214, 0xff800000
  v_mov_b32 v96, v214
  v_mov_b32 v100, v214
  v_mov_b32 v104, v214
  v_mov_b32 v108, v214
L_redo_loop:
  s_waitcnt vmcnt(0) lgkmcnt(0)
  s_barrier
  s_add_u32 m0, s63, 32768
  s_nop 0
  buffer_load_dwordx4 v228, s[44:47], s60 offen offset:0 lds
  buffer_load_dwordx4 v229, s[44:47], s60 offen offset:1024 lds
  buffer_load_dwordx4 v230, s[44:47], s60 offen offset:2048 lds
  buffer_load_dwordx4 v231, s[44:47], s60 offen offset:3072 lds
  s_add_u32 s60, s60, 16384
  s_waitcnt vmcnt(0)
  s_barrier
  ds_read_b128 a[192:195], v216 offset:32768
  ds_read_b128 a[196:199], v217 offset:32768
  ds_read_b128 a[200:203], v218 offset:32768
  ds_read_b128 a[204:207], v219 offset:32768
  ds_read_b128 a[208:211], v216 offset:36864
  ds_read_b128 a[212:215], v217 offset:36864
  ds_read_b128 a[216:219], v218 offset:36864
  ds_read_b128 a[220:223], v219 offset:36864
  s_waitcnt lgkmcnt(0)
  v_mfma_f32_16x16x32_bf16 v[0:3], a[192:195], a[128:131], 0
  v_mfma_f32_16x16x32_bf16 v[0:3], a[196:199], a[132:135], v[0:3]
  v_mfma_f32_16x16x32_bf16 v[0:3], a[200:203], a[136:139], v[0:3]
  v_mfma_f32_16x16x32_bf16 v[0:3], a[204:207], a[140:143], v[0:3]
  v_mfma_f32_16x16x32_bf16 v[4:7], a[204:207], a[156:159], 0
  v_mfma_f32_16x16x32_bf16 v[4:7], a[200:203], a[152:155], v[4:7]
  v_mfma_f32_16x16x32_bf16 v[4:7], a[196:199], a[148:151], v[4:7]
  v_mfma_f32_16x16x32_bf16 v[4:7], a[192:195], a[144:147], v[4:7]
  v_mfma_f32_16x16x32_bf16 v[8:11], a[192:195], a[160:163], 0
  v_mfma_f32_16x16x32_bf16 v[8:11], a[196:199], a[164:167], v[8:11]
  v_mfma_f32_16x16x32_bf16 v[8:11], a[200:203], a[168:171], v[8:11]
  v_mfma_f32_16x16x32_bf16 v[8:11], a[204:207], a[172:175], v[8:11]
  v_mfma_f32_16x16x32_bf16 v[12:15], a[204:207], a[188:191], 0
  v_mfma_f32_16x16x32_bf16 v[12:15], a[200:203], a[184:187], v[12:15]
  v_mfma_f32_16x16x32_bf16 v[12:15], a[196:199], a[180:183], v[12:15]
  v_mfma_f32_16x16x32_bf16 v[12:15], a[192:195], a[176:179], v[12:15]
  v_mfma_f32_16x16x32_bf16 v[28:31], a[208:211], a[176:179], 0
  v_mfma_f32_16x16x32_bf16 v[28:31], a[212:215], a[180:183], v[28:31]
  v_mfma_f32_16x16x32_bf16 v[28:31], a[216:219], a[184:187], v[28:31]
  v_mfma_f32_16x16x32_bf16 v[28:31], a[220:223], a[188:191], v[28:31]
  v_mfma_f32_16x16x32_bf16 v[24:27], a[220:223], a[172:175], 0
  v_mfma_f32_16x16x32_bf16 v[24:27], a[216:219], a[168:171], v[24:27]
  v_mfma_f32_16x16x32_bf16 v[24:27], a[212:215], a[164:167], v[24:27]
  v_mfma_f32_16x16x32_bf16 v[24:27], a[208:211], a[160:163], v[24:27]
  v_mfma_f32_16x16x32_bf16 v[20:23], a[208:211], a[144:147], 0
  v_mfma_f32_16x16x32_bf16 v[20:23], a[212:215], a[148:151], v[20:23]
  v_mfma_f32_16x16x32_bf16 v[20:23], a[216:219], a[152:155], v[20:23]
  v_mfma_f32_16x16x32_bf16 v[20:23], a[220:223], a[156:159], v[20:23]
  v_mfma_f32_16x16x32_bf16 v[16:19], a[220:223], a[140:143], 0
  v_mfma_f32_16x16x32_bf16 v[16:19], a[216:219], a[136:139], v[16:19]
  v_mfma_f32_16x16x32_bf16 v[16:19], a[212:215], a[132:135], v[16:19]
  v_mfma_f32_16x16x32_bf16 v[16:19], a[208:211], a[128:131], v[16:19]
  s_nop 7
  v_max3_f32 v96, v0, v1, v96
  v_max3_f32 v96, v2, v3, v96
  v_max3_f32 v96, v16, v17, v96
  v_max3_f32 v96, v18, v19, v96
  v_max3_f32 v100, v4, v5, v100
  v_max3_f32 v100, v6, v7, v100
  v_max3_f32 v100, v20, v21, v100
  v_max3_f32 v100, v22, v23, v100
  v_max3_f32 v104, v8, v9, v104
  v_max3_f32 v104, v10, v11, v104
  v_max3_f32 v104, v24, v25, v104
  v_max3_f32 v104, v26, v27, v104
  v_max3_f32 v108, v12, v13, v108
  v_max3_f32 v108, v14, v15, v108
  v_max3_f32 v108, v28, v29, v108
  v_max3_f32 v108, v30, v31, v108
  ds_read_b128 a[192:195], v216 offset:40960
  ds_read_b128 a[196:199], v217 offset:40960
  ds_read_b128 a[200:203], v218 offset:40960
  ds_read_b128 a[204:207], v219 offset:40960
  ds_read_b128 a[208:211], v216 offset:45056
  ds_read_b128 a[212:215], v217 offset:45056
  ds_read_b128 a[216:219], v218 offset:45056
  ds_read_b128 a[220:223], v219 offset:45056
  s_waitcnt lgkmcnt(0)
  v_mfma_f32_16x16x32_bf16 v[0:3], a[192:195], a[128:131], 0
  v_mfma_f32_16x16x32_bf16 v[0:3], a[196:199], a[132:135], v[0:3]
  v_mfma_f32_16x16x32_bf16 v[0:3], a[200:203], a[136:139], v[0:3]
  v_mfma_f32_16x16x32_bf16 v[0:3], a[204:207], a[140:143], v[0:3]
  v_mfma_f32_16x16x32_bf16 v[4:7], a[204:207], a[156:159], 0
  v_mfma_f32_16x16x32_bf16 v[4:7], a[200:203], a[152:155], v[4:7]
  v_mfma_f32_16x16x32_bf16 v[4:7], a[196:199], a[148:151], v[4:7]
  v_mfma_f32_16x16x32_bf16 v[4:7], a[192:195], a[144:147], v[4:7]
  v_mfma_f32_16x16x32_bf16 v[8:11], a[192:195], a[160:163], 0
  v_mfma_f32_16x16x32_bf16 v[8:11], a[196:199], a[164:167], v[8:11]
  v_mfma_f32_16x16x32_bf16 v[8:11], a[200:203], a[168:171], v[8:11]
  v_mfma_f32_16x16x32_bf16 v[8:11], a[204:207], a[172:175], v[8:11]
  v_mfma_f32_16x16x32_bf16 v[12:15], a[204:207], a[188:191], 0
  v_mfma_f32_16x16x32_bf16 v[12:15], a[200:203], a[184:187], v[12:15]
  v_mfma_f32_16x16x32_bf16 v[12:15], a[196:199], a[180:183], v[12:15]
  v_mfma_f32_16x16x32_bf16 v[12:15], a[192:195], a[176:179], v[12:15]
  v_mfma_f32_16x16x32_bf16 v[28:31], a[208:211], a[176:179], 0
  v_mfma_f32_16x16x32_bf16 v[28:31], a[212:215], a[180:183], v[28:31]
  v_mfma_f32_16x16x32_bf16 v[28:31], a[216:219], a[184:187], v[28:31]
  v_mfma_f32_16x16x32_bf16 v[28:31], a[220:223], a[188:191], v[28:31]
  v_mfma_f32_16x16x32_bf16 v[24:27], a[220:223], a[172:175], 0
  v_mfma_f32_16x16x32_bf16 v[24:27], a[216:219], a[168:171], v[24:27]
  v_mfma_f32_16x16x32_bf16 v[24:27], a[212:215], a[164:167], v[24:27]
  v_mfma_f32_16x16x32_bf16 v[24:27], a[208:211], a[160:163], v[24:27]
  v_mfma_f32_16x16x32_bf16 v[20:23], a[208:211], a[144:147], 0
  v_mfma_f32_16x16x32_bf16 v[20:23], a[212:215], a[148:151], v[20:23]
  v_mfma_f32_16x16x32_bf16 v[20:23], a[216:219], a[152:155], v[20:23]
  v_mfma_f32_16x16x32_bf16 v[20:23], a[220:223], a[156:159], v[20:23]
  v_mfma_f32_16x16x32_bf16 v[16:19], a[220:223], a[140:143], 0
  v_mfma_f32_16x16x32_bf16 v[16:19], a[216:219], a[136:139], v[16:19]
  v_mfma_f32_16x16x32_bf16 v[16:19], a[212:215], a[132:135], v[16:19]
  v_mfma_f32_16x16x32_bf16 v[16:19], a[208:211], a[128:131], v[16:19]
  s_nop 7
  v_max3_f32 v96, v0, v1, v96
  v_max3_f32 v96, v2, v3, v96
  v_max3_f32 v96, v16, v17, v96
  v_max3_f32 v96, v18, v19, v96
  v_max3_f32 v100, v4, v5, v100
  v_max3_f32 v100, v6, v7, v100
  v_max3_f32 v100, v20, v21, v100
  v_max3_f32 v100, v22, v23, v100
  v_max3_f32 v104, v8, v9, v104
  v_max3_f32 v104, v10, v11, v104
  v_max3_f32 v104, v24, v25, v104
  v_max3_f32 v104, v26, v27, v104
  v_max3_f32 v108, v12, v13, v108
  v_max3_f32 v108, v14, v15, v108
  v_max3_f32 v108, v28, v29, v108
  v_max3_f32 v108, v30, v31, v108
  s_sub_u32 s62, s62, 1
  s_cmp_lg_u32 s62, 0
  s_cbranch_scc1 L_redo_loop
  v_mov_b32 v97, v96
  s_nop 1
  v_permlane32_swap_b32 v96, v97
  v_max_f32 v96, v96, v97
  v_mov_b32 v97, v96
  s_nop 1
  v_permlane16_swap_b32 v96, v97
  v_max_f32 v96, v96, v97
  v_xor_b32 v96, 0x80000000, v96
  v_mov_b32 v97, v96
  v_mov_b32 v98, v96
  v_mov_b32 v99, v96
  v_mov_b32 v101, v100
  s_nop 1
  v_permlane32_swap_b32 v100, v101
  v_max_f32 v100, v100, v101
  v_mov_b32 v101, v100
  s_nop 1
  v_permlane16_swap_b32 v100, v101
  v_max_f32 v100, v100, v101
  v_xor_b32 v100, 0x80000000, v100
  v_mov_b32 v101, v100
  v_mov_b32 v102, v100
  v_mov_b32 v103, v100
  v_mov_b32 v105, v104
  s_nop 1
  v_permlane32_swap_b32 v104, v105
  v_max_f32 v104, v104, v105
  v_mov_b32 v105, v104
  s_nop 1
  v_permlane16_swap_b32 v104, v105
  v_max_f32 v104, v104, v105
  v_xor_b32 v104, 0x80000000, v104
  v_mov_b32 v105, v104
  v_mov_b32 v106, v104
  v_mov_b32 v107, v104
  v_mov_b32 v109, v108
  s_nop 1
  v_permlane32_swap_b32 v108, v109
  v_max_f32 v108, v108, v109
  v_mov_b32 v109, v108
  s_nop 1
  v_permlane16_swap_b32 v108, v109
  v_max_f32 v108, v108, v109
  v_xor_b32 v108, 0x80000000, v108
  v_mov_b32 v109, v108
  v_mov_b32 v110, v108
  v_mov_b32 v111, v108
  s_barrier
  s_mov_b32 s60, s69
  s_mov_b32 s61, s69
  s_add_u32 m0, s63, 32768
  s_nop 0
  buffer_load_dwordx4 v228, s[44:47], s60 offen offset:0 lds
  buffer_load_dwordx4 v229, s[44:47], s60 offen offset:1024 lds
  buffer_load_dwordx4 v230, s[44:47], s60 offen offset:2048 lds
  buffer_load_dwordx4 v231, s[44:47], s60 offen offset:3072 lds
  s_add_u32 s60, s60, 16384
  s_add_u32 m0, s63, 49152
  s_nop 0
  buffer_load_dwordx4 v228, s[44:47], s60 offen offset:0 lds
  buffer_load_dwordx4 v229, s[44:47], s60 offen offset:1024 lds
  buffer_load_dwordx4 v230, s[44:47], s60 offen offset:2048 lds
  buffer_load_dwordx4 v231, s[44:47], s60 offen offset:3072 lds
  s_add_u32 s60, s60, 16384
  s_add_u32 m0, s63, 0
  s_nop 0
  buffer_load_dwordx4 v228, s[44:47], s60 offen offset:0 lds
  buffer_load_dwordx4 v229, s[44:47], s60 offen offset:1024 lds
  buffer_load_dwordx4 v230, s[44:47], s60 offen offset:2048 lds
  buffer_load_dwordx4 v231, s[44:47], s60 offen offset:3072 lds
  s_add_u32 s60, s60, 16384
  s_add_u32 m0, s63, 16384
  s_nop 0
  buffer_load_dwordx4 v228, s[44:47], s60 offen offset:0 lds
  buffer_load_dwordx4 v229, s[44:47], s60 offen offset:1024 lds
  buffer_load_dwordx4 v230, s[44:47], s60 offen offset:2048 lds
  buffer_load_dwordx4 v231, s[44:47], s60 offen offset:3072 lds
  s_add_u32 s60, s60, 16384
  s_add_u32 m0, s64, 0
  s_nop 0
  buffer_load_dwordx4 v232, s[48:51], s61 offen offset:0 lds
  buffer_load_dwordx4 v233, s[48:51], s61 offen offset:1024 lds
  buffer_load_dwordx4 v232, s[48:51], s61 offen offset:2048 lds
  buffer_load_dwordx4 v233, s[48:51], s61 offen offset:3072 lds
  s_add_u32 s61, s61, 16384
  s_add_u32 m0, s64, 16384
  s_nop 0
  buffer_load_dwordx4 v232, s[48:51], s61 offen offset:0 lds
  buffer_load_dwordx4 v233, s[48:51], s61 offen offset:1024 lds
  buffer_load_dwordx4 v232, s[48:51], s61 offen offset:2048 lds
  buffer_load_dwordx4 v233, s[48:51], s61 offen offset:3072 lds
  s_add_u32 s61, s61, 16384
  s_mov_b32 s13, s68
  s_waitcnt vmcnt(0)
  s_barrier
  v_mov_b32 v204, 0
  v_mov_b32 v205, 0
  v_mov_b32 v206, 0
  v_mov_b32 v207, 0
  s_nop 1
  v_mfma_f32_32x32x16_bf16 a[0:15], v[204:207], v[204:207], 0
  v_mfma_f32_32x32x16_bf16 a[16:31], v[204:207], v[204:207], 0
  v_mfma_f32_32x32x16_bf16 a[32:47], v[204:207], v[204:207], 0
  v_mfma_f32_32x32x16_bf16 a[48:63], v[204:207], v[204:207], 0
  v_mfma_f32_32x32x16_bf16 a[64:79], v[204:207], v[204:207], 0
  v_mfma_f32_32x32x16_bf16 a[80:95], v[204:207], v[204:207], 0
  v_mfma_f32_32x32x16_bf16 a[96:111], v[204:207], v[204:207], 0
  v_mfma_f32_32x32x16_bf16 a[112:127], v[204:207], v[204:207], 0
  s_add_u32 s61, s69, 32768
  v_mov_b32 v112, 0
  v_mov_b32 v113, 0
  v_mov_b32 v114, 0
  v_mov_b32 v115, 0
  v_mov_b32 v116, 0
  v_mov_b32 v117, 0
  v_mov_b32 v118, 0
  v_mov_b32 v119, 0
  v_mov_b32 v120, 0
  v_mov_b32 v121, 0
  v_mov_b32 v122, 0
  v_mov_b32 v123, 0
  v_and_b32 v214, 3, v212
  v_cmp_eq_u32 vcc, 0, v214
  v_mov_b32 v214, 0x3f803f80
  s_nop 0
  v_cndmask_b32 v124, 0, v214, vcc
  v_mov_b32 v125, v124
  v_mov_b32 v126, v124
  v_mov_b32 v127, v124
  ds_read_b128 a[192:195], v216 offset:32768
  ds_read_b128 a[196:199], v217 offset:32768
  ds_read_b128 a[200:203], v218 offset:32768
  ds_read_b128 a[204:207], v219 offset:32768
  ds_read_b128 a[208:211], v216 offset:36864
  ds_read_b128 a[212:215], v217 offset:36864
  ds_read_b128 a[216:219], v218 offset:36864
  ds_read_b128 a[220:223], v219 offset:36864
  ds_read_b128 a[224:227], v216 offset:40960
  ds_read_b128 a[228:231], v217 offset:40960
  ds_read_b128 a[232:235], v218 offset:40960
  ds_read_b128 a[236:239], v219 offset:40960
  s_waitcnt lgkmcnt(11)
  v_mfma_f32_16x16x32_bf16 v[0:3], a[192:195], a[128:131], v[96:99]
  ds_read_b128 a[240:243], v216 offset:45056
  s_add_u32 m0, s63, 32768
  s_waitcnt lgkmcnt(10)
  v_mfma_f32_16x16x32_bf16 v[0:3], a[196:199], a[132:135], v[0:3]
  ds_read_b128 a[244:247], v217 offset:45056
  v_mfma_f32_16x16x32_bf16 v[0:3], a[200:203], a[136:139], v[0:3]
  ds_read_b128 a[248:251], v218 offset:45056
  s_waitcnt lgkmcnt(10)
  v_mfma_f32_16x16x32_bf16 v[0:3], a[204:207], a[140:143], v[0:3]
  ds_read_b128 a[252:255], v219 offset:45056
  v_mfma_f32_16x16x32_bf16 v[4:7], a[192:195], a[144:147], v[100:103]
  s_nop 2
  s_waitcnt lgkmcnt(8)
  v_mfma_f32_16x16x32_bf16 v[16:19], a[220:223], a[140:143], v[96:99]
  v_mfma_f32_16x16x32_bf16 v[16:19], a[216:219], a[136:139], v[16:19]
  v_exp_f32 v0, v0
  v_mfma_f32_16x16x32_bf16 v[16:19], a[212:215], a[132:135], v[16:19]
  v_add_f32 v112, v112, v0
  v_mfma_f32_16x16x32_bf16 v[16:19], a[208:211], a[128:131], v[16:19]
  v_exp_f32 v1, v1
  v_mfma_f32_16x16x32_bf16 v[4:7], a[196:199], a[148:151], v[4:7]
  v_add_f32 v112, v112, v1
  v_cvt_pk_bf16_f32 v64, v0, v1
  v_mfma_f32_16x16x32_bf16 v[4:7], a[200:203], a[152:155], v[4:7]
  v_exp_f32 v2, v2
  v_mfma_f32_16x16x32_bf16 v[4:7], a[204:207], a[156:159], v[4:7]
  v_add_f32 v112, v112, v2
  v_mfma_f32_16x16x32_bf16 v[20:23], a[220:223], a[156:159], v[100:103]
  s_waitcnt lgkmcnt(0)
  s_barrier
  v_exp_f32 v3, v3
  v_mfma_f32_16x16x32_bf16 v[20:23], a[216:219], a[152:155], v[20:23]
  buffer_load_dwordx4 v228, s[44:47], s60 offen offset:0 lds
  v_mfma_f32_16x16x32_bf16 v[20:23], a[212:215], a[148:151], v[20:23]
  v_add_f32 v112, v112, v3
  v_cvt_pk_bf16_f32 v65, v2, v3
  v_mfma_f32_16x16x32_bf16 v[20:23], a[208:211], a[144:147], v[20:23]
  v_exp_f32 v16, v16
  v_mfma_f32_16x16x32_bf16 v[8:11], a[192:195], a[160:163], v[104:107]
  v_add_f32 v112, v112, v16
  v_mfma_f32_16x16x32_bf16 v[8:11], a[196:199], a[164:167], v[8:11]
  buffer_load_dwordx4 v229, s[44:47], s60 offen offset:1024 lds
  v_mfma_f32_16x16x32_bf16 v[8:11], a[200:203], a[168:171], v[8:11]
  v_exp_f32 v17, v17
  v_mfma_f32_16x16x32_bf16 v[8:11], a[204:207], a[172:175], v[8:11]
  v_add_f32 v112, v112, v17
  v_cvt_pk_bf16_f32 v66, v16, v17
  v_mfma_f32_16x16x32_bf16 v[24:27], a[220:223], a[172:175], v[104:107]
  v_exp_f32 v18, v18
  v_mfma_f32_16x16x32_bf16 v[24:27], a[216:219], a[168:171], v[24:27]
  buffer_load_dwordx4 v230, s[44:47], s60 offen offset:2048 lds
  v_mfma_f32_16x16x32_bf16 v[24:27], a[212:215], a[164:167], v[24:27]
  v_add_f32 v112, v112, v18
  v_mfma_f32_16x16x32_bf16 v[24:27], a[208:211], a[160:163], v[24:27]
  v_exp_f32 v19, v19
  v_mfma_f32_16x16x32_bf16 v[12:15], a[192:195], a[176:179], v[108:111]
  ds_read_b128 a[192:195], v216 offset:49152
  v_add_f32 v112, v112, v19
  v_mfma_f32_16x16x32_bf16 v[12:15], a[196:199], a[180:183], v[12:15]
  ds_read_b128 a[196:199], v217 offset:49152
  v_cvt_pk_bf16_f32 v67, v18, v19
  v_mfma_f32_16x16x32_bf16 v[12:15], a[200:203], a[184:187], v[12:15]
  ds_read_b128 a[200:203], v218 offset:49152
  v_mfma_f32_16x16x32_bf16 v[12:15], a[204:207], a[188:191], v[12:15]
  ds_read_b128 a[204:207], v219 offset:49152
  v_mfma_f32_16x16x32_bf16 v[28:31], a[220:223], a[188:191], v[108:111]
  buffer_load_dwordx4 v231, s[44:47], s60 offen offset:3072 lds
  v_mfma_f32_16x16x32_bf16 v[28:31], a[216:219], a[184:187], v[28:31]
  s_add_u32 s60, s60, 16384
  v_exp_f32 v4, v4
  v_mfma_f32_16x16x32_bf16 v[28:31], a[212:215], a[180:183], v[28:31]
  v_add_f32 v113, v113, v4
  v_mfma_f32_16x16x32_bf16 v[28:31], a[208:211], a[176:179], v[28:31]
  ds_read_b128 a[208:211], v216 offset:53248
  v_mfma_f32_16x16x32_bf16 v[32:35], a[224:227], a[128:131], v[96:99]
  ds_read_b128 a[212:215], v217 offset:53248
  v_mfma_f32_16x16x32_bf16 v[32:35], a[228:231], a[132:135], v[32:35]
  ds_read_b128 a[216:219], v218 offset:53248
  v_mfma_f32_16x16x32_bf16 v[32:35], a[232:235], a[136:139], v[32:35]
  ds_read_b128 a[220:223], v219 offset:53248
  v_mfma_f32_16x16x32_bf16 v[32:35], a[236:239], a[140:143], v[32:35]
  v_exp_f32 v5, v5
  v_mfma_f32_16x16x32_bf16 v[48:51], a[252:255], a[140:143], v[96:99]
  v_add_f32 v113, v113, v5
  v_cvt_pk_bf16_f32 v68, v4, v5
  v_mfma_f32_16x16x32_bf16 v[48:51], a[248:251], a[136:139], v[48:51]
  v_exp_f32 v6, v6
  v_mfma_f32_16x16x32_bf16 v[48:51], a[244:247], a[132:135], v[48:51]
  v_add_f32 v113, v113, v6
  v_mfma_f32_16x16x32_bf16 v[48:51], a[240:243], a[128:131], v[48:51]
  v_exp_f32 v7, v7
  v_mfma_f32_16x16x32_bf16 v[36:39], a[224:227], a[144:147], v[100:103]
  v_add_f32 v113, v113, v7
  v_cvt_pk_bf16_f32 v69, v6, v7
  v_mfma_f32_16x16x32_bf16 v[36:39], a[228:231], a[148:151], v[36:39]
  v_exp_f32 v20, v20
  v_mfma_f32_16x16x32_bf16 v[36:39], a[232:235], a[152:155], v[36:39]
  s_add_u32 m0, s64, 32768
  v_add_f32 v113, v113, v20
  v_mfma_f32_16x16x32_bf16 v[36:39], a[236:239], a[156:159], v[36:39]
  buffer_load_dwordx4 v232, s[48:51], s61 offen offset:0 lds
  v_mfma_f32_16x16x32_bf16 v[52:55], a[252:255], a[156:159], v[100:103]
  v_exp_f32 v21, v21
  v_mfma_f32_16x16x32_bf16 v[52:55], a[248:251], a[152:155], v[52:55]
  v_add_f32 v113, v113, v21
  v_cvt_pk_bf16_f32 v70, v20, v21
  v_mfma_f32_16x16x32_bf16 v[52:55], a[244:247], a[148:151], v[52:55]
  v_exp_f32 v22, v22
  v_mfma_f32_16x16x32_bf16 v[52:55], a[240:243], a[144:147], v[52:55]
  buffer_load_dwordx4 v233, s[48:51], s61 offen offset:1024 lds
  v_mfma_f32_16x16x32_bf16 v[40:43], a[224:227], a[160:163], v[104:107]
  v_add_f32 v113, v113, v22
  v_mfma_f32_16x16x32_bf16 v[40:43], a[228:231], a[164:167], v[40:43]
  v_exp_f32 v23, v23
  v_mfma_f32_16x16x32_bf16 v[40:43], a[232:235], a[168:171], v[40:43]
  v_add_f32 v113, v113, v23
  v_cvt_pk_bf16_f32 v71, v22, v23
  v_mfma_f32_16x16x32_bf16 v[40:43], a[236:239], a[172:175], v[40:43]
  buffer_load_dwordx4 v232, s[48:51], s61 offen offset:2048 lds
  v_mfma_f32_16x16x32_bf16 v[56:59], a[252:255], a[172:175], v[104:107]
  v_exp_f32 v8, v8
  v_mfma_f32_16x16x32_bf16 v[56:59], a[248:251], a[168:171], v[56:59]
  v_exp_f32 v9, v9
  v_mfma_f32_16x16x32_bf16 v[56:59], a[244:247], a[164:167], v[56:59]
  v_cvt_pk_bf16_f32 v72, v8, v9
  v_mfma_f32_16x16x32_bf16 v[56:59], a[240:243], a[160:163], v[56:59]
  buffer_load_dwordx4 v233, s[48:51], s61 offen offset:3072 lds
  v_mfma_f32_16x16x32_bf16 v[44:47], a[224:227], a[176:179], v[108:111]
  s_add_u32 s61, s61, 16384
  v_exp_f32 v10, v10
  v_mfma_f32_16x16x32_bf16 v[44:47], a[228:231], a[180:183], v[44:47]
  v_exp_f32 v11, v11
  v_mfma_f32_16x16x32_bf16 v[44:47], a[232:235], a[184:187], v[44:47]
  v_cvt_pk_bf16_f32 v73, v10, v11
  v_mfma_f32_16x16x32_bf16 v[44:47], a[236:239], a[188:191], v[44:47]
  v_exp_f32 v24, v24
  v_mfma_f32_16x16x32_bf16 v[60:63], a[252:255], a[188:191], v[108:111]
  v_exp_f32 v25, v25
  v_mfma_f32_16x16x32_bf16 v[60:63], a[248:251], a[184:187], v[60:63]
  v_cvt_pk_bf16_f32 v74, v24, v25
  v_mfma_f32_16x16x32_bf16 v[60:63], a[244:247], a[180:183], v[60:63]
  v_exp_f32 v26, v26
  v_mfma_f32_16x16x32_bf16 v[60:63], a[240:243], a[176:179], v[60:63]
  v_exp_f32 v27, v27
  s_waitcnt lgkmcnt(0)
  v_mfma_f32_16x16x32_bf16 v[0:3], a[192:195], a[128:131], v[96:99]
  v_cvt_pk_bf16_f32 v75, v26, v27
  v_mfma_f32_16x16x32_bf16 v[0:3], a[196:199], a[132:135], v[0:3]
  v_exp_f32 v12, v12
  v_mfma_f32_16x16x32_bf16 v[0:3], a[200:203], a[136:139], v[0:3]
  v_exp_f32 v13, v13
  v_mfma_f32_16x16x32_bf16 v[0:3], a[204:207], a[140:143], v[0:3]
  v_cvt_pk_bf16_f32 v76, v12, v13
  v_mfma_f32_16x16x32_bf16 v[16:19], a[220:223], a[140:143], v[96:99]
  v_exp_f32 v14, v14
  v_mfma_f32_16x16x32_bf16 v[16:19], a[216:219], a[136:139], v[16:19]
  v_exp_f32 v15, v15
  v_mfma_f32_16x16x32_bf16 v[16:19], a[212:215], a[132:135], v[16:19]
  v_cvt_pk_bf16_f32 v77, v14, v15
  v_mfma_f32_16x16x32_bf16 v[16:19], a[208:211], a[128:131], v[16:19]
  v_exp_f32 v28, v28
  v_mfma_f32_16x16x32_bf16 v[4:7], a[192:195], a[144:147], v[100:103]
  v_exp_f32 v29, v29
  v_mfma_f32_16x16x32_bf16 v[4:7], a[196:199], a[148:151], v[4:7]
  v_cvt_pk_bf16_f32 v78, v28, v29
  v_mfma_f32_16x16x32_bf16 v[4:7], a[200:203], a[152:155], v[4:7]
  v_exp_f32 v30, v30
  v_mfma_f32_16x16x32_bf16 v[4:7], a[204:207], a[156:159], v[4:7]
  v_exp_f32 v31, v31
  v_mfma_f32_16x16x32_bf16 v[20:23], a[220:223], a[156:159], v[100:103]
  v_cvt_pk_bf16_f32 v79, v30, v31
  v_mfma_f32_16x16x32_bf16 v[20:23], a[216:219], a[152:155], v[20:23]
  v_exp_f32 v32, v32
  v_mfma_f32_16x16x32_bf16 v[20:23], a[212:215], a[148:151], v[20:23]
  v_add_f32 v112, v112, v32
  v_mfma_f32_16x16x32_bf16 v[20:23], a[208:211], a[144:147], v[20:23]
  v_exp_f32 v33, v33
  v_mfma_f32_16x16x32_bf16 v[8:11], a[192:195], a[160:163], v[104:107]
  v_add_f32 v112, v112, v33
  v_cvt_pk_bf16_f32 v80, v32, v33
  v_mfma_f32_16x16x32_bf16 v[8:11], a[196:199], a[164:167], v[8:11]
  v_exp_f32 v34, v34
  v_mfma_f32_16x16x32_bf16 v[8:11], a[200:203], a[168:171], v[8:11]
  v_add_f32 v112, v112, v34
  v_mfma_f32_16x16x32_bf16 v[8:11], a[204:207], a[172:175], v[8:11]
  v_exp_f32 v35, v35
  v_mfma_f32_16x16x32_bf16 v[24:27], a[220:223], a[172:175], v[104:107]
  v_add_f32 v112, v112, v35
  v_cvt_pk_bf16_f32 v81, v34, v35
  v_mfma_f32_16x16x32_bf16 v[24:27], a[216:219], a[168:171], v[24:27]
  v_exp_f32 v48, v48
  v_mfma_f32_16x16x32_bf16 v[24:27], a[212:215], a[164:167], v[24:27]
  v_add_f32 v112, v112, v48
  v_mfma_f32_16x16x32_bf16 v[24:27], a[208:211], a[160:163], v[24:27]
  v_exp_f32 v49, v49
  v_mfma_f32_16x16x32_bf16 v[12:15], a[192:195], a[176:179], v[108:111]
  ds_read_b128 a[192:195], v216 offset:57344
  v_add_f32 v112, v112, v49
  v_mfma_f32_16x16x32_bf16 v[12:15], a[196:199], a[180:183], v[12:15]
  ds_read_b128 a[196:199], v217 offset:57344
  v_cvt_pk_bf16_f32 v82, v48, v49
  v_mfma_f32_16x16x32_bf16 v[12:15], a[200:203], a[184:187], v[12:15]
  ds_read_b128 a[200:203], v218 offset:57344
  v_mfma_f32_16x16x32_bf16 v[12:15], a[204:207], a[188:191], v[12:15]
  ds_read_b128 a[204:207], v219 offset:57344
  v_mfma_f32_16x16x32_bf16 v[28:31], a[220:223], a[188:191], v[108:111]
  v_exp_f32 v50, v50
  v_mfma_f32_16x16x32_bf16 v[28:31], a[216:219], a[184:187], v[28:31]
  v_add_f32 v112, v112, v50
  v_mfma_f32_16x16x32_bf16 v[28:31], a[212:215], a[180:183], v[28:31]
  v_exp_f32 v51, v51
  v_mfma_f32_16x16x32_bf16 v[28:31], a[208:211], a[176:179], v[28:31]
  ds_read_b128 a[208:211], v216 offset:61440
  v_add_f32 v112, v112, v51
  v_cvt_pk_bf16_f32 v83, v50, v51
  v_exp_f32 v36, v36
  v_exp_f32 v37, v37
  v_add_f32 v113, v113, v36
  v_add_f32 v113, v113, v37
  v_cvt_pk_bf16_f32 v84, v36, v37
  v_exp_f32 v38, v38
  v_exp_f32 v39, v39
  v_add_f32 v113, v113, v38
  v_add_f32 v113, v113, v39
  v_cvt_pk_bf16_f32 v85, v38, v39
  v_exp_f32 v52, v52
  v_exp_f32 v53, v53
  v_add_f32 v113, v113, v52
  v_add_f32 v113, v113, v53
  v_cvt_pk_bf16_f32 v86, v52, v53
  v_exp_f32 v54, v54
  v_exp_f32 v55, v55
  v_add_f32 v113, v113, v54
  v_add_f32 v113, v113, v55
  v_cvt_pk_bf16_f32 v87, v54, v55
  v_exp_f32 v40, v40
  v_exp_f32 v41, v41
  v_exp_f32 v42, v42
  v_cvt_pk_bf16_f32 v88, v40, v41
  v_exp_f32 v43, v43
  v_exp_f32 v56, v56
  v_cvt_pk_bf16_f32 v89, v42, v43
  v_exp_f32 v57, v57
  v_exp_f32 v58, v58
  v_cvt_pk_bf16_f32 v90, v56, v57
  v_exp_f32 v59, v59
  v_exp_f32 v44, v44
  v_cvt_pk_bf16_f32 v91, v58, v59
  v_exp_f32 v45, v45
  v_exp_f32 v46, v46
  v_cvt_pk_bf16_f32 v92, v44, v45
  v_exp_f32 v47, v47
  v_exp_f32 v60, v60
  v_cvt_pk_bf16_f32 v93, v46, v47
  v_exp_f32 v61, v61
  v_exp_f32 v62, v62
  v_cvt_pk_bf16_f32 v94, v60, v61
  v_exp_f32 v63, v63
  ds_read_b128 a[212:215], v217 offset:61440
  v_cvt_pk_bf16_f32 v95, v62, v63
  ds_read_b128 a[216:219], v218 offset:61440
  ds_read_b128 a[220:223], v219 offset:61440
  s_mov_b32 s62, 7
  s_branch L_p2
.p2align 12
L_gst:
  s_branch L_gst_ret
  s_nop 0
L_gemm0:
  s_waitcnt vmcnt(16) lgkmcnt(0)
  v_mfma_f32_16x16x32_bf16 v[0:3], v[64:67], v[96:99], v[0:3]
  ds_read_b128 a[224:227], v210 offset:0
  s_add_u32 s3, s3, 4096
  v_mfma_f32_16x16x32_bf16 v[0:3], v[80:83], v[112:115], v[0:3]
  ds_read_b128 a[228:231], v210 offset:1024
  s_cmp_eq_u32 s3, s7
  v_mfma_f32_16x16x32_bf16 v[4:7], v[80:83], v[116:119], v[4:7]
  ds_read_b128 a[232:235], v210 offset:2048
  s_cselect_b32 s3, 0, s3
  v_mfma_f32_16x16x32_bf16 v[4:7], v[64:67], v[100:103], v[4:7]
  ds_read_b128 a[236:239], v210 offset:3072
  v_add_u32 v210, s3, v213
  v_mfma_f32_16x16x32_bf16 v[8:11], v[64:67], v[104:107], v[8:11]
  ds_read_b64_tr_b16 a[192:193], v244 offset:16384
  s_add_u32 s13, s13, s14
  v_mfma_f32_16x16x32_bf16 v[8:11], v[80:83], v[120:123], v[8:11]
  ds_read_b64_tr_b16 a[194:195], v244 offset:18432
  s_cmp_eq_u32 s13, s27
  v_mfma_f32_16x16x32_bf16 v[12:15], v[80:83], v[124:127], v[12:15]
  ds_read_b64_tr_b16 a[196:197], v245 offset:16384
  s_cselect_b32 s13, 0, s13
  v_mfma_f32_16x16x32_bf16 v[12:15], v[64:67], v[108:111], v[12:15]
  ds_read_b64_tr_b16 a[198:199], v245 offset:18432
  s_add_u32 m0, s64, 49152
  v_mfma_f32_16x16x32_bf16 v[28:31], v[68:71], v[108:111], v[28:31]
  ds_read_b64_tr_b16 a[200:201], v246 offset:16384
  v_mfma_f32_16x16x32_bf16 v[28:31], v[84:87], v[124:127], v[28:31]
  ds_read_b64_tr_b16 a[202:203], v246 offset:18432
  v_mfma_f32_16x16x32_bf16 v[24:27], v[84:87], v[120:123], v[24:27]
  ds_read_b64_tr_b16 a[204:205], v247 offset:16384
  v_mfma_f32_16x16x32_bf16 v[24:27], v[68:71], v[104:107], v[24:27]
  ds_read_b64_tr_b16 a[206:207], v247 offset:18432
  s_sub_u32 s10, s10, 1
  v_mfma_f32_16x16x32_bf16 v[20:23], v[68:71], v[100:103], v[20:23]
  buffer_load_dwordx4 v236, s[40:43], s13 offen offset:0 lds
  v_mfma_f32_16x16x32_bf16 v[20:23], v[84:87], v[116:119], v[20:23]
  buffer_load_dwordx4 v237, s[40:43], s13 offen offset:1024 lds
  v_mfma_f32_16x16x32_bf16 v[16:19], v[84:87], v[112:115], v[16:19]
  buffer_load_dwordx4 v238, s[40:43], s13 offen offset:2048 lds
  v_mfma_f32_16x16x32_bf16 v[16:19], v[68:71], v[96:99], v[16:19]
  buffer_load_dwordx4 v239, s[40:43], s13 offen offset:3072 lds
  s_cbranch_scc1 L_gemm_ret
L_gemm1:
  s_waitcnt vmcnt(16) lgkmcnt(0)
  v_mfma_f32_16x16x32_bf16 v[32:35], v[72:75], v[96:99], v[32:35]
  ds_read_b128 a[240:243], v210 offset:0
  s_add_u32 s3, s3, 4096
  v_mfma_f32_16x16x32_bf16 v[32:35], v[88:91], v[112:115], v[32:35]
  ds_read_b128 a[244:247], v210 offset:1024
  s_cmp_eq_u32 s3, s7
  v_mfma_f32_16x16x32_bf16 v[36:39], v[88:91], v[116:119], v[36:39]
  ds_read_b128 a[248:251], v210 offset:2048
  s_cselect_b32 s3, 0, s3
  v_mfma_f32_16x16x32_bf16 v[36:39], v[72:75], v[100:103], v[36:39]
  ds_read_b128 a[252:255], v210 offset:3072
  v_add_u32 v210, s3, v213
  v_mfma_f32_16x16x32_bf16 v[40:43], v[72:75], v[104:107], v[40:43]
  ds_read_b64_tr_b16 a[208:209], v244 offset:32768
  s_add_u32 s13, s13, s14
  v_mfma_f32_16x16x32_bf16 v[40:43], v[88:91], v[120:123], v[40:43]
  ds_read_b64_tr_b16 a[210:211], v244 offset:34816
  s_cmp_eq_u32 s13, s27
  v_mfma_f32_16x16x32_bf16 v[44:47], v[88:91], v[124:127], v[44:47]
  ds_read_b64_tr_b16 a[212:213], v245 offset:32768
  s_cselect_b32 s13, 0, s13
  v_mfma_f32_16x16x32_bf16 v[44:47], v[72:75], v[108:111], v[44:47]
  ds_read_b64_tr_b16 a[214:215], v245 offset:34816
  s_add_u32 m0, s64, 65536
  v_mfma_f32_16x16x32_bf16 v[60:63], v[76:79], v[108:111], v[60:63]
  ds_read_b64_tr_b16 a[216:217], v246 offset:32768
  v_mfma_f32_16x16x32_bf16 v[60:63], v[92:95], v[124:127], v[60:63]
  ds_read_b64_tr_b16 a[218:219], v246 offset:34816
  v_mfma_f32_16x16x32_bf16 v[56:59], v[92:95], v[120:123], v[56:59]
  ds_read_b64_tr_b16 a[220:221], v247 offset:32768
  v_mfma_f32_16x16x32_bf16 v[56:59], v[76:79], v[104:107], v[56:59]
  ds_read_b64_tr_b16 a[222:223], v247 offset:34816
  v_mfma_f32_16x16x32_bf16 v[52:55], v[76:79], v[100:103], v[52:55]
  buffer_load_dwordx4 v236, s[40:43], s13 offen offset:0 lds
  v_mfma_f32_16x16x32_bf16 v[52:55], v[92:95], v[116:119], v[52:55]
  buffer_load_dwordx4 v237, s[40:43], s13 offen offset:1024 lds
  v_mfma_f32_16x16x32_bf16 v[48:51], v[92:95], v[112:115], v[48:51]
  buffer_load_dwordx4 v238, s[40:43], s13 offen offset:2048 lds
  v_mfma_f32_16x16x32_bf16 v[48:51], v[76:79], v[96:99], v[48:51]
  buffer_load_dwordx4 v239, s[40:43], s13 offen offset:3072 lds
L_gemm2:
  s_waitcnt vmcnt(16) lgkmcnt(0)
  v_mfma_f32_16x16x32_bf16 v[0:3], a[192:195], a[224:227], v[0:3]
  ds_read_b128 v[96:99], v210 offset:0
  s_add_u32 s3, s3, 4096
  v_mfma_f32_16x16x32_bf16 v[0:3], a[208:211], a[240:243], v[0:3]
  ds_read_b128 v[100:103], v210 offset:1024
  s_cmp_eq_u32 s3, s7
  v_mfma_f32_16x16x32_bf16 v[4:7], a[208:211], a[244:247], v[4:7]
  ds_read_b128 v[104:107], v210 offset:2048
  s_cselect_b32 s3, 0, s3
  v_mfma_f32_16x16x32_bf16 v[4:7], a[192:195], a[228:231], v[4:7]
  ds_read_b128 v[108:111], v210 offset:3072
  v_add_u32 v210, s3, v213
  v_mfma_f32_16x16x32_bf16 v[8:11], a[192:195], a[232:235], v[8:11]
  ds_read_b64_tr_b16 v[64:65], v240 offset:0
  s_add_u32 s13, s13, s14
  v_mfma_f32_16x16x32_bf16 v[8:11], a[208:211], a[248:251], v[8:11]
  ds_read_b64_tr_b16 v[66:67], v240 offset:2048
  s_cmp_eq_u32 s13, s27
  v_mfma_f32_16x16x32_bf16 v[12:15], a[208:211], a[252:255], v[12:15]
  ds_read_b64_tr_b16 v[68:69], v241 offset:0
  s_cselect_b32 s13, 0, s13
  v_mfma_f32_16x16x32_bf16 v[12:15], a[192:195], a[236:239], v[12:15]
  ds_read_b64_tr_b16 v[70:71], v241 offset:2048
  s_add_u32 m0, s64, 81920
  v_mfma_f32_16x16x32_bf16 v[28:31], a[196:199], a[236:239], v[28:31]
  ds_read_b64_tr_b16 v[72:73], v242 offset:0
  v_mfma_f32_16x16x32_bf16 v[28:31], a[212:215], a[252:255], v[28:31]
  ds_read_b64_tr_b16 v[74:75], v242 offset:2048
  v_mfma_f32_16x16x32_bf16 v[24:27], a[212:215], a[248:251], v[24:27]
  ds_read_b64_tr_b16 v[76:77], v243 offset:0
  v_mfma_f32_16x16x32_bf16 v[24:27], a[196:199], a[232:235], v[24:27]
  ds_read_b64_tr_b16 v[78:79], v243 offset:2048
  v_mfma_f32_16x16x32_bf16 v[20:23], a[196:199], a[228:231], v[20:23]
  buffer_load_dwordx4 v236, s[40:43], s13 offen offset:0 lds
  v_mfma_f32_16x16x32_bf16 v[20:23], a[212:215], a[244:247], v[20:23]
  buffer_load_dwordx4 v237, s[40:43], s13 offen offset:1024 lds
  v_mfma_f32_16x16x32_bf16 v[16:19], a[212:215], a[240:243], v[16:19]
  buffer_load_dwordx4 v238, s[40:43], s13 offen offset:2048 lds
  v_mfma_f32_16x16x32_bf16 v[16:19], a[196:199], a[224:227], v[16:19]
  buffer_load_dwordx4 v239, s[40:43], s13 offen offset:3072 lds
L_gemm3:
  s_waitcnt vmcnt(16) lgkmcnt(0)
  v_mfma_f32_16x16x32_bf16 v[32:35], a[200:203], a[224:227], v[32:35]
  ds_read_b128 v[112:115], v210 offset:0
  s_add_u32 s3, s3, 4096
  v_mfma_f32_16x16x32_bf16 v[32:35], a[216:219], a[240:243], v[32:35]
  ds_read_b128 v[116:119], v210 offset:1024
  s_cmp_eq_u32 s3, s7
  v_mfma_f32_16x16x32_bf16 v[36:39], a[216:219], a[244:247], v[36:39]
  ds_read_b128 v[120:123], v210 offset:2048
  s_cselect_b32 s3, 0, s3
  v_mfma_f32_16x16x32_bf16 v[36:39], a[200:203], a[228:231], v[36:39]
  ds_read_b128 v[124:127], v210 offset:3072
  v_add_u32 v210, s3, v213
  v_mfma_f32_16x16x32_bf16 v[40:43], a[200:203], a[232:235], v[40:43]
  ds_read_b64_tr_b16 v[80:81], v240 offset:16384
  s_add_u32 s13, s13, s14
  v_mfma_f32_16x16x32_bf16 v[40:43], a[216:219], a[248:251], v[40:43]
  ds_read_b64_tr_b16 v[82:83], v240 offset:18432
  s_cmp_eq_u32 s13, s27
  v_mfma_f32_16x16x32_bf16 v[44:47], a[216:219], a[252:255], v[44:47]
  ds_read_b64_tr_b16 v[84:85], v241 offset:16384
  s_cselect_b32 s13, 0, s13
  v_mfma_f32_16x16x32_bf16 v[44:47], a[200:203], a[236:239], v[44:47]
  ds_read_b64_tr_b16 v[86:87], v241 offset:18432
  s_add_u32 m0, s64, 0
  v_mfma_f32_16x16x32_bf16 v[60:63], a[204:207], a[236:239], v[60:63]
  ds_read_b64_tr_b16 v[88:89], v242 offset:16384
  v_mfma_f32_16x16x32_bf16 v[60:63], a[220:223], a[252:255], v[60:63]
  ds_read_b64_tr_b16 v[90:91], v242 offset:18432
  v_mfma_f32_16x16x32_bf16 v[56:59], a[220:223], a[248:251], v[56:59]
  ds_read_b64_tr_b16 v[92:93], v243 offset:16384
  v_mfma_f32_16x16x32_bf16 v[56:59], a[204:207], a[232:235], v[56:59]
  ds_read_b64_tr_b16 v[94:95], v243 offset:18432
  s_sub_u32 s10, s10, 1
  v_mfma_f32_16x16x32_bf16 v[52:55], a[204:207], a[228:231], v[52:55]
  buffer_load_dwordx4 v236, s[40:43], s13 offen offset:0 lds
  v_mfma_f32_16x16x32_bf16 v[52:55], a[220:223], a[244:247], v[52:55]
  buffer_load_dwordx4 v237, s[40:43], s13 offen offset:1024 lds
  v_mfma_f32_16x16x32_bf16 v[48:51], a[220:223], a[240:243], v[48:51]
  buffer_load_dwordx4 v238, s[40:43], s13 offen offset:2048 lds
  v_mfma_f32_16x16x32_bf16 v[48:51], a[204:207], a[224:227], v[48:51]
  buffer_load_dwordx4 v239, s[40:43], s13 offen offset:3072 lds
  s_cbranch_scc1 L_gemm_ret
L_gemm4:
  s_waitcnt vmcnt(16) lgkmcnt(0)
  v_mfma_f32_16x16x32_bf16 v[0:3], v[64:67], v[96:99], v[0:3]
  ds_read_b128 a[224:227], v210 offset:0
  s_add_u32 s3, s3, 4096
  v_mfma_f32_16x16x32_bf16 v[0:3], v[80:83], v[112:115], v[0:3]
  ds_read_b128 a[228:231], v210 offset:1024
  s_cmp_eq_u32 s3, s7
  v_mfma_f32_16x16x32_bf16 v[4:7], v[80:83], v[116:119], v[4:7]
  ds_read_b128 a[232:235], v210 offset:2048
  s_cselect_b32 s3, 0, s3
  v_mfma_f32_16x16x32_bf16 v[4:7], v[64:67], v[100:103], v[4:7]
  ds_read_b128 a[236:239], v210 offset:3072
  v_add_u32 v210, s3, v213
  v_mfma_f32_16x16x32_bf16 v[8:11], v[64:67], v[104:107], v[8:11]
  ds_read_b64_tr_b16 a[192:193], v240 offset:32768
  s_add_u32 s13, s13, s14
  v_mfma_f32_16x16x32_bf16 v[8:11], v[80:83], v[120:123], v[8:11]
  ds_read_b64_tr_b16 a[194:195], v240 offset:34816
  s_cmp_eq_u32 s13, s27
  v_mfma_f32_16x16x32_bf16 v[12:15], v[80:83], v[124:127], v[12:15]
  ds_read_b64_tr_b16 a[196:197], v241 offset:32768
  s_cselect_b32 s13, 0, s13
  v_mfma_f32_16x16x32_bf16 v[12:15], v[64:67], v[108:111], v[12:15]
  ds_read_b64_tr_b16 a[198:199], v241 offset:34816
  s_add_u32 m0, s64, 16384
  v_mfma_f32_16x16x32_bf16 v[28:31], v[68:71], v[108:111], v[28:31]
  ds_read_b64_tr_b16 a[200:201], v242 offset:32768
  v_mfma_f32_16x16x32_bf16 v[28:31], v[84:87], v[124:127], v[28:31]
  ds_read_b64_tr_b16 a[202:203], v242 offset:34816
  v_mfma_f32_16x16x32_bf16 v[24:27], v[84:87], v[120:123], v[24:27]
  ds_read_b64_tr_b16 a[204:205], v243 offset:32768
  v_mfma_f32_16x16x32_bf16 v[24:27], v[68:71], v[104:107], v[24:27]
  ds_read_b64_tr_b16 a[206:207], v243 offset:34816
  s_sub_u32 s10, s10, 1
  v_mfma_f32_16x16x32_bf16 v[20:23], v[68:71], v[100:103], v[20:23]
  buffer_load_dwordx4 v236, s[40:43], s13 offen offset:0 lds
  v_mfma_f32_16x16x32_bf16 v[20:23], v[84:87], v[116:119], v[20:23]
  buffer_load_dwordx4 v237, s[40:43], s13 offen offset:1024 lds
  v_mfma_f32_16x16x32_bf16 v[16:19], v[84:87], v[112:115], v[16:19]
  buffer_load_dwordx4 v238, s[40:43], s13 offen offset:2048 lds
  v_mfma_f32_16x16x32_bf16 v[16:19], v[68:71], v[96:99], v[16:19]
  buffer_load_dwordx4 v239, s[40:43], s13 offen offset:3072 lds
  s_cbranch_scc1 L_gemm_ret
L_gemm5:
  s_waitcnt vmcnt(16) lgkmcnt(0)
  v_mfma_f32_16x16x32_bf16 v[32:35], v[72:75], v[96:99], v[32:35]
  ds_read_b128 a[240:243], v210 offset:0
  s_add_u32 s3, s3, 4096
  v_mfma_f32_16x16x32_bf16 v[32:35], v[88:91], v[112:115], v[32:35]
  ds_read_b128 a[244:247], v210 offset:1024
  s_cmp_eq_u32 s3, s7
  v_mfma_f32_16x16x32_bf16 v[36:39], v[88:91], v[116:119], v[36:39]
  ds_read_b128 a[248:251], v210 offset:2048
  s_cselect_b32 s3, 0, s3
  v_mfma_f32_16x16x32_bf16 v[36:39], v[72:75], v[100:103], v[36:39]
  ds_read_b128 a[252:255], v210 offset:3072
  v_add_u32 v210, s3, v213
  v_mfma_f32_16x16x32_bf16 v[40:43], v[72:75], v[104:107], v[40:43]
  ds_read_b64_tr_b16 a[208:209], v244 offset:0
  s_add_u32 s13, s13, s14
  v_mfma_f32_16x16x32_bf16 v[40:43], v[88:91], v[120:123], v[40:43]
  ds_read_b64_tr_b16 a[210:211], v244 offset:2048
  s_cmp_eq_u32 s13, s27
  v_mfma_f32_16x16x32_bf16 v[44:47], v[88:91], v[124:127], v[44:47]
  ds_read_b64_tr_b16 a[212:213], v245 offset:0
  s_cselect_b32 s13, 0, s13
  v_mfma_f32_16x16x32_bf16 v[44:47], v[72:75], v[108:111], v[44:47]
  ds_read_b64_tr_b16 a[214:215], v245 offset:2048
  s_add_u32 m0, s64, 32768
  v_mfma_f32_16x16x32_bf16 v[60:63], v[76:79], v[108:111], v[60:63]
  ds_read_b64_tr_b16 a[216:217], v246 offset:0
  v_mfma_f32_16x16x32_bf16 v[60:63], v[92:95], v[124:127], v[60:63]
  ds_read_b64_tr_b16 a[218:219], v246 offset:2048
  v_mfma_f32_16x16x32_bf16 v[56:59], v[92:95], v[120:123], v[56:59]
  ds_read_b64_tr_b16 a[220:221], v247 offset:0
  v_mfma_f32_16x16x32_bf16 v[56:59], v[76:79], v[104:107], v[56:59]
  ds_read_b64_tr_b16 a[222:223], v247 offset:2048
  v_mfma_f32_16x16x32_bf16 v[52:55], v[76:79], v[100:103], v[52:55]
  buffer_load_dwordx4 v236, s[40:43], s13 offen offset:0 lds
  v_mfma_f32_16x16x32_bf16 v[52:55], v[92:95], v[116:119], v[52:55]
  buffer_load_dwordx4 v237, s[40:43], s13 offen offset:1024 lds
  v_mfma_f32_16x16x32_bf16 v[48:51], v[92:95], v[112:115], v[48:51]
  buffer_load_dwordx4 v238, s[40:43], s13 offen offset:2048 lds
  v_mfma_f32_16x16x32_bf16 v[48:51], v[76:79], v[96:99], v[48:51]
  buffer_load_dwordx4 v239, s[40:43], s13 offen offset:3072 lds
L_gemm6:
  s_waitcnt vmcnt(16) lgkmcnt(0)
  v_mfma_f32_16x16x32_bf16 v[0:3], a[192:195], a[224:227], v[0:3]
  ds_read_b128 v[96:99], v210 offset:0
  s_add_u32 s3, s3, 4096
  v_mfma_f32_16x16x32_bf16 v[0:3], a[208:211], a[240:243], v[0:3]
  ds_read_b128 v[100:103], v210 offset:1024
  s_cmp_eq_u32 s3, s7
  v_mfma_f32_16x16x32_bf16 v[4:7], a[208:211], a[244:247], v[4:7]
  ds_read_b128 v[104:107], v210 offset:2048
  s_cselect_b32 s3, 0, s3
  v_mfma_f32_16x16x32_bf16 v[4:7], a[192:195], a[228:231], v[4:7]
  ds_read_b128 v[108:111], v210 offset:3072
  v_add_u32 v210, s3, v213
  v_mfma_f32_16x16x32_bf16 v[8:11], a[192:195], a[232:235], v[8:11]
  ds_read_b64_tr_b16 v[64:65], v244 offset:16384
  s_add_u32 s13, s13, s14
  v_mfma_f32_16x16x32_bf16 v[8:11], a[208:211], a[248:251], v[8:11]
  ds_read_b64_tr_b16 v[66:67], v244 offset:18432
  s_cmp_eq_u32 s13, s27
  v_mfma_f32_16x16x32_bf16 v[12:15], a[208:211], a[252:255], v[12:15]
  ds_read_b64_tr_b16 v[68:69], v245 offset:16384
  s_cselect_b32 s13, 0, s13
  v_mfma_f32_16x16x32_bf16 v[12:15], a[192:195], a[236:239], v[12:15]
  ds_read_b64_tr_b16 v[70:71], v245 offset:18432
  s_add_u32 m0, s64, 49152
  v_mfma_f32_16x16x32_bf16 v[28:31], a[196:199], a[236:239], v[28:31]
  ds_read_b64_tr_b16 v[72:73], v246 offset:16384
  v_mfma_f32_16x16x32_bf16 v[28:31], a[212:215], a[252:255], v[28:31]
  ds_read_b64_tr_b16 v[74:75], v246 offset:18432
  v_mfma_f32_16x16x32_bf16 v[24:27], a[212:215], a[248:251], v[24:27]
  ds_read_b64_tr_b16 v[76:77], v247 offset:16384
  v_mfma_f32_16x16x32_bf16 v[24:27], a[196:199], a[232:235], v[24:27]
  ds_read_b64_tr_b16 v[78:79], v247 offset:18432
  v_mfma_f32_16x16x32_bf16 v[20:23], a[196:199], a[228:231], v[20:23]
  buffer_load_dwordx4 v236, s[40:43], s13 offen offset:0 lds
  v_mfma_f32_16x16x32_bf16 v[20:23], a[212:215], a[244:247], v[20:23]
  buffer_load_dwordx4 v237, s[40:43], s13 offen offset:1024 lds
  v_mfma_f32_16x16x32_bf16 v[16:19], a[212:215], a[240:243], v[16:19]
  buffer_load_dwordx4 v238, s[40:43], s13 offen offset:2048 lds
  v_mfma_f32_16x16x32_bf16 v[16:19], a[196:199], a[224:227], v[16:19]
  buffer_load_dwordx4 v239, s[40:43], s13 offen offset:3072 lds
L_gemm7:
  s_waitcnt vmcnt(16) lgkmcnt(0)
  v_mfma_f32_16x16x32_bf16 v[32:35], a[200:203], a[224:227], v[32:35]
  ds_read_b128 v[112:115], v210 offset:0
  s_add_u32 s3, s3, 4096
  v_mfma_f32_16x16x32_bf16 v[32:35], a[216:219], a[240:243], v[32:35]
  ds_read_b128 v[116:119], v210 offset:1024
  s_cmp_eq_u32 s3, s7
  v_mfma_f32_16x16x32_bf16 v[36:39], a[216:219], a[244:247], v[36:39]
  ds_read_b128 v[120:123], v210 offset:2048
  s_cselect_b32 s3, 0, s3
  v_mfma_f32_16x16x32_bf16 v[36:39], a[200:203], a[228:231], v[36:39]
  ds_read_b128 v[124:127], v210 offset:3072
  v_add_u32 v210, s3, v213
  v_mfma_f32_16x16x32_bf16 v[40:43], a[200:203], a[232:235], v[40:43]
  ds_read_b64_tr_b16 v[80:81], v244 offset:32768
  s_add_u32 s13, s13, s14
  v_mfma_f32_16x16x32_bf16 v[40:43], a[216:219], a[248:251], v[40:43]
  ds_read_b64_tr_b16 v[82:83], v244 offset:34816
  s_cmp_eq_u32 s13, s27
  v_mfma_f32_16x16x32_bf16 v[44:47], a[216:219], a[252:255], v[44:47]
  ds_read_b64_tr_b16 v[84:85], v245 offset:32768
  s_cselect_b32 s13, 0, s13
  v_mfma_f32_16x16x32_bf16 v[44:47], a[200:203], a[236:239], v[44:47]
  ds_read_b64_tr_b16 v[86:87], v245 offset:34816
  s_add_u32 m0, s64, 65536
  v_mfma_f32_16x16x32_bf16 v[60:63], a[204:207], a[236:239], v[60:63]
  ds_read_b64_tr_b16 v[88:89], v246 offset:32768
  v_mfma_f32_16x16x32_bf16 v[60:63], a[220:223], a[252:255], v[60:63]
  ds_read_b64_tr_b16 v[90:91], v246 offset:34816
  v_mfma_f32_16x16x32_bf16 v[56:59], a[220:223], a[248:251], v[56:59]
  ds_read_b64_tr_b16 v[92:93], v247 offset:32768
  v_mfma_f32_16x16x32_bf16 v[56:59], a[204:207], a[232:235], v[56:59]
  ds_read_b64_tr_b16 v[94:95], v247 offset:34816
  s_sub_u32 s10, s10, 1
  v_mfma_f32_16x16x32_bf16 v[52:55], a[204:207], a[228:231], v[52:55]
  buffer_load_dwordx4 v236, s[40:43], s13 offen offset:0 lds
  v_mfma_f32_16x16x32_bf16 v[52:55], a[220:223], a[244:247], v[52:55]
  buffer_load_dwordx4 v237, s[40:43], s13 offen offset:1024 lds
  v_mfma_f32_16x16x32_bf16 v[48:51], a[220:223], a[240:243], v[48:51]
  buffer_load_dwordx4 v238, s[40:43], s13 offen offset:2048 lds
  v_mfma_f32_16x16x32_bf16 v[48:51], a[204:207], a[224:227], v[48:51]
  buffer_load_dwordx4 v239, s[40:43], s13 offen offset:3072 lds
  s_cbranch_scc1 L_gemm_ret
L_gemm8:
  s_waitcnt vmcnt(16) lgkmcnt(0)
  v_mfma_f32_16x16x32_bf16 v[0:3], v[64:67], v[96:99], v[0:3]
  ds_read_b128 a[224:227], v210 offset:0
  s_add_u32 s3, s3, 4096
  v_mfma_f32_16x16x32_bf16 v[0:3], v[80:83], v[112:115], v[0:3]
  ds_read_b128 a[228:231], v210 offset:1024
  s_cmp_eq_u32 s3, s7
  v_mfma_f32_16x16x32_bf16 v[4:7], v[80:83], v[116:119], v[4:7]
  ds_read_b128 a[232:235], v210 offset:2048
  s_cselect_b32 s3, 0, s3
  v_mfma_f32_16x16x32_bf16 v[4:7], v[64:67], v[100:103], v[4:7]
  ds_read_b128 a[236:239], v210 offset:3072
  v_add_u32 v210, s3, v213
  v_mfma_f32_16x16x32_bf16 v[8:11], v[64:67], v[104:107], v[8:11]
  ds_read_b64_tr_b16 a[192:193], v240 offset:0
  s_add_u32 s13, s13, s14
  v_mfma_f32_16x16x32_bf16 v[8:11], v[80:83], v[120:123], v[8:11]
  ds_read_b64_tr_b16 a[194:195], v240 offset:2048
  s_cmp_eq_u32 s13, s27
  v_mfma_f32_16x16x32_bf16 v[12:15], v[80:83], v[124:127], v[12:15]
  ds_read_b64_tr_b16 a[196:197], v241 offset:0
  s_cselect_b32 s13, 0, s13
  v_mfma_f32_16x16x32_bf16 v[12:15], v[64:67], v[108:111], v[12:15]
  ds_read_b64_tr_b16 a[198:199], v241 offset:2048
  s_add_u32 m0, s64, 81920
  v_mfma_f32_16x16x32_bf16 v[28:31], v[68:71], v[108:111], v[28:31]
  ds_read_b64_tr_b16 a[200:201], v242 offset:0
  v_mfma_f32_16x16x32_bf16 v[28:31], v[84:87], v[124:127], v[28:31]
  ds_read_b64_tr_b16 a[202:203], v242 offset:2048
  v_mfma_f32_16x16x32_bf16 v[24:27], v[84:87], v[120:123], v[24:27]
  ds_read_b64_tr_b16 a[204:205], v243 offset:0
  v_mfma_f32_16x16x32_bf16 v[24:27], v[68:71], v[104:107], v[24:27]
  ds_read_b64_tr_b16 a[206:207], v243 offset:2048
  s_sub_u32 s10, s10, 1
  v_mfma_f32_16x16x32_bf16 v[20:23], v[68:71], v[100:103], v[20:23]
  buffer_load_dwordx4 v236, s[40:43], s13 offen offset:0 lds
  v_mfma_f32_16x16x32_bf16 v[20:23], v[84:87], v[116:119], v[20:23]
  buffer_load_dwordx4 v237, s[40:43], s13 offen offset:1024 lds
  v_mfma_f32_16x16x32_bf16 v[16:19], v[84:87], v[112:115], v[16:19]
  buffer_load_dwordx4 v238, s[40:43], s13 offen offset:2048 lds
  v_mfma_f32_16x16x32_bf16 v[16:19], v[68:71], v[96:99], v[16:19]
  buffer_load_dwordx4 v239, s[40:43], s13 offen offset:3072 lds
  s_cbranch_scc1 L_gemm_ret
L_gemm9:
  s_waitcnt vmcnt(16) lgkmcnt(0)
  v_mfma_f32_16x16x32_bf16 v[32:35], v[72:75], v[96:99], v[32:35]
  ds_read_b128 a[240:243], v210 offset:0
  s_add_u32 s3, s3, 4096
  v_mfma_f32_16x16x32_bf16 v[32:35], v[88:91], v[112:115], v[32:35]
  ds_read_b128 a[244:247], v210 offset:1024
  s_cmp_eq_u32 s3, s7
  v_mfma_f32_16x16x32_bf16 v[36:39], v[88:91], v[116:119], v[36:39]
  ds_read_b128 a[248:251], v210 offset:2048
  s_cselect_b32 s3, 0, s3
  v_mfma_f32_16x16x32_bf16 v[36:39], v[72:75], v[100:103], v[36:39]
  ds_read_b128 a[252:255], v210 offset:3072
  v_add_u32 v210, s3, v213
  v_mfma_f32_16x16x32_bf16 v[40:43], v[72:75], v[104:107], v[40:43]
  ds_read_b64_tr_b16 a[208:209], v240 offset:16384
  s_add_u32 s13, s13, s14
  v_mfma_f32_16x16x32_bf16 v[40:43], v[88:91], v[120:123], v[40:43]
  ds_read_b64_tr_b16 a[210:211], v240 offset:18432
  s_cmp_eq_u32 s13, s27
  v_mfma_f32_16x16x32_bf16 v[44:47], v[88:91], v[124:127], v[44:47]
  ds_read_b64_tr_b16 a[212:213], v241 offset:16384
  s_cselect_b32 s13, 0, s13
  v_mfma_f32_16x16x32_bf16 v[44:47], v[72:75], v[108:111], v[44:47]
  ds_read_b64_tr_b16 a[214:215], v241 offset:18432
  s_add_u32 m0, s64, 0
  v_mfma_f32_16x16x32_bf16 v[60:63], v[76:79], v[108:111], v[60:63]
  ds_read_b64_tr_b16 a[216:217], v242 offset:16384
  v_mfma_f32_16x16x32_bf16 v[60:63], v[92:95], v[124:127], v[60:63]
  ds_read_b64_tr_b16 a[218:219], v242 offset:18432
  v_mfma_f32_16x16x32_bf16 v[56:59], v[92:95], v[120:123], v[56:59]
  ds_read_b64_tr_b16 a[220:221], v243 offset:16384
  v_mfma_f32_16x16x32_bf16 v[56:59], v[76:79], v[104:107], v[56:59]
  ds_read_b64_tr_b16 a[222:223], v243 offset:18432
  v_mfma_f32_16x16x32_bf16 v[52:55], v[76:79], v[100:103], v[52:55]
  buffer_load_dwordx4 v236, s[40:43], s13 offen offset:0 lds
  v_mfma_f32_16x16x32_bf16 v[52:55], v[92:95], v[116:119], v[52:55]
  buffer_load_dwordx4 v237, s[40:43], s13 offen offset:1024 lds
  v_mfma_f32_16x16x32_bf16 v[48:51], v[92:95], v[112:115], v[48:51]
  buffer_load_dwordx4 v238, s[40:43], s13 offen offset:2048 lds
  v_mfma_f32_16x16x32_bf16 v[48:51], v[76:79], v[96:99], v[48:51]
  buffer_load_dwordx4 v239, s[40:43], s13 offen offset:3072 lds
L_gemm10:
  s_waitcnt vmcnt(16) lgkmcnt(0)
  v_mfma_f32_16x16x32_bf16 v[0:3], a[192:195], a[224:227], v[0:3]
  ds_read_b128 v[96:99], v210 offset:0
  s_add_u32 s3, s3, 4096
  v_mfma_f32_16x16x32_bf16 v[0:3], a[208:211], a[240:243], v[0:3]
  ds_read_b128 v[100:103], v210 offset:1024
  s_cmp_eq_u32 s3, s7
  v_mfma_f32_16x16x32_bf16 v[4:7], a[208:211], a[244:247], v[4:7]
  ds_read_b128 v[104:107], v210 offset:2048
  s_cselect_b32 s3, 0, s3
  v_mfma_f32_16x16x32_bf16 v[4:7], a[192:195], a[228:231], v[4:7]
  ds_read_b128 v[108:111], v210 offset:3072
  v_add_u32 v210, s3, v213
  v_mfma_f32_16x16x32_bf16 v[8:11], a[192:195], a[232:235], v[8:11]
  ds_read_b64_tr_b16 v[64:65], v240 offset:32768
  s_add_u32 s13, s13, s14
  v_mfma_f32_16x16x32_bf16 v[8:11], a[208:211], a[248:251], v[8:11]
  ds_read_b64_tr_b16 v[66:67], v240 offset:34816
  s_cmp_eq_u32 s13, s27
  v_mfma_f32_16x16x32_bf16 v[12:15], a[208:211], a[252:255], v[12:15]
  ds_read_b64_tr_b16 v[68:69], v241 offset:32768
  s_cselect_b32 s13, 0, s13
  v_mfma_f32_16x16x32_bf16 v[12:15], a[192:195], a[236:239], v[12:15]
  ds_read_b64_tr_b16 v[70:71], v241 offset:34816
  s_add_u32 m0, s64, 16384
  v_mfma_f32_16x16x32_bf16 v[28:31], a[196:199], a[236:239], v[28:31]
  ds_read_b64_tr_b16 v[72:73], v242 offset:32768
  v_mfma_f32_16x16x32_bf16 v[28:31], a[212:215], a[252:255], v[28:31]
  ds_read_b64_tr_b16 v[74:75], v242 offset:34816
  v_mfma_f32_16x16x32_bf16 v[24:27], a[212:215], a[248:251], v[24:27]
  ds_read_b64_tr_b16 v[76:77], v243 offset:32768
  v_mfma_f32_16x16x32_bf16 v[24:27], a[196:199], a[232:235], v[24:27]
  ds_read_b64_tr_b16 v[78:79], v243 offset:34816
  s_sub_u32 s10, s10, 1
  v_mfma_f32_16x16x32_bf16 v[20:23], a[196:199], a[228:231], v[20:23]
  buffer_load_dwordx4 v236, s[40:43], s13 offen offset:0 lds
  v_mfma_f32_16x16x32_bf16 v[20:23], a[212:215], a[244:247], v[20:23]
  buffer_load_dwordx4 v237, s[40:43], s13 offen offset:1024 lds
  v_mfma_f32_16x16x32_bf16 v[16:19], a[212:215], a[240:243], v[16:19]
  buffer_load_dwordx4 v238, s[40:43], s13 offen offset:2048 lds
  v_mfma_f32_16x16x32_bf16 v[16:19], a[196:199], a[224:227], v[16:19]
  buffer_load_dwordx4 v239, s[40:43], s13 offen offset:3072 lds
  s_cbranch_scc1 L_gemm_ret
L_gemm11:
  s_waitcnt vmcnt(16) lgkmcnt(0)
  v_mfma_f32_16x16x32_bf16 v[32:35], a[200:203], a[224:227], v[32:35]
  ds_read_b128 v[112:115], v210 offset:0
  s_add_u32 s3, s3, 4096
  v_mfma_f32_16x16x32_bf16 v[32:35], a[216:219], a[240:243], v[32:35]
  ds_read_b128 v[116:119], v210 offset:1024
  s_cmp_eq_u32 s3, s7
  v_mfma_f32_16x16x32_bf16 v[36:39], a[216:219], a[244:247], v[36:39]
  ds_read_b128 v[120:123], v210 offset:2048
  s_cselect_b32 s3, 0, s3
  v_mfma_f32_16x16x32_bf16 v[36:39], a[200:203], a[228:231], v[36:39]
  ds_read_b128 v[124:127], v210 offset:3072
  v_add_u32 v210, s3, v213
  v_mfma_f32_16x16x32_bf16 v[40:43], a[200:203], a[232:235], v[40:43]
  ds_read_b64_tr_b16 v[80:81], v244 offset:0
  s_add_u32 s13, s13, s14
  v_mfma_f32_16x16x32_bf16 v[40:43], a[216:219], a[248:251], v[40:43]
  ds_read_b64_tr_b16 v[82:83], v244 offset:2048
  s_cmp_eq_u32 s13, s27
  v_mfma_f32_16x16x32_bf16 v[44:47], a[216:219], a[252:255], v[44:47]
  ds_read_b64_tr_b16 v[84:85], v245 offset:0
  s_cselect_b32 s13, 0, s13
  v_mfma_f32_16x16x32_bf16 v[44:47], a[200:203], a[236:239], v[44:47]
  ds_read_b64_tr_b16 v[86:87], v245 offset:2048
  s_add_u32 m0, s64, 32768
  v_mfma_f32_16x16x32_bf16 v[60:63], a[204:207], a[236:239], v[60:63]
  ds_read_b64_tr_b16 v[88:89], v246 offset:0
  v_mfma_f32_16x16x32_bf16 v[60:63], a[220:223], a[252:255], v[60:63]
  ds_read_b64_tr_b16 v[90:91], v246 offset:2048
  v_mfma_f32_16x16x32_bf16 v[56:59], a[220:223], a[248:251], v[56:59]
  ds_read_b64_tr_b16 v[92:93], v247 offset:0
  v_mfma_f32_16x16x32_bf16 v[56:59], a[204:207], a[232:235], v[56:59]
  ds_read_b64_tr_b16 v[94:95], v247 offset:2048
  s_sub_u32 s10, s10, 1
  v_mfma_f32_16x16x32_bf16 v[52:55], a[204:207], a[228:231], v[52:55]
  buffer_load_dwordx4 v236, s[40:43], s13 offen offset:0 lds
  v_mfma_f32_16x16x32_bf16 v[52:55], a[220:223], a[244:247], v[52:55]
  buffer_load_dwordx4 v237, s[40:43], s13 offen offset:1024 lds
  v_mfma_f32_16x16x32_bf16 v[48:51], a[220:223], a[240:243], v[48:51]
  buffer_load_dwordx4 v238, s[40:43], s13 offen offset:2048 lds
  v_mfma_f32_16x16x32_bf16 v[48:51], a[204:207], a[224:227], v[48:51]
  buffer_load_dwordx4 v239, s[40:43], s13 offen offset:3072 lds
  s_cbranch_scc0 L_gemm0
L_gemm_ret:
  s_setpc_b64 s[8:9]
L_code_end:
.section .rodata,"a"
.p2align 6
.amdhsa_kernel recurrent_scan__gqa_block_cached__dense_activation_relu__prompt_kernel
  .amdhsa_next_free_vgpr 512
  .amdhsa_next_free_sgpr 102
  .amdhsa_accum_offset 256
  .amdhsa_group_segment_fixed_size 0
  .amdhsa_kernarg_size 88
  .amdhsa_user_sgpr_count 2
  .amdhsa_user_sgpr_kernarg_segment_ptr 1
  .amdhsa_system_sgpr_workgroup_id_x 1
.end_amdhsa_kernel
```
